```python
import torch

def _softmax(x, axis=-1):
    return torch.softmax(x, dim=axis)

def _gelu(x):
    return torch.nn.functional.gelu(x, approximate='tanh')

def _silu(x):
    return torch.nn.functional.silu(x)

def _sigmoid(x):
    return torch.sigmoid(x)

def _layernorm(x, axis=-1, eps=1e-05):
    m = x.mean(dim=axis, keepdim=True)
    v = x.var(dim=axis, keepdim=True, unbiased=False)
    return (x - m) / torch.sqrt(v + eps)

def _scatter_add(tgt, idx, src, axis=0):
    return tgt.clone().index_add_(axis, idx, src)

def _segment_sum(src, seg, n):
    out = torch.zeros((n,) + src.shape[1:], dtype=src.dtype)
    return out.index_add_(0, seg, src)

def _pad(x, pw):
    flat = tuple((v for pair in reversed(pw) for v in pair))
    return torch.nn.functional.pad(x, flat)
kernel_name = 'parallel_sum__softmax_full_mha__mixer_gmlp__prompt'

def setup_inputs():

    _w = lambda a: (lambda t: t.to(torch.bfloat16) if t.is_floating_point() else t)(torch.as_tensor(a))

    def _A_setup():
        B, S, D = (1, 2048, 640)
        return {'x': _w((lambda *s: torch.randn(*s, dtype=torch.bfloat16) * 0.05)(B, S, D)), 'wqkv': _w((lambda *s: torch.randn(*s, dtype=torch.bfloat16) * 0.2)(D, 3 * D)), 'wo': _w((lambda *s: torch.randn(*s, dtype=torch.bfloat16) * 0.1)(D, D))}
    _A_in = _A_setup()

    def _B_setup():
        B, S, D, F = (1, 2048, 640, 1728)
        Fh = F // 2
        return {'x': _w((lambda *s: torch.randn(*s, dtype=torch.bfloat16) * 0.05)(B, S, D)), 'w_in': _w((lambda *s: torch.randn(*s, dtype=torch.bfloat16) * 0.8)(D, 2 * Fh)), 'w_sp': _w(0.01 * (lambda *s: torch.randn(*s, dtype=torch.bfloat16) * 0.8)(S, S)), 'b_sp': _w(1.0 + 0.01 * (lambda *s: torch.randn(*s, dtype=torch.bfloat16) * 0.2)(S)), 'w_out': _w((lambda *s: torch.randn(*s, dtype=torch.bfloat16) * 0.2)(Fh, D))}
    _B_in = _B_setup()
    return {'A_x': _A_in['x'], 'A_wqkv': _A_in['wqkv'], 'A_wo': _A_in['wo'], 'B_x': _B_in['x'], 'B_w_in': _B_in['w_in'], 'B_w_sp': _B_in['w_sp'], 'B_b_sp': _B_in['b_sp'], 'B_w_out': _B_in['w_out']}

def reference(A_x, A_wqkv, A_wo, B_x, B_w_in, B_w_sp, B_b_sp, B_w_out):

    def _A_ref(x, wqkv, wo):
        B, S, D = x.shape
        H = 32
        Dh = D // H
        qkv = (lambda x, *d: x.permute(*d))((x @ wqkv).reshape(B, S, 3, H, Dh), 2, 0, 3, 1, 4)
        q, k, v = (qkv[0], qkv[1], qkv[2])
        scale = Dh ** (-0.5)
        scores = torch.einsum('bhqd,bhkd->bhqk', q, k) * scale
        p = _softmax(scores, axis=-1)
        o = torch.einsum('bhqk,bhkd->bhqd', p, v)
        return (lambda x, *d: x.permute(*d))(o, 0, 2, 1, 3).reshape(B, S, D) @ wo

    def _B_ref(x, w_in, w_sp, b_sp, w_out):
        B, S, D = x.shape
        F = w_in.shape[-1]
        Fh = F // 2
        z = _gelu(torch.einsum('bsd,df->bsf', x, w_in))
        z1 = z[..., :Fh].clone()
        z2 = _layernorm(z[..., Fh:], axis=-1)
        g = torch.einsum('ts,bsf->btf', w_sp, z2) + b_sp[None, :, None]
        return torch.einsum('bsf,fd->bsd', z1 * g, w_out)
    x = A_x
    xn = _layernorm(x, axis=-1)
    return x + _A_ref(xn, A_wqkv, A_wo) + _B_ref(xn, B_w_in, B_w_sp, B_b_sp, B_w_out)
```

```asm
; @launch kernel=parallel_sum__softmax_full_mha__mixer_gmlp__prompt_kernel grid=(256,1,1) block=(512,1,1) lds=141312
; @launch kernel=k23_kernel grid=(256,1,1) block=(512,1,1) lds=163840
.amdgcn_target "amdgcn-amd-amdhsa--gfx950"
.text
.globl parallel_sum__softmax_full_mha__mixer_gmlp__prompt_kernel
.p2align 8
.type parallel_sum__softmax_full_mha__mixer_gmlp__prompt_kernel,@function
parallel_sum__softmax_full_mha__mixer_gmlp__prompt_kernel:
    s_cmp_ge_u32 s2, 256
    s_cbranch_scc1 K1_END
    s_load_dwordx4 s[4:7], s[0:1], 0
    s_load_dwordx2 s[16:17], s[0:1], 32
    s_load_dwordx2 s[20:21], s[0:1], 80
    v_lshrrev_b32 v1, 6, v0
    v_and_b32 v0, 63, v0
    v_readfirstlane_b32 s30, v1
    s_and_b32 s47, s2, 7
    s_lshr_b32 s48, s2, 3
    s_and_b32 s28, s47, 1
    s_lshl_b32 s28, s28, 3
    s_and_b32 s49, s48, 7
    s_add_u32 s28, s28, s49
    s_lshr_b32 s29, s47, 1
    s_lshl_b32 s29, s29, 2
    s_lshr_b32 s49, s48, 3
    s_add_u32 s29, s29, s49
    s_mov_b32 s22, 31940608
    s_mov_b32 s23, 0x00020000
    s_cmp_eq_u32 s29, 15
    s_cbranch_scc1 K1_WT
    s_and_b32 s31, s30, 3
    s_lshr_b32 s32, s30, 2
    s_lshl_b32 s34, s30, 11
    s_lshl_b32 s47, s28, 7
    s_lshl_b32 s48, s30, 4
    s_add_u32 s47, s47, s48
    s_mul_i32 s47, s47, 1280
    v_lshrrev_b32 v50, 3, v0
    v_lshrrev_b32 v51, 4, v0
    v_and_b32 v52, 7, v0
    v_xor_b32 v36, v51, v52
    v_lshlrev_b32 v36, 4, v36
    s_movk_i32 s48, 1280
    v_mad_u32_u24 v36, v50, s48, v36
    v_add_u32 v36, s47, v36
    v_xor_b32 v37, 64, v36
    v_add_u32 v37, 10240, v37
    s_lshr_b32 s47, s30, 1
    s_and_b32 s48, s30, 1
    s_mul_i32 s33, s47, 2112
    s_mul_i32 s49, s48, 1088
    s_add_u32 s33, s33, s49
    s_lshl_b32 s47, s47, 3
    s_add_u32 s47, s47, s48
    s_lshl_b32 s47, s47, 1
    v_and_b32 v50, 1, v50
    v_lshl_add_u32 v50, v51, 2, v50
    v_add_u32 v50, s47, v50
    v_lshlrev_b32 v52, 4, v52
    s_movk_i32 s48, 3456
    v_mad_u32_u24 v39, v50, s48, v52
    s_movk_i32 s48, 3840
    v_mad_u32_u24 v5, v50, s48, v52
    s_lshl_b32 s47, s29, 7
    s_add_u32 s48, s47, 1664
    s_cmp_lt_u32 s29, 14
    s_cselect_b32 s48, s48, 2130706432
    v_add_u32 v38, s48, v39
    s_cmp_lt_u32 s29, 13
    s_cselect_b32 s48, s47, 2130706432
    v_add_u32 v39, s48, v39
    s_lshl_b32 s47, s29, 8
    v_add_u32 v5, s47, v5
    s_mov_b32 s18, 2211840
    s_mov_b32 s19, 0x00020000
    s_mov_b32 s10, 2621440
    s_mov_b32 s11, 0x00020000
    s_mov_b32 s14, 2457600
    s_mov_b32 s15, 0x00020000
    s_waitcnt lgkmcnt(0)
    s_mov_b32 s8, s4
    s_mov_b32 s9, s5
    s_mov_b32 s12, s6
    s_mov_b32 s13, s7
    s_mov_b32 s56, 0
    s_add_u32 m0, s34, 0
    s_nop 0
    buffer_load_dwordx4 v36, s[8:11], s56 offen lds
    s_mov_b32 s57, 0
    s_add_u32 m0, s34, 1024
    s_nop 0
    buffer_load_dwordx4 v37, s[8:11], s57 offen lds
    s_mov_b32 s58, 0
    s_add_u32 m0, s33, 16896
    s_nop 0
    buffer_load_dwordx4 v38, s[16:19], s58 offen lds
    s_mov_b32 s59, 0
    s_add_u32 m0, s33, 25344
    s_nop 0
    buffer_load_dwordx4 v39, s[16:19], s59 offen lds
    s_cmp_lg_u32 s32, 0
    s_cbranch_scc1 K1_1
    s_mov_b32 s60, 128
    s_add_u32 m0, s34, 33792
    s_nop 0
    buffer_load_dwordx4 v36, s[8:11], s60 offen lds
    s_mov_b32 s61, 128
    s_add_u32 m0, s34, 34816
    s_nop 0
    buffer_load_dwordx4 v37, s[8:11], s61 offen lds
    s_mov_b32 s62, 221184
    s_add_u32 m0, s33, 50688
    s_nop 0
    buffer_load_dwordx4 v38, s[16:19], s62 offen lds
    s_mov_b32 s63, 221184
    s_add_u32 m0, s33, 59136
    s_nop 0
    buffer_load_dwordx4 v39, s[16:19], s63 offen lds
    s_mov_b32 s38, 0
    s_mov_b32 s39, -1
    s_mov_b32 s55, 0xffff0000
    v_bfe_u32 v50, v0, 3, 1
    v_mul_u32_u24 v1, 1088, v50
    v_and_b32 v50, 4, v0
    v_lshl_add_u32 v1, v50, 5, v1
    v_and_b32 v50, 33, v0
    v_lshl_add_u32 v1, v50, 4, v1
    v_and_b32 v50, 16, v0
    v_lshl_add_u32 v1, v50, 1, v1
    v_and_b32 v50, 2, v0
    v_lshl_add_u32 v1, v50, 2, v1
    s_xor_b32 s47, s31, 3
    s_mul_i32 s47, s47, 2112
    s_add_u32 s47, s47, 0
    v_add_u32 v4, s47, v1
    s_xor_b32 s47, s31, 2
    s_mul_i32 s47, s47, 2112
    s_add_u32 s47, s47, 0
    v_add_u32 v3, s47, v1
    s_xor_b32 s47, s31, 1
    s_mul_i32 s47, s47, 2112
    s_add_u32 s47, s47, 0
    v_add_u32 v2, s47, v1
    s_xor_b32 s47, s31, 0
    s_mul_i32 s47, s47, 2112
    s_add_u32 s47, s47, 0
    v_add_u32 v1, s47, v1
    v_and_b32 v50, 31, v0
    v_bfe_u32 v51, v0, 1, 3
    v_lshrrev_b32 v52, 5, v0
    v_xor_b32 v51, v51, v52
    v_lshlrev_b32 v51, 4, v51
    v_lshl_add_u32 v32, v50, 7, v51
    s_mul_i32 s47, s31, 4128
    v_xor_b32 v32, s47, v32
    v_xor_b32 v33, 32, v32
    v_xor_b32 v34, 64, v32
    v_xor_b32 v35, 96, v32
    s_lshl_b32 s37, s28, 14
    s_lshl_b32 s48, s31, 8
    s_add_u32 s37, s37, s48
    s_add_u32 s37, s37, 22675456
    s_add_u32 s43, s37, 4096
    v_lshrrev_b32 v50, 5, v0
    v_mul_u32_u24 v50, 6912, v50
    v_lshl_add_u32 v54, v0, 3, v50
    s_lshl_b32 s48, s29, 10
    v_lshlrev_b32 v55, 3, v0
    v_add_u32 v55, s48, v55
    v_mov_b32 v50, 2130706432
    v_cndmask_b32 v55, v55, v50, s[38:39]
    buffer_load_dword v56, v55, s[20:23], s37 offen offset:4 sc1
    buffer_load_dword v57, v54, s[20:23], s37 offen offset:4 sc1
    buffer_load_dword v58, v54, s[20:23], s37 offen offset:1028 sc1
    buffer_load_dword v59, v54, s[20:23], s37 offen offset:2052 sc1
    buffer_load_dword v60, v54, s[20:23], s37 offen offset:3076 sc1
    buffer_load_dword v61, v54, s[20:23], s43 offen offset:4 sc1
    buffer_load_dword v62, v54, s[20:23], s43 offen offset:1028 sc1
    buffer_load_dword v63, v54, s[20:23], s43 offen offset:2052 sc1
    v_mov_b32 v50, 0x3f803f80
    s_mov_b32 s44, 0x000f000f
    s_mov_b32 s45, 0x0f000f00
    v_cndmask_b32 v6, 0, v50, s[44:45]
    v_cndmask_b32 v7, 0, v50, s[44:45]
    s_lshl_b64 s[44:45], s[44:45], 4
    v_cndmask_b32 v8, 0, v50, s[44:45]
    v_cndmask_b32 v9, 0, v50, s[44:45]
    v_and_b32 v50, 1, v0
    v_mul_u32_u24 v50, 0xaaaa, v50
    v_add_u32 v10, 0x4444, v50
    v_mov_b32 v40, 0
    v_mov_b32 v41, 0
    v_mov_b32 v42, 0
    v_mov_b32 v43, 0
    v_mov_b32 v44, 0
    v_mov_b32 v45, 0
    v_mov_b32 v46, 0
    v_mov_b32 v47, 0
    v_mov_b32 v48, 0
    v_mov_b32 v49, 0
    s_lshl_b32 s50, s28, 2
    s_add_u32 s50, s50, s31
    s_mul_i32 s41, s50, 122880
    s_lshl_b32 s47, s29, 13
    s_add_u32 s41, s41, s47
    s_add_u32 s41, s41, 0
    s_mul_i32 s40, s50, 110592
    s_lshl_b32 s47, s29, 12
    s_add_u32 s40, s40, s47
    s_add_u32 s40, s40, 7917568
    s_cmp_lt_u32 s29, 5
    s_mov_b32 s35, 0xbede652a
    s_cmov_b32 s35, 0xbe0f7cdf
    s_cmp_eq_u32 s29, 0
    s_cselect_b32 s36, 0, 1.0
    s_cselect_b64 s[44:45], -1, 0
    s_mov_b64 s[52:53], 0
    s_cmp_lt_u32 s29, 14
    s_cselect_b32 s42, 0, 2130706432
    s_cselect_b32 s51, 0, 64
    s_waitcnt vmcnt(12)
    s_barrier
    ds_read_b128 v[96:99], v32 offset:0
    ds_read_b64_tr_b16 v[16:17], v1 offset:16896
    ds_read_b64_tr_b16 v[18:19], v1 offset:17152
    ds_read_b64_tr_b16 v[20:21], v1 offset:16960
    ds_read_b64_tr_b16 v[22:23], v1 offset:17216
    ds_read_b128 v[100:103], v33 offset:0
    ds_read_b64_tr_b16 v[24:25], v2 offset:16896
    ds_read_b64_tr_b16 v[26:27], v2 offset:17152
    ds_read_b64_tr_b16 v[28:29], v2 offset:16960
    ds_read_b64_tr_b16 v[30:31], v2 offset:17216
    s_waitcnt lgkmcnt(5)
    v_smfmac_f32_16x16x64_bf16 v[40:43], v[6:9], v[16:23], v10
    v_mfma_f32_32x32x16_bf16 v[64:79], v[16:19], v[96:99], 0
    ds_read_b128 v[104:107], v34 offset:0
    ds_read_b64_tr_b16 v[16:17], v3 offset:16896
    ds_read_b64_tr_b16 v[18:19], v3 offset:17152
    s_mov_b32 s56, 256
    s_add_u32 m0, s34, 67584
    s_nop 0
    buffer_load_dwordx4 v36, s[8:11], s56 offen lds
    v_lshlrev_b32 v50, 16, v96
    v_and_b32 v51, s55, v96
    v_lshlrev_b32 v52, 16, v97
    v_and_b32 v53, s55, v97
    v_mfma_f32_32x32x16_bf16 v[80:95], v[20:23], v[96:99], 0
    ds_read_b64_tr_b16 v[20:21], v3 offset:16960
    ds_read_b64_tr_b16 v[22:23], v3 offset:17216
    s_mov_b32 s57, 256
    s_add_u32 m0, s34, 68608
    s_nop 0
    buffer_load_dwordx4 v37, s[8:11], s57 offen lds
    v_fmac_f32 v48, v50, v50
    v_fmac_f32 v49, v51, v51
    v_fmac_f32 v48, v52, v52
    v_fmac_f32 v49, v53, v53
    s_waitcnt lgkmcnt(7)
    v_mfma_f32_32x32x16_bf16 v[64:79], v[24:27], v[100:103], v[64:79]
    ds_read_b128 v[108:111], v35 offset:0
    ds_read_b64_tr_b16 v[24:25], v4 offset:16896
    ds_read_b64_tr_b16 v[26:27], v4 offset:17152
    s_mov_b32 s58, 442368
    s_add_u32 m0, s33, 84480
    s_nop 0
    buffer_load_dwordx4 v38, s[16:19], s58 offen lds
    v_lshlrev_b32 v50, 16, v98
    v_and_b32 v51, s55, v98
    v_lshlrev_b32 v52, 16, v99
    v_and_b32 v53, s55, v99
    s_waitcnt lgkmcnt(8)
    v_mfma_f32_32x32x16_bf16 v[80:95], v[28:31], v[100:103], v[80:95]
    ds_read_b64_tr_b16 v[28:29], v4 offset:16960
    ds_read_b64_tr_b16 v[30:31], v4 offset:17216
    s_mov_b32 s59, 442368
    s_add_u32 m0, s33, 92928
    s_nop 0
    buffer_load_dwordx4 v39, s[16:19], s59 offen lds
    v_fmac_f32 v48, v50, v50
    v_fmac_f32 v49, v51, v51
    v_fmac_f32 v48, v52, v52
    v_fmac_f32 v49, v53, v53
    v_smfmac_f32_16x16x64_bf16 v[44:47], v[6:9], v[96:103], v10
    s_waitcnt lgkmcnt(7)
    v_mfma_f32_32x32x16_bf16 v[64:79], v[16:19], v[104:107], v[64:79]
    s_mov_b32 s60, 384
    s_add_u32 m0, s34, 101376
    s_nop 0
    buffer_load_dwordx4 v36, s[8:11], s60 offen lds
    v_lshlrev_b32 v50, 16, v100
    v_and_b32 v51, s55, v100
    v_lshlrev_b32 v52, 16, v101
    v_and_b32 v53, s55, v101
    s_waitcnt lgkmcnt(0)
    s_waitcnt vmcnt(13)
    s_barrier
    ds_read_b128 v[112:115], v32 offset:33792
    ds_read_b64_tr_b16 v[16:17], v1 offset:50688
    ds_read_b64_tr_b16 v[18:19], v1 offset:50944
    v_mfma_f32_32x32x16_bf16 v[80:95], v[20:23], v[104:107], v[80:95]
    ds_read_b64_tr_b16 v[20:21], v1 offset:50752
    ds_read_b64_tr_b16 v[22:23], v1 offset:51008
    s_mov_b32 s61, 384
    s_add_u32 m0, s34, 102400
    s_nop 0
    buffer_load_dwordx4 v37, s[8:11], s61 offen lds
    v_fmac_f32 v48, v50, v50
    v_fmac_f32 v49, v51, v51
    v_fmac_f32 v48, v52, v52
    v_fmac_f32 v49, v53, v53
    v_mfma_f32_32x32x16_bf16 v[64:79], v[24:27], v[108:111], v[64:79]
    ds_read_b128 v[116:119], v33 offset:33792
    ds_read_b64_tr_b16 v[24:25], v2 offset:50688
    ds_read_b64_tr_b16 v[26:27], v2 offset:50944
    s_mov_b32 s62, 663552
    s_add_u32 m0, s33, 118272
    s_nop 0
    buffer_load_dwordx4 v38, s[16:19], s62 offen lds
    v_lshlrev_b32 v50, 16, v102
    v_and_b32 v51, s55, v102
    v_lshlrev_b32 v52, 16, v103
    v_and_b32 v53, s55, v103
    v_mfma_f32_32x32x16_bf16 v[80:95], v[28:31], v[108:111], v[80:95]
    ds_read_b64_tr_b16 v[28:29], v2 offset:50752
    ds_read_b64_tr_b16 v[30:31], v2 offset:51008
    s_mov_b32 s63, 663552
    s_add_u32 m0, s33, 126720
    s_nop 0
    buffer_load_dwordx4 v39, s[16:19], s63 offen lds
    v_fmac_f32 v48, v50, v50
    v_fmac_f32 v49, v51, v51
    v_fmac_f32 v48, v52, v52
    v_fmac_f32 v49, v53, v53
    s_waitcnt lgkmcnt(5)
    v_smfmac_f32_16x16x64_bf16 v[40:43], v[6:9], v[16:23], v10
    v_mfma_f32_32x32x16_bf16 v[64:79], v[16:19], v[112:115], v[64:79]
    ds_read_b128 v[120:123], v34 offset:33792
    ds_read_b64_tr_b16 v[16:17], v3 offset:50688
    ds_read_b64_tr_b16 v[18:19], v3 offset:50944
    s_mov_b32 s56, 512
    s_add_u32 m0, s34, 0
    s_nop 0
    buffer_load_dwordx4 v36, s[8:11], s56 offen lds
    v_lshlrev_b32 v50, 16, v112
    v_and_b32 v51, s55, v112
    v_lshlrev_b32 v52, 16, v113
    v_and_b32 v53, s55, v113
    v_mfma_f32_32x32x16_bf16 v[80:95], v[20:23], v[112:115], v[80:95]
    ds_read_b64_tr_b16 v[20:21], v3 offset:50752
    ds_read_b64_tr_b16 v[22:23], v3 offset:51008
    v_fmac_f32 v48, v50, v50
    v_fmac_f32 v49, v51, v51
    v_fmac_f32 v48, v52, v52
    v_fmac_f32 v49, v53, v53
    s_waitcnt lgkmcnt(7)
    v_mfma_f32_32x32x16_bf16 v[64:79], v[24:27], v[116:119], v[64:79]
    ds_read_b128 v[124:127], v35 offset:33792
    ds_read_b64_tr_b16 v[24:25], v4 offset:50688
    ds_read_b64_tr_b16 v[26:27], v4 offset:50944
    s_mov_b32 s57, 512
    s_add_u32 m0, s34, 1024
    s_nop 0
    buffer_load_dwordx4 v37, s[8:11], s57 offen lds
    v_lshlrev_b32 v50, 16, v114
    v_and_b32 v51, s55, v114
    v_lshlrev_b32 v52, 16, v115
    v_and_b32 v53, s55, v115
    s_waitcnt lgkmcnt(8)
    v_mfma_f32_32x32x16_bf16 v[80:95], v[28:31], v[116:119], v[80:95]
    ds_read_b64_tr_b16 v[28:29], v4 offset:50752
    ds_read_b64_tr_b16 v[30:31], v4 offset:51008
    v_fmac_f32 v48, v50, v50
    v_fmac_f32 v49, v51, v51
    v_fmac_f32 v48, v52, v52
    v_fmac_f32 v49, v53, v53
    v_smfmac_f32_16x16x64_bf16 v[44:47], v[6:9], v[112:119], v10
    s_waitcnt lgkmcnt(7)
    v_mfma_f32_32x32x16_bf16 v[64:79], v[16:19], v[120:123], v[64:79]
    s_mov_b32 s58, 884736
    s_add_u32 m0, s33, 16896
    s_nop 0
    buffer_load_dwordx4 v38, s[16:19], s58 offen lds
    v_lshlrev_b32 v50, 16, v116
    v_and_b32 v51, s55, v116
    v_lshlrev_b32 v52, 16, v117
    v_and_b32 v53, s55, v117
    v_add_u32 v1, 67584, v1
    v_add_u32 v2, 67584, v2
    v_add_u32 v3, 67584, v3
    v_add_u32 v4, 67584, v4
    v_add_u32 v32, 67584, v32
    v_add_u32 v33, 67584, v33
    v_add_u32 v34, 67584, v34
    v_add_u32 v35, 67584, v35
    s_waitcnt lgkmcnt(0)
    s_waitcnt vmcnt(7)
    s_barrier
    ds_read_b128 v[128:131], v32 offset:0
    ds_read_b64_tr_b16 v[16:17], v1 offset:16896
    ds_read_b64_tr_b16 v[18:19], v1 offset:17152
    v_mfma_f32_32x32x16_bf16 v[80:95], v[20:23], v[120:123], v[80:95]
    ds_read_b64_tr_b16 v[20:21], v1 offset:16960
    ds_read_b64_tr_b16 v[22:23], v1 offset:17216
    s_mov_b32 s59, 884736
    s_add_u32 m0, s33, 25344
    s_nop 0
    buffer_load_dwordx4 v39, s[16:19], s59 offen lds
    v_fmac_f32 v48, v50, v50
    v_fmac_f32 v49, v51, v51
    v_fmac_f32 v48, v52, v52
    v_fmac_f32 v49, v53, v53
    v_mfma_f32_32x32x16_bf16 v[64:79], v[24:27], v[124:127], v[64:79]
    ds_read_b128 v[132:135], v33 offset:0
    ds_read_b64_tr_b16 v[24:25], v2 offset:16896
    ds_read_b64_tr_b16 v[26:27], v2 offset:17152
    s_mov_b32 s60, 640
    s_add_u32 m0, s34, 33792
    s_nop 0
    buffer_load_dwordx4 v36, s[8:11], s60 offen lds
    v_lshlrev_b32 v50, 16, v118
    v_and_b32 v51, s55, v118
    v_lshlrev_b32 v52, 16, v119
    v_and_b32 v53, s55, v119
    v_mfma_f32_32x32x16_bf16 v[80:95], v[28:31], v[124:127], v[80:95]
    ds_read_b64_tr_b16 v[28:29], v2 offset:16960
    ds_read_b64_tr_b16 v[30:31], v2 offset:17216
    v_fmac_f32 v48, v50, v50
    v_fmac_f32 v49, v51, v51
    v_fmac_f32 v48, v52, v52
    v_fmac_f32 v49, v53, v53
    s_waitcnt lgkmcnt(5)
    v_smfmac_f32_16x16x64_bf16 v[40:43], v[6:9], v[16:23], v10
    v_mfma_f32_32x32x16_bf16 v[64:79], v[16:19], v[128:131], v[64:79]
    ds_read_b128 v[136:139], v34 offset:0
    ds_read_b64_tr_b16 v[16:17], v3 offset:16896
    ds_read_b64_tr_b16 v[18:19], v3 offset:17152
    s_mov_b32 s61, 640
    s_add_u32 m0, s34, 34816
    s_nop 0
    buffer_load_dwordx4 v37, s[8:11], s61 offen lds
    v_lshlrev_b32 v50, 16, v128
    v_and_b32 v51, s55, v128
    v_lshlrev_b32 v52, 16, v129
    v_and_b32 v53, s55, v129
    v_mfma_f32_32x32x16_bf16 v[80:95], v[20:23], v[128:131], v[80:95]
    ds_read_b64_tr_b16 v[20:21], v3 offset:16960
    ds_read_b64_tr_b16 v[22:23], v3 offset:17216
    v_fmac_f32 v48, v50, v50
    v_fmac_f32 v49, v51, v51
    v_fmac_f32 v48, v52, v52
    v_fmac_f32 v49, v53, v53
    s_waitcnt lgkmcnt(7)
    v_mfma_f32_32x32x16_bf16 v[64:79], v[24:27], v[132:135], v[64:79]
    ds_read_b128 v[140:143], v35 offset:0
    ds_read_b64_tr_b16 v[24:25], v4 offset:16896
    ds_read_b64_tr_b16 v[26:27], v4 offset:17152
    s_mov_b32 s62, 1105920
    s_add_u32 m0, s33, 50688
    s_nop 0
    buffer_load_dwordx4 v38, s[16:19], s62 offen lds
    v_lshlrev_b32 v50, 16, v130
    v_and_b32 v51, s55, v130
    v_lshlrev_b32 v52, 16, v131
    v_and_b32 v53, s55, v131
    s_waitcnt lgkmcnt(8)
    v_mfma_f32_32x32x16_bf16 v[80:95], v[28:31], v[132:135], v[80:95]
    ds_read_b64_tr_b16 v[28:29], v4 offset:16960
    ds_read_b64_tr_b16 v[30:31], v4 offset:17216
    v_fmac_f32 v48, v50, v50
    v_fmac_f32 v49, v51, v51
    v_fmac_f32 v48, v52, v52
    v_fmac_f32 v49, v53, v53
    v_smfmac_f32_16x16x64_bf16 v[44:47], v[6:9], v[128:135], v10
    s_waitcnt lgkmcnt(7)
    v_mfma_f32_32x32x16_bf16 v[64:79], v[16:19], v[136:139], v[64:79]
    s_mov_b32 s63, 1105920
    s_add_u32 m0, s33, 59136
    s_nop 0
    buffer_load_dwordx4 v39, s[16:19], s63 offen lds
    v_lshlrev_b32 v50, 16, v132
    v_and_b32 v51, s55, v132
    v_lshlrev_b32 v52, 16, v133
    v_and_b32 v53, s55, v133
    s_waitcnt lgkmcnt(0)
    s_waitcnt vmcnt(8)
    s_barrier
    ds_read_b128 v[144:147], v32 offset:33792
    ds_read_b64_tr_b16 v[16:17], v1 offset:50688
    ds_read_b64_tr_b16 v[18:19], v1 offset:50944
    v_mfma_f32_32x32x16_bf16 v[80:95], v[20:23], v[136:139], v[80:95]
    ds_read_b64_tr_b16 v[20:21], v1 offset:50752
    ds_read_b64_tr_b16 v[22:23], v1 offset:51008
    s_mov_b32 s56, 768
    s_add_u32 m0, s34, 67584
    s_nop 0
    buffer_load_dwordx4 v36, s[8:11], s56 offen lds
    v_fmac_f32 v48, v50, v50
    v_fmac_f32 v49, v51, v51
    v_fmac_f32 v48, v52, v52
    v_fmac_f32 v49, v53, v53
    v_mfma_f32_32x32x16_bf16 v[64:79], v[24:27], v[140:143], v[64:79]
    ds_read_b128 v[148:151], v33 offset:33792
    ds_read_b64_tr_b16 v[24:25], v2 offset:50688
    ds_read_b64_tr_b16 v[26:27], v2 offset:50944
    s_mov_b32 s57, 768
    s_add_u32 m0, s34, 68608
    s_nop 0
    buffer_load_dwordx4 v37, s[8:11], s57 offen lds
    v_lshlrev_b32 v50, 16, v134
    v_and_b32 v51, s55, v134
    v_lshlrev_b32 v52, 16, v135
    v_and_b32 v53, s55, v135
    v_mfma_f32_32x32x16_bf16 v[80:95], v[28:31], v[140:143], v[80:95]
    ds_read_b64_tr_b16 v[28:29], v2 offset:50752
    ds_read_b64_tr_b16 v[30:31], v2 offset:51008
    v_fmac_f32 v48, v50, v50
    v_fmac_f32 v49, v51, v51
    v_fmac_f32 v48, v52, v52
    v_fmac_f32 v49, v53, v53
    s_waitcnt lgkmcnt(5)
    v_smfmac_f32_16x16x64_bf16 v[40:43], v[6:9], v[16:23], v10
    v_mfma_f32_32x32x16_bf16 v[64:79], v[16:19], v[144:147], v[64:79]
    ds_read_b128 v[152:155], v34 offset:33792
    ds_read_b64_tr_b16 v[16:17], v3 offset:50688
    ds_read_b64_tr_b16 v[18:19], v3 offset:50944
    s_mov_b32 s58, 1327104
    s_add_u32 m0, s33, 84480
    s_nop 0
    buffer_load_dwordx4 v38, s[16:19], s58 offen lds
    v_lshlrev_b32 v50, 16, v144
    v_and_b32 v51, s55, v144
    v_lshlrev_b32 v52, 16, v145
    v_and_b32 v53, s55, v145
    v_mfma_f32_32x32x16_bf16 v[80:95], v[20:23], v[144:147], v[80:95]
    ds_read_b64_tr_b16 v[20:21], v3 offset:50752
    ds_read_b64_tr_b16 v[22:23], v3 offset:51008
    v_fmac_f32 v48, v50, v50
    v_fmac_f32 v49, v51, v51
    v_fmac_f32 v48, v52, v52
    v_fmac_f32 v49, v53, v53
    s_waitcnt lgkmcnt(7)
    v_mfma_f32_32x32x16_bf16 v[64:79], v[24:27], v[148:151], v[64:79]
    ds_read_b128 v[156:159], v35 offset:33792
    ds_read_b64_tr_b16 v[24:25], v4 offset:50688
    ds_read_b64_tr_b16 v[26:27], v4 offset:50944
    s_mov_b32 s59, 1327104
    s_add_u32 m0, s33, 92928
    s_nop 0
    buffer_load_dwordx4 v39, s[16:19], s59 offen lds
    v_lshlrev_b32 v50, 16, v146
    v_and_b32 v51, s55, v146
    v_lshlrev_b32 v52, 16, v147
    v_and_b32 v53, s55, v147
    s_waitcnt lgkmcnt(8)
    v_mfma_f32_32x32x16_bf16 v[80:95], v[28:31], v[148:151], v[80:95]
    ds_read_b64_tr_b16 v[28:29], v4 offset:50752
    ds_read_b64_tr_b16 v[30:31], v4 offset:51008
    v_fmac_f32 v48, v50, v50
    v_fmac_f32 v49, v51, v51
    v_fmac_f32 v48, v52, v52
    v_fmac_f32 v49, v53, v53
    v_smfmac_f32_16x16x64_bf16 v[44:47], v[6:9], v[144:151], v10
    s_waitcnt lgkmcnt(7)
    v_mfma_f32_32x32x16_bf16 v[64:79], v[16:19], v[152:155], v[64:79]
    v_lshlrev_b32 v50, 16, v148
    v_and_b32 v51, s55, v148
    v_lshlrev_b32 v52, 16, v149
    v_and_b32 v53, s55, v149
    v_add_u32 v1, -67584, v1
    v_add_u32 v2, -67584, v2
    v_add_u32 v3, -67584, v3
    v_add_u32 v4, -67584, v4
    v_add_u32 v32, -67584, v32
    v_add_u32 v33, -67584, v33
    v_add_u32 v34, -67584, v34
    v_add_u32 v35, -67584, v35
    s_waitcnt lgkmcnt(0)
    s_waitcnt vmcnt(8)
    s_barrier
    ds_read_b128 v[160:163], v32 offset:0
    ds_read_b64_tr_b16 v[16:17], v1 offset:16896
    ds_read_b64_tr_b16 v[18:19], v1 offset:17152
    v_mfma_f32_32x32x16_bf16 v[80:95], v[20:23], v[152:155], v[80:95]
    ds_read_b64_tr_b16 v[20:21], v1 offset:16960
    ds_read_b64_tr_b16 v[22:23], v1 offset:17216
    s_mov_b32 s60, 896
    s_add_u32 m0, s34, 101376
    s_nop 0
    buffer_load_dwordx4 v36, s[8:11], s60 offen lds
    v_fmac_f32 v48, v50, v50
    v_fmac_f32 v49, v51, v51
    v_fmac_f32 v48, v52, v52
    v_fmac_f32 v49, v53, v53
    v_mfma_f32_32x32x16_bf16 v[64:79], v[24:27], v[156:159], v[64:79]
    ds_read_b128 v[164:167], v33 offset:0
    ds_read_b64_tr_b16 v[24:25], v2 offset:16896
    ds_read_b64_tr_b16 v[26:27], v2 offset:17152
    s_mov_b32 s61, 896
    s_add_u32 m0, s34, 102400
    s_nop 0
    buffer_load_dwordx4 v37, s[8:11], s61 offen lds
    v_lshlrev_b32 v50, 16, v150
    v_and_b32 v51, s55, v150
    v_lshlrev_b32 v52, 16, v151
    v_and_b32 v53, s55, v151
    v_mfma_f32_32x32x16_bf16 v[80:95], v[28:31], v[156:159], v[80:95]
    ds_read_b64_tr_b16 v[28:29], v2 offset:16960
    ds_read_b64_tr_b16 v[30:31], v2 offset:17216
    v_fmac_f32 v48, v50, v50
    v_fmac_f32 v49, v51, v51
    v_fmac_f32 v48, v52, v52
    v_fmac_f32 v49, v53, v53
    s_waitcnt lgkmcnt(5)
    v_smfmac_f32_16x16x64_bf16 v[40:43], v[6:9], v[16:23], v10
    v_mfma_f32_32x32x16_bf16 v[64:79], v[16:19], v[160:163], v[64:79]
    ds_read_b128 v[168:171], v34 offset:0
    ds_read_b64_tr_b16 v[16:17], v3 offset:16896
    ds_read_b64_tr_b16 v[18:19], v3 offset:17152
    s_mov_b32 s62, 1548288
    s_add_u32 m0, s33, 118272
    s_nop 0
    buffer_load_dwordx4 v38, s[16:19], s62 offen lds
    v_lshlrev_b32 v50, 16, v160
    v_and_b32 v51, s55, v160
    v_lshlrev_b32 v52, 16, v161
    v_and_b32 v53, s55, v161
    v_mfma_f32_32x32x16_bf16 v[80:95], v[20:23], v[160:163], v[80:95]
    ds_read_b64_tr_b16 v[20:21], v3 offset:16960
    ds_read_b64_tr_b16 v[22:23], v3 offset:17216
    v_fmac_f32 v48, v50, v50
    v_fmac_f32 v49, v51, v51
    v_fmac_f32 v48, v52, v52
    v_fmac_f32 v49, v53, v53
    s_waitcnt lgkmcnt(7)
    v_mfma_f32_32x32x16_bf16 v[64:79], v[24:27], v[164:167], v[64:79]
    ds_read_b128 v[172:175], v35 offset:0
    ds_read_b64_tr_b16 v[24:25], v4 offset:16896
    ds_read_b64_tr_b16 v[26:27], v4 offset:17152
    s_mov_b32 s63, 1548288
    s_add_u32 m0, s33, 126720
    s_nop 0
    buffer_load_dwordx4 v39, s[16:19], s63 offen lds
    v_lshlrev_b32 v50, 16, v162
    v_and_b32 v51, s55, v162
    v_lshlrev_b32 v52, 16, v163
    v_and_b32 v53, s55, v163
    s_waitcnt lgkmcnt(8)
    v_mfma_f32_32x32x16_bf16 v[80:95], v[28:31], v[164:167], v[80:95]
    ds_read_b64_tr_b16 v[28:29], v4 offset:16960
    ds_read_b64_tr_b16 v[30:31], v4 offset:17216
    v_fmac_f32 v48, v50, v50
    v_fmac_f32 v49, v51, v51
    v_fmac_f32 v48, v52, v52
    v_fmac_f32 v49, v53, v53
    v_smfmac_f32_16x16x64_bf16 v[44:47], v[6:9], v[160:167], v10
    s_waitcnt lgkmcnt(7)
    v_mfma_f32_32x32x16_bf16 v[64:79], v[16:19], v[168:171], v[64:79]
    v_lshlrev_b32 v50, 16, v164
    v_and_b32 v51, s55, v164
    v_lshlrev_b32 v52, 16, v165
    v_and_b32 v53, s55, v165
    v_lshlrev_b32 v54, 8, v10
    v_alignbit_b32 v54, v56, v54, 1
    v_alignbit_b32 v54, v57, v54, 1
    s_waitcnt lgkmcnt(0)
    s_waitcnt vmcnt(8)
    s_barrier
    ds_read_b128 v[176:179], v32 offset:33792
    ds_read_b64_tr_b16 v[16:17], v1 offset:50688
    ds_read_b64_tr_b16 v[18:19], v1 offset:50944
    v_mfma_f32_32x32x16_bf16 v[80:95], v[20:23], v[168:171], v[80:95]
    ds_read_b64_tr_b16 v[20:21], v1 offset:50752
    ds_read_b64_tr_b16 v[22:23], v1 offset:51008
    s_mov_b32 s56, 1024
    s_add_u32 m0, s34, 0
    s_nop 0
    buffer_load_dwordx4 v36, s[8:11], s56 offen lds
    v_fmac_f32 v48, v50, v50
    v_fmac_f32 v49, v51, v51
    v_fmac_f32 v48, v52, v52
    v_fmac_f32 v49, v53, v53
    v_alignbit_b32 v54, v58, v54, 1
    v_alignbit_b32 v54, v59, v54, 1
    v_mfma_f32_32x32x16_bf16 v[64:79], v[24:27], v[172:175], v[64:79]
    ds_read_b128 v[180:183], v33 offset:33792
    ds_read_b64_tr_b16 v[24:25], v2 offset:50688
    ds_read_b64_tr_b16 v[26:27], v2 offset:50944
    s_mov_b32 s57, 1024
    s_add_u32 m0, s34, 1024
    s_nop 0
    buffer_load_dwordx4 v37, s[8:11], s57 offen lds
    v_lshlrev_b32 v50, 16, v166
    v_and_b32 v51, s55, v166
    v_lshlrev_b32 v52, 16, v167
    v_and_b32 v53, s55, v167
    v_alignbit_b32 v54, v60, v54, 1
    v_alignbit_b32 v54, v61, v54, 1
    v_mfma_f32_32x32x16_bf16 v[80:95], v[28:31], v[172:175], v[80:95]
    ds_read_b64_tr_b16 v[28:29], v2 offset:50752
    ds_read_b64_tr_b16 v[30:31], v2 offset:51008
    v_fmac_f32 v48, v50, v50
    v_fmac_f32 v49, v51, v51
    v_fmac_f32 v48, v52, v52
    v_fmac_f32 v49, v53, v53
    v_alignbit_b32 v54, v62, v54, 1
    v_alignbit_b32 v10, v63, v54, 1
    s_waitcnt lgkmcnt(5)
    s_nop 0
    v_smfmac_f32_16x16x64_bf16 v[40:43], v[6:9], v[16:23], v10
    v_mfma_f32_32x32x16_bf16 v[64:79], v[16:19], v[176:179], v[64:79]
    ds_read_b128 v[184:187], v34 offset:33792
    ds_read_b64_tr_b16 v[16:17], v3 offset:50688
    ds_read_b64_tr_b16 v[18:19], v3 offset:50944
    s_mov_b32 s58, 1769472
    s_add_u32 m0, s33, 16896
    s_nop 0
    buffer_load_dwordx4 v38, s[16:19], s58 offen lds
    v_lshlrev_b32 v50, 16, v176
    v_and_b32 v51, s55, v176
    v_lshlrev_b32 v52, 16, v177
    v_and_b32 v53, s55, v177
    v_mfma_f32_32x32x16_bf16 v[80:95], v[20:23], v[176:179], v[80:95]
    ds_read_b64_tr_b16 v[20:21], v3 offset:50752
    ds_read_b64_tr_b16 v[22:23], v3 offset:51008
    v_fmac_f32 v48, v50, v50
    v_fmac_f32 v49, v51, v51
    v_fmac_f32 v48, v52, v52
    v_fmac_f32 v49, v53, v53
    s_waitcnt lgkmcnt(7)
    v_mfma_f32_32x32x16_bf16 v[64:79], v[24:27], v[180:183], v[64:79]
    ds_read_b128 v[188:191], v35 offset:33792
    ds_read_b64_tr_b16 v[24:25], v4 offset:50688
    ds_read_b64_tr_b16 v[26:27], v4 offset:50944
    s_mov_b32 s59, 1769472
    s_add_u32 m0, s33, 25344
    s_nop 0
    buffer_load_dwordx4 v39, s[16:19], s59 offen lds
    v_lshlrev_b32 v50, 16, v178
    v_and_b32 v51, s55, v178
    v_lshlrev_b32 v52, 16, v179
    v_and_b32 v53, s55, v179
    s_waitcnt lgkmcnt(8)
    v_mfma_f32_32x32x16_bf16 v[80:95], v[28:31], v[180:183], v[80:95]
    ds_read_b64_tr_b16 v[28:29], v4 offset:50752
    ds_read_b64_tr_b16 v[30:31], v4 offset:51008
    v_fmac_f32 v48, v50, v50
    v_fmac_f32 v49, v51, v51
    v_fmac_f32 v48, v52, v52
    v_fmac_f32 v49, v53, v53
    v_smfmac_f32_16x16x64_bf16 v[44:47], v[6:9], v[176:183], v10
    s_waitcnt lgkmcnt(7)
    v_mfma_f32_32x32x16_bf16 v[64:79], v[16:19], v[184:187], v[64:79]
    v_lshlrev_b32 v50, 16, v180
    v_and_b32 v51, s55, v180
    v_lshlrev_b32 v52, 16, v181
    v_and_b32 v53, s55, v181
    v_add_u32 v1, 67584, v1
    v_add_u32 v2, 67584, v2
    v_add_u32 v3, 67584, v3
    v_add_u32 v4, 67584, v4
    v_add_u32 v32, 67584, v32
    v_add_u32 v33, 67584, v33
    v_add_u32 v34, 67584, v34
    v_add_u32 v35, 67584, v35
    s_waitcnt lgkmcnt(0)
    s_waitcnt vmcnt(8)
    s_barrier
    ds_read_b128 v[192:195], v32 offset:0
    ds_read_b64_tr_b16 v[16:17], v1 offset:16896
    ds_read_b64_tr_b16 v[18:19], v1 offset:17152
    v_mfma_f32_32x32x16_bf16 v[80:95], v[20:23], v[184:187], v[80:95]
    ds_read_b64_tr_b16 v[20:21], v1 offset:16960
    ds_read_b64_tr_b16 v[22:23], v1 offset:17216
    s_mov_b32 s60, 1152
    s_add_u32 m0, s34, 33792
    s_nop 0
    buffer_load_dwordx4 v36, s[8:11], s60 offen lds
    v_fmac_f32 v48, v50, v50
    v_fmac_f32 v49, v51, v51
    v_fmac_f32 v48, v52, v52
    v_fmac_f32 v49, v53, v53
    v_mfma_f32_32x32x16_bf16 v[64:79], v[24:27], v[188:191], v[64:79]
    ds_read_b128 v[196:199], v33 offset:0
    ds_read_b64_tr_b16 v[24:25], v2 offset:16896
    ds_read_b64_tr_b16 v[26:27], v2 offset:17152
    s_mov_b32 s61, 1152
    s_add_u32 m0, s34, 34816
    s_nop 0
    buffer_load_dwordx4 v37, s[8:11], s61 offen lds
    v_lshlrev_b32 v50, 16, v182
    v_and_b32 v51, s55, v182
    v_lshlrev_b32 v52, 16, v183
    v_and_b32 v53, s55, v183
    v_mfma_f32_32x32x16_bf16 v[80:95], v[28:31], v[188:191], v[80:95]
    ds_read_b64_tr_b16 v[28:29], v2 offset:16960
    ds_read_b64_tr_b16 v[30:31], v2 offset:17216
    v_fmac_f32 v48, v50, v50
    v_fmac_f32 v49, v51, v51
    v_fmac_f32 v48, v52, v52
    v_fmac_f32 v49, v53, v53
    s_waitcnt lgkmcnt(5)
    v_smfmac_f32_16x16x64_bf16 v[40:43], v[6:9], v[16:23], v10
    v_mfma_f32_32x32x16_bf16 v[64:79], v[16:19], v[192:195], v[64:79]
    ds_read_b128 v[200:203], v34 offset:0
    ds_read_b64_tr_b16 v[16:17], v3 offset:16896
    ds_read_b64_tr_b16 v[18:19], v3 offset:17152
    s_mov_b32 s62, 1990656
    s_add_u32 m0, s33, 50688
    s_nop 0
    buffer_load_dwordx4 v38, s[16:19], s62 offen lds
    v_lshlrev_b32 v50, 16, v192
    v_and_b32 v51, s55, v192
    v_lshlrev_b32 v52, 16, v193
    v_and_b32 v53, s55, v193
    v_mfma_f32_32x32x16_bf16 v[80:95], v[20:23], v[192:195], v[80:95]
    ds_read_b64_tr_b16 v[20:21], v3 offset:16960
    ds_read_b64_tr_b16 v[22:23], v3 offset:17216
    v_fmac_f32 v48, v50, v50
    v_fmac_f32 v49, v51, v51
    v_fmac_f32 v48, v52, v52
    v_fmac_f32 v49, v53, v53
    s_waitcnt lgkmcnt(7)
    v_mfma_f32_32x32x16_bf16 v[64:79], v[24:27], v[196:199], v[64:79]
    ds_read_b128 v[204:207], v35 offset:0
    ds_read_b64_tr_b16 v[24:25], v4 offset:16896
    ds_read_b64_tr_b16 v[26:27], v4 offset:17152
    s_mov_b32 s63, 1990656
    s_add_u32 m0, s33, 59136
    s_nop 0
    buffer_load_dwordx4 v39, s[16:19], s63 offen lds
    v_lshlrev_b32 v50, 16, v194
    v_and_b32 v51, s55, v194
    v_lshlrev_b32 v52, 16, v195
    v_and_b32 v53, s55, v195
    s_waitcnt lgkmcnt(8)
    v_mfma_f32_32x32x16_bf16 v[80:95], v[28:31], v[196:199], v[80:95]
    ds_read_b64_tr_b16 v[28:29], v4 offset:16960
    ds_read_b64_tr_b16 v[30:31], v4 offset:17216
    v_fmac_f32 v48, v50, v50
    v_fmac_f32 v49, v51, v51
    v_fmac_f32 v48, v52, v52
    v_fmac_f32 v49, v53, v53
    v_smfmac_f32_16x16x64_bf16 v[44:47], v[6:9], v[192:199], v10
    s_waitcnt lgkmcnt(7)
    v_mfma_f32_32x32x16_bf16 v[64:79], v[16:19], v[200:203], v[64:79]
    v_lshlrev_b32 v50, 16, v196
    v_and_b32 v51, s55, v196
    v_lshlrev_b32 v52, 16, v197
    v_and_b32 v53, s55, v197
    s_waitcnt lgkmcnt(0)
    s_waitcnt vmcnt(8)
    s_barrier
    ds_read_b128 v[208:211], v32 offset:33792
    ds_read_b64_tr_b16 v[16:17], v1 offset:50688
    ds_read_b64_tr_b16 v[18:19], v1 offset:50944
    v_mfma_f32_32x32x16_bf16 v[80:95], v[20:23], v[200:203], v[80:95]
    ds_read_b64_tr_b16 v[20:21], v1 offset:50752
    ds_read_b64_tr_b16 v[22:23], v1 offset:51008
    s_mov_b32 s56, 0
    s_add_u32 m0, s33, 67584
    s_nop 0
    buffer_load_dwordx4 v5, s[12:15], s56 offen lds
    v_fmac_f32 v48, v50, v50
    v_fmac_f32 v49, v51, v51
    v_fmac_f32 v48, v52, v52
    v_fmac_f32 v49, v53, v53
    v_mfma_f32_32x32x16_bf16 v[64:79], v[24:27], v[204:207], v[64:79]
    ds_read_b128 v[212:215], v33 offset:33792
    ds_read_b64_tr_b16 v[24:25], v2 offset:50688
    ds_read_b64_tr_b16 v[26:27], v2 offset:50944
    s_mov_b32 s57, 128
    s_add_u32 m0, s33, 76032
    s_nop 0
    buffer_load_dwordx4 v5, s[12:15], s57 offen lds
    v_lshlrev_b32 v50, 16, v198
    v_and_b32 v51, s55, v198
    v_lshlrev_b32 v52, 16, v199
    v_and_b32 v53, s55, v199
    v_mfma_f32_32x32x16_bf16 v[80:95], v[28:31], v[204:207], v[80:95]
    ds_read_b64_tr_b16 v[28:29], v2 offset:50752
    ds_read_b64_tr_b16 v[30:31], v2 offset:51008
    v_fmac_f32 v48, v50, v50
    v_fmac_f32 v49, v51, v51
    v_fmac_f32 v48, v52, v52
    v_fmac_f32 v49, v53, v53
    s_waitcnt lgkmcnt(5)
    v_smfmac_f32_16x16x64_bf16 v[40:43], v[6:9], v[16:23], v10
    v_mfma_f32_32x32x16_bf16 v[64:79], v[16:19], v[208:211], v[64:79]
    ds_read_b128 v[216:219], v34 offset:33792
    ds_read_b64_tr_b16 v[16:17], v3 offset:50688
    ds_read_b64_tr_b16 v[18:19], v3 offset:50944
    s_mov_b32 s58, 245760
    s_add_u32 m0, s33, 84480
    s_nop 0
    buffer_load_dwordx4 v5, s[12:15], s58 offen lds
    v_lshlrev_b32 v50, 16, v208
    v_and_b32 v51, s55, v208
    v_lshlrev_b32 v52, 16, v209
    v_and_b32 v53, s55, v209
    v_mfma_f32_32x32x16_bf16 v[80:95], v[20:23], v[208:211], v[80:95]
    ds_read_b64_tr_b16 v[20:21], v3 offset:50752
    ds_read_b64_tr_b16 v[22:23], v3 offset:51008
    v_fmac_f32 v48, v50, v50
    v_fmac_f32 v49, v51, v51
    v_fmac_f32 v48, v52, v52
    v_fmac_f32 v49, v53, v53
    s_waitcnt lgkmcnt(7)
    v_mfma_f32_32x32x16_bf16 v[64:79], v[24:27], v[212:215], v[64:79]
    ds_read_b128 v[220:223], v35 offset:33792
    ds_read_b64_tr_b16 v[24:25], v4 offset:50688
    ds_read_b64_tr_b16 v[26:27], v4 offset:50944
    s_mov_b32 s59, 245888
    s_add_u32 m0, s33, 92928
    s_nop 0
    buffer_load_dwordx4 v5, s[12:15], s59 offen lds
    v_lshlrev_b32 v50, 16, v210
    v_and_b32 v51, s55, v210
    v_lshlrev_b32 v52, 16, v211
    v_and_b32 v53, s55, v211
    s_waitcnt lgkmcnt(8)
    v_mfma_f32_32x32x16_bf16 v[80:95], v[28:31], v[212:215], v[80:95]
    ds_read_b64_tr_b16 v[28:29], v4 offset:50752
    ds_read_b64_tr_b16 v[30:31], v4 offset:51008
    v_fmac_f32 v48, v50, v50
    v_fmac_f32 v49, v51, v51
    v_fmac_f32 v48, v52, v52
    v_fmac_f32 v49, v53, v53
    v_smfmac_f32_16x16x64_bf16 v[44:47], v[6:9], v[208:215], v10
    s_waitcnt lgkmcnt(7)
    v_mfma_f32_32x32x16_bf16 v[64:79], v[16:19], v[216:219], v[64:79]
    v_lshlrev_b32 v50, 16, v212
    v_and_b32 v51, s55, v212
    v_lshlrev_b32 v52, 16, v213
    v_and_b32 v53, s55, v213
    v_lshlrev_b32 v54, 4, v0
    v_add_u32 v54, 135168, v54
    v_add_u32 v1, -67584, v1
    v_add_u32 v2, -67584, v2
    v_add_u32 v3, -67584, v3
    v_add_u32 v4, -67584, v4
    v_add_u32 v32, -67584, v32
    v_add_u32 v33, -67584, v33
    v_add_u32 v34, -67584, v34
    v_add_u32 v35, -67584, v35
    s_waitcnt lgkmcnt(0)
    s_waitcnt vmcnt(8)
    s_barrier
    ds_read_b128 v[224:227], v32 offset:0
    ds_read_b64_tr_b16 v[16:17], v1 offset:16896
    ds_read_b64_tr_b16 v[18:19], v1 offset:17152
    v_mfma_f32_32x32x16_bf16 v[80:95], v[20:23], v[216:219], v[80:95]
    ds_read_b64_tr_b16 v[20:21], v1 offset:16960
    ds_read_b64_tr_b16 v[22:23], v1 offset:17216
    s_mov_b32 s60, 491520
    s_add_u32 m0, s33, 101376
    s_nop 0
    buffer_load_dwordx4 v5, s[12:15], s60 offen lds
    v_fmac_f32 v48, v50, v50
    v_fmac_f32 v49, v51, v51
    v_fmac_f32 v48, v52, v52
    v_fmac_f32 v49, v53, v53
    v_and_b32 v55, 31, v0
    v_lshlrev_b32 v55, 4, v55
    v_mfma_f32_32x32x16_bf16 v[64:79], v[24:27], v[220:223], v[64:79]
    ds_read_b128 v[228:231], v33 offset:0
    ds_read_b64_tr_b16 v[24:25], v2 offset:16896
    ds_read_b64_tr_b16 v[26:27], v2 offset:17152
    s_mov_b32 s61, 491648
    s_add_u32 m0, s33, 109824
    s_nop 0
    buffer_load_dwordx4 v5, s[12:15], s61 offen lds
    v_lshlrev_b32 v50, 16, v214
    v_and_b32 v51, s55, v214
    v_lshlrev_b32 v52, 16, v215
    v_and_b32 v53, s55, v215
    s_lshl_b32 s47, s31, 9
    s_add_u32 s47, s47, 135168
    v_add_u32 v55, s47, v55
    v_lshrrev_b32 v56, 5, v0
    v_mfma_f32_32x32x16_bf16 v[80:95], v[28:31], v[220:223], v[80:95]
    ds_read_b64_tr_b16 v[28:29], v2 offset:16960
    ds_read_b64_tr_b16 v[30:31], v2 offset:17216
    v_fmac_f32 v48, v50, v50
    v_fmac_f32 v49, v51, v51
    v_fmac_f32 v48, v52, v52
    v_fmac_f32 v49, v53, v53
    v_lshl_add_u32 v56, v56, 2, v55
    s_waitcnt lgkmcnt(5)
    v_smfmac_f32_16x16x64_bf16 v[40:43], v[6:9], v[16:23], v10
    v_mfma_f32_32x32x16_bf16 v[64:79], v[16:19], v[224:227], v[64:79]
    ds_read_b128 v[232:235], v34 offset:0
    ds_read_b64_tr_b16 v[16:17], v3 offset:16896
    ds_read_b64_tr_b16 v[18:19], v3 offset:17152
    s_mov_b32 s62, 737280
    s_add_u32 m0, s33, 118272
    s_nop 0
    buffer_load_dwordx4 v5, s[12:15], s62 offen lds
    v_lshlrev_b32 v50, 16, v224
    v_and_b32 v51, s55, v224
    v_lshlrev_b32 v52, 16, v225
    v_and_b32 v53, s55, v225
    v_mfma_f32_32x32x16_bf16 v[80:95], v[20:23], v[224:227], v[80:95]
    ds_read_b64_tr_b16 v[20:21], v3 offset:16960
    ds_read_b64_tr_b16 v[22:23], v3 offset:17216
    v_fmac_f32 v48, v50, v50
    v_fmac_f32 v49, v51, v51
    v_fmac_f32 v48, v52, v52
    v_fmac_f32 v49, v53, v53
    s_waitcnt lgkmcnt(7)
    v_mfma_f32_32x32x16_bf16 v[64:79], v[24:27], v[228:231], v[64:79]
    ds_read_b128 v[236:239], v35 offset:0
    ds_read_b64_tr_b16 v[24:25], v4 offset:16896
    ds_read_b64_tr_b16 v[26:27], v4 offset:17152
    s_mov_b32 s63, 737408
    s_add_u32 m0, s33, 126720
    s_nop 0
    buffer_load_dwordx4 v5, s[12:15], s63 offen lds
    v_lshlrev_b32 v50, 16, v226
    v_and_b32 v51, s55, v226
    v_lshlrev_b32 v52, 16, v227
    v_and_b32 v53, s55, v227
    s_waitcnt lgkmcnt(8)
    v_mfma_f32_32x32x16_bf16 v[80:95], v[28:31], v[228:231], v[80:95]
    ds_read_b64_tr_b16 v[28:29], v4 offset:16960
    ds_read_b64_tr_b16 v[30:31], v4 offset:17216
    v_fmac_f32 v48, v50, v50
    v_fmac_f32 v49, v51, v51
    v_fmac_f32 v48, v52, v52
    v_fmac_f32 v49, v53, v53
    v_smfmac_f32_16x16x64_bf16 v[44:47], v[6:9], v[224:231], v10
    s_waitcnt lgkmcnt(7)
    v_mfma_f32_32x32x16_bf16 v[64:79], v[16:19], v[232:235], v[64:79]
    v_lshlrev_b32 v50, 16, v228
    v_and_b32 v51, s55, v228
    v_lshlrev_b32 v52, 16, v229
    v_and_b32 v53, s55, v229
    s_waitcnt lgkmcnt(0)
    s_waitcnt vmcnt(8)
    s_barrier
    ds_read_b128 v[240:243], v32 offset:33792
    ds_read_b64_tr_b16 v[16:17], v1 offset:50688
    ds_read_b64_tr_b16 v[18:19], v1 offset:50944
    v_mfma_f32_32x32x16_bf16 v[80:95], v[20:23], v[232:235], v[80:95]
    ds_read_b64_tr_b16 v[20:21], v1 offset:50752
    ds_read_b64_tr_b16 v[22:23], v1 offset:51008
    s_mov_b32 s56, 983040
    s_add_u32 m0, s33, 0
    s_nop 0
    buffer_load_dwordx4 v5, s[12:15], s56 offen lds
    v_fmac_f32 v48, v50, v50
    v_fmac_f32 v49, v51, v51
    v_fmac_f32 v48, v52, v52
    v_fmac_f32 v49, v53, v53
    v_mfma_f32_32x32x16_bf16 v[64:79], v[24:27], v[236:239], v[64:79]
    ds_read_b128 v[244:247], v33 offset:33792
    ds_read_b64_tr_b16 v[24:25], v2 offset:50688
    ds_read_b64_tr_b16 v[26:27], v2 offset:50944
    s_mov_b32 s57, 983168
    s_add_u32 m0, s33, 8448
    s_nop 0
    buffer_load_dwordx4 v5, s[12:15], s57 offen lds
    v_lshlrev_b32 v50, 16, v230
    v_and_b32 v51, s55, v230
    v_lshlrev_b32 v52, 16, v231
    v_and_b32 v53, s55, v231
    v_mfma_f32_32x32x16_bf16 v[80:95], v[28:31], v[236:239], v[80:95]
    ds_read_b64_tr_b16 v[28:29], v2 offset:50752
    ds_read_b64_tr_b16 v[30:31], v2 offset:51008
    ds_read_b128 v[248:251], v34 offset:33792
    ds_read_b128 v[252:255], v35 offset:33792
    v_fmac_f32 v48, v50, v50
    v_fmac_f32 v49, v51, v51
    v_fmac_f32 v48, v52, v52
    v_fmac_f32 v49, v53, v53
    s_waitcnt lgkmcnt(7)
    v_smfmac_f32_16x16x64_bf16 v[40:43], v[6:9], v[16:23], v10
    v_mfma_f32_32x32x16_bf16 v[64:79], v[16:19], v[240:243], v[64:79]
    ds_read_b64_tr_b16 v[16:17], v3 offset:50688
    ds_read_b64_tr_b16 v[18:19], v3 offset:50944
    s_mov_b32 s58, 1228800
    s_add_u32 m0, s33, 16896
    s_nop 0
    buffer_load_dwordx4 v5, s[12:15], s58 offen lds
    v_lshlrev_b32 v50, 16, v240
    v_and_b32 v51, s55, v240
    v_lshlrev_b32 v52, 16, v241
    v_and_b32 v53, s55, v241
    v_fmac_f32 v48, v50, v50
    v_fmac_f32 v49, v51, v51
    v_fmac_f32 v48, v52, v52
    v_fmac_f32 v49, v53, v53
    v_lshlrev_b32 v50, 16, v242
    v_and_b32 v51, s55, v242
    v_lshlrev_b32 v52, 16, v243
    v_mfma_f32_32x32x16_bf16 v[80:95], v[20:23], v[240:243], v[80:95]
    ds_read_b64_tr_b16 v[20:21], v3 offset:50752
    ds_read_b64_tr_b16 v[22:23], v3 offset:51008
    v_and_b32 v53, s55, v243
    v_fmac_f32 v48, v50, v50
    v_fmac_f32 v49, v51, v51
    v_fmac_f32 v48, v52, v52
    v_fmac_f32 v49, v53, v53
    s_waitcnt lgkmcnt(10)
    v_lshlrev_b32 v50, 16, v244
    v_and_b32 v51, s55, v244
    v_lshlrev_b32 v52, 16, v245
    v_and_b32 v53, s55, v245
    v_fmac_f32 v48, v50, v50
    v_fmac_f32 v49, v51, v51
    v_smfmac_f32_16x16x64_bf16 v[44:47], v[6:9], v[240:247], v10
    s_waitcnt lgkmcnt(8)
    v_mfma_f32_32x32x16_bf16 v[64:79], v[24:27], v[244:247], v[64:79]
    ds_read_b64_tr_b16 v[24:25], v4 offset:50688
    ds_read_b64_tr_b16 v[26:27], v4 offset:50944
    s_mov_b32 s59, 1228928
    s_add_u32 m0, s33, 25344
    s_nop 0
    buffer_load_dwordx4 v5, s[12:15], s59 offen lds
    v_fmac_f32 v48, v52, v52
    v_fmac_f32 v49, v53, v53
    v_lshlrev_b32 v50, 16, v246
    v_and_b32 v51, s55, v246
    v_lshlrev_b32 v52, 16, v247
    v_and_b32 v53, s55, v247
    v_fmac_f32 v48, v50, v50
    v_fmac_f32 v49, v51, v51
    v_fmac_f32 v48, v52, v52
    v_fmac_f32 v49, v53, v53
    s_waitcnt lgkmcnt(8)
    v_mfma_f32_32x32x16_bf16 v[80:95], v[28:31], v[244:247], v[80:95]
    ds_read_b64_tr_b16 v[28:29], v4 offset:50752
    ds_read_b64_tr_b16 v[30:31], v4 offset:51008
    s_lshl_b32 s47, s31, 2
    v_add_u32 v57, s47, v54
    v_add_f32 v40, v40, v41
    ds_write_b32 v57, v40 offset:2048
    v_add_f32 v44, v44, v45
    v_add_f32 v48, v48, v49
    s_nop 1
    v_permlane32_swap_b32 v44, v48
    v_add_f32 v44, v44, v48
    ds_write_b32 v56, v44 offset:0
    s_waitcnt lgkmcnt(8)
    v_mfma_f32_32x32x16_bf16 v[64:79], v[16:19], v[248:251], v[64:79]
    v_add_u32 v1, 67584, v1
    v_add_u32 v2, 67584, v2
    v_add_u32 v3, 67584, v3
    v_add_u32 v4, 67584, v4
    s_waitcnt lgkmcnt(0)
    s_waitcnt vmcnt(8)
    s_barrier
    ds_read_b64_tr_b16 v[16:17], v1 offset:0
    ds_read_b64_tr_b16 v[18:19], v1 offset:256
    ds_read_b128 v[56:59], v55
    ds_read_b128 v[60:63], v54 offset:2048
    v_mfma_f32_32x32x16_bf16 v[80:95], v[20:23], v[248:251], v[80:95]
    ds_read_b64_tr_b16 v[20:21], v1 offset:64
    ds_read_b64_tr_b16 v[22:23], v1 offset:320
    s_mov_b32 s60, 1474560
    s_add_u32 m0, s33, 33792
    s_nop 0
    buffer_load_dwordx4 v5, s[12:15], s60 offen lds
    v_mfma_f32_32x32x16_bf16 v[64:79], v[24:27], v[252:255], v[64:79]
    ds_read_b64_tr_b16 v[24:25], v2 offset:0
    ds_read_b64_tr_b16 v[26:27], v2 offset:256
    s_mov_b32 s61, 1474688
    s_add_u32 m0, s33, 42240
    s_nop 0
    buffer_load_dwordx4 v5, s[12:15], s61 offen lds
    s_waitcnt lgkmcnt(5)
    v_add_f32 v56, v56, v58
    v_add_f32 v57, v57, v59
    s_waitcnt lgkmcnt(4)
    v_add_f32 v60, v60, v61
    v_mul_f32 v56, 0xbacccccd, v56
    v_mul_f32 v57, 0x3acccccd, v57
    v_add_f32 v62, v62, v63
    v_cvt_pk_bf16_f32 v12, v56, v56
    v_fma_f32 v57, -v56, v56, v57
    v_add_f32 v60, v60, v62
    v_and_b32 v58, s55, v12
    v_cvt_pk_bf16_f32 v61, v60, v60
    v_max_f32 v57, 0, v57
    v_sub_f32 v58, v56, v58
    v_and_b32 v61, s55, v61
    v_add_f32 v57, 0x3727c5ac, v57
    v_cvt_pk_bf16_f32 v13, v58, v58
    v_sub_f32 v62, v60, v61
    v_rsq_f32 v14, v57
    v_mfma_f32_32x32x16_bf16 v[80:95], v[28:31], v[252:255], v[80:95]
    ds_read_b64_tr_b16 v[28:29], v2 offset:64
    ds_read_b64_tr_b16 v[30:31], v2 offset:320
    v_cvt_pk_bf16_f32 v40, v60, v62
    v_and_b32 v59, s55, v13
    v_sqrt_f32 v11, v57
    v_and_b32 v61, s55, v40
    v_sub_f32 v58, v58, v59
    v_cndmask_b32 v13, v13, 0, s[38:39]
    v_sub_f32 v62, v62, v61
    v_cvt_pk_bf16_f32 v58, v56, v58
    v_cvt_pk_bf16_f32 v42, v62, v60
    v_mul_f32 v15, 0xc0135761, v14
    v_cndmask_b32 v12, v12, v58, s[38:39]
    v_permlane32_swap_b32 v40, v42
    v_mul_f32 v14, v14, v14
    v_mul_f32 v14, 0x3d372713, v14
    v_mov_b32 v41, v40
    v_mul_f32 v14, v14, v15
    v_mov_b32 v43, v42
    v_mfma_f32_32x32x8bf16_1k v[64:79], v[40:41], v[12:13], v[64:79]
    s_nop 0
    v_mfma_f32_32x32x8bf16_1k v[80:95], v[42:43], v[12:13], v[80:95]
    v_mfma_f32_32x32x16_bf16 v[32:47], v[16:19], v[96:99], 0
    ds_read_b64_tr_b16 v[16:17], v3 offset:0
    ds_read_b64_tr_b16 v[18:19], v3 offset:256
    s_mov_b32 s62, 1720320
    s_add_u32 m0, s33, 50688
    s_nop 0
    buffer_load_dwordx4 v5, s[12:15], s62 offen lds
    s_waitcnt lgkmcnt(6)
    v_mfma_f32_32x32x16_bf16 v[48:63], v[20:23], v[96:99], 0
    ds_read_b64_tr_b16 v[20:21], v3 offset:64
    ds_read_b64_tr_b16 v[22:23], v3 offset:320
    s_setprio 1
    s_waitcnt lgkmcnt(6)
    v_mfma_f32_32x32x16_bf16 v[32:47], v[24:27], v[100:103], v[32:47]
    ds_read_b64_tr_b16 v[24:25], v4 offset:0
    ds_read_b64_tr_b16 v[26:27], v4 offset:256
    s_mov_b32 s63, 1720448
    s_add_u32 m0, s33, 59136
    s_nop 0
    buffer_load_dwordx4 v5, s[12:15], s63 offen lds
    v_mul_f32 v96, v64, v64
    v_mul_f32 v97, v65, v65
    v_mul_f32 v98, v66, v66
    v_mul_f32 v99, v67, v67
    v_fma_f32 v96, v96, v14, v15
    v_fma_f32 v97, v97, v14, v15
    v_fma_f32 v98, v98, v14, v15
    v_fma_f32 v99, v99, v14, v15
    v_mul_f32 v96, v96, v64
    v_mul_f32 v97, v97, v65
    v_mul_f32 v98, v98, v66
    v_mul_f32 v99, v99, v67
    s_waitcnt lgkmcnt(6)
    v_mfma_f32_32x32x16_bf16 v[48:63], v[28:31], v[100:103], v[48:63]
    ds_read_b64_tr_b16 v[28:29], v4 offset:64
    ds_read_b64_tr_b16 v[30:31], v4 offset:320
    v_exp_f32 v96, v96
    v_exp_f32 v97, v97
    v_exp_f32 v98, v98
    v_exp_f32 v99, v99
    v_fma_f32 v96, v96, v11, v11
    v_fma_f32 v97, v97, v11, v11
    v_fma_f32 v98, v98, v11, v11
    v_fma_f32 v99, v99, v11, v11
    s_waitcnt lgkmcnt(6)
    v_mfma_f32_32x32x16_bf16 v[32:47], v[16:19], v[104:107], v[32:47]
    ds_read_b64_tr_b16 v[16:17], v1 offset:16896
    ds_read_b64_tr_b16 v[18:19], v1 offset:17152
    v_rcp_f32 v96, v96
    v_rcp_f32 v97, v97
    v_rcp_f32 v98, v98
    v_rcp_f32 v99, v99
    v_mul_f32 v64, v96, v64
    v_mul_f32 v65, v97, v65
    v_mul_f32 v66, v98, v66
    s_waitcnt lgkmcnt(6)
    v_mfma_f32_32x32x16_bf16 v[48:63], v[20:23], v[104:107], v[48:63]
    ds_read_b64_tr_b16 v[20:21], v1 offset:16960
    ds_read_b64_tr_b16 v[22:23], v1 offset:17216
    v_mul_f32 v67, v99, v67
    v_add_f32 v100, v64, v65
    v_mul_f32 v101, v64, v64
    v_add_f32 v102, v66, v67
    v_mul_f32 v103, v66, v66
    v_fmac_f32 v101, v65, v65
    v_fmac_f32 v103, v67, v67
    v_mul_f32 v96, v68, v68
    v_mul_f32 v97, v69, v69
    v_mul_f32 v98, v70, v70
    v_mul_f32 v99, v71, v71
    v_fma_f32 v96, v96, v14, v15
    v_mov_b32 v104, 0
    v_mov_b32 v105, 0
    v_mov_b32 v106, 0
    v_mov_b32 v107, 0
    s_waitcnt lgkmcnt(4)
    s_nop 0
    v_smfmac_f32_16x16x64_bf16 v[104:107], v[6:9], v[24:31], v10
    v_mfma_f32_32x32x16_bf16 v[32:47], v[24:27], v[108:111], v[32:47]
    ds_read_b64_tr_b16 v[24:25], v2 offset:16896
    ds_read_b64_tr_b16 v[26:27], v2 offset:17152
    v_fma_f32 v97, v97, v14, v15
    v_fma_f32 v98, v98, v14, v15
    v_fma_f32 v99, v99, v14, v15
    v_mul_f32 v96, v96, v68
    v_mul_f32 v97, v97, v69
    v_mul_f32 v98, v98, v70
    v_mul_f32 v99, v99, v71
    v_exp_f32 v96, v96
    v_exp_f32 v97, v97
    v_mfma_f32_32x32x16_bf16 v[48:63], v[28:31], v[108:111], v[48:63]
    ds_read_b64_tr_b16 v[28:29], v2 offset:16960
    ds_read_b64_tr_b16 v[30:31], v2 offset:17216
    v_exp_f32 v98, v98
    v_exp_f32 v99, v99
    v_fma_f32 v96, v96, v11, v11
    v_fma_f32 v97, v97, v11, v11
    v_fma_f32 v98, v98, v11, v11
    v_fma_f32 v99, v99, v11, v11
    v_rcp_f32 v96, v96
    v_rcp_f32 v97, v97
    s_waitcnt lgkmcnt(4)
    v_smfmac_f32_16x16x64_bf16 v[104:107], v[6:9], v[16:23], v10
    v_mfma_f32_32x32x16_bf16 v[32:47], v[16:19], v[112:115], v[32:47]
    ds_read_b64_tr_b16 v[16:17], v3 offset:16896
    ds_read_b64_tr_b16 v[18:19], v3 offset:17152
    v_rcp_f32 v98, v98
    v_rcp_f32 v99, v99
    v_mul_f32 v68, v96, v68
    v_mul_f32 v69, v97, v69
    v_mul_f32 v70, v98, v70
    v_mul_f32 v71, v99, v71
    v_add_f32 v100, v100, v68
    v_fmac_f32 v101, v68, v68
    v_add_f32 v102, v102, v69
    v_mfma_f32_32x32x16_bf16 v[48:63], v[20:23], v[112:115], v[48:63]
    ds_read_b64_tr_b16 v[20:21], v3 offset:16960
    ds_read_b64_tr_b16 v[22:23], v3 offset:17216
    v_fmac_f32 v103, v69, v69
    v_add_f32 v100, v100, v70
    v_fmac_f32 v101, v70, v70
    v_add_f32 v102, v102, v71
    v_fmac_f32 v103, v71, v71
    v_mul_f32 v96, v72, v72
    v_mul_f32 v97, v73, v73
    v_mul_f32 v98, v74, v74
    v_mul_f32 v99, v75, v75
    v_fma_f32 v96, v96, v14, v15
    v_fma_f32 v97, v97, v14, v15
    v_fma_f32 v98, v98, v14, v15
    s_waitcnt lgkmcnt(6)
    v_mfma_f32_32x32x16_bf16 v[32:47], v[24:27], v[116:119], v[32:47]
    ds_read_b64_tr_b16 v[24:25], v4 offset:16896
    ds_read_b64_tr_b16 v[26:27], v4 offset:17152
    v_fma_f32 v99, v99, v14, v15
    v_mul_f32 v96, v96, v72
    v_mul_f32 v97, v97, v73
    v_mul_f32 v98, v98, v74
    v_mul_f32 v99, v99, v75
    v_exp_f32 v96, v96
    v_exp_f32 v97, v97
    v_exp_f32 v98, v98
    s_waitcnt lgkmcnt(6)
    v_mfma_f32_32x32x16_bf16 v[48:63], v[28:31], v[116:119], v[48:63]
    ds_read_b64_tr_b16 v[28:29], v4 offset:16960
    ds_read_b64_tr_b16 v[30:31], v4 offset:17216
    v_exp_f32 v99, v99
    v_fma_f32 v96, v96, v11, v11
    v_fma_f32 v97, v97, v11, v11
    v_fma_f32 v98, v98, v11, v11
    v_fma_f32 v99, v99, v11, v11
    v_rcp_f32 v96, v96
    v_rcp_f32 v97, v97
    v_rcp_f32 v98, v98
    s_waitcnt lgkmcnt(6)
    v_mfma_f32_32x32x16_bf16 v[32:47], v[16:19], v[120:123], v[32:47]
    v_rcp_f32 v99, v99
    v_mul_f32 v72, v96, v72
    v_mul_f32 v73, v97, v73
    v_mul_f32 v74, v98, v74
    v_mul_f32 v75, v99, v75
    v_add_f32 v100, v100, v72
    v_fmac_f32 v101, v72, v72
    v_add_f32 v102, v102, v73
    v_fmac_f32 v103, v73, v73
    v_add_f32 v100, v100, v74
    v_fmac_f32 v101, v74, v74
    s_waitcnt lgkmcnt(0)
    s_waitcnt vmcnt(8)
    s_barrier
    ds_read_b64_tr_b16 v[16:17], v1 offset:33792
    ds_read_b64_tr_b16 v[18:19], v1 offset:34048
    v_mfma_f32_32x32x16_bf16 v[48:63], v[20:23], v[120:123], v[48:63]
    ds_read_b64_tr_b16 v[20:21], v1 offset:33856
    ds_read_b64_tr_b16 v[22:23], v1 offset:34112
    s_mov_b32 s56, 1966080
    s_add_u32 m0, s33, 67584
    s_nop 0
    buffer_load_dwordx4 v5, s[12:15], s56 offen lds
    v_add_f32 v102, v102, v75
    v_fmac_f32 v103, v75, v75
    v_mul_f32 v96, v76, v76
    v_mul_f32 v97, v77, v77
    v_mul_f32 v98, v78, v78
    v_mul_f32 v99, v79, v79
    v_fma_f32 v96, v96, v14, v15
    v_fma_f32 v97, v97, v14, v15
    v_fma_f32 v98, v98, v14, v15
    v_fma_f32 v99, v99, v14, v15
    v_mul_f32 v96, v96, v76
    v_mfma_f32_32x32x16_bf16 v[32:47], v[24:27], v[124:127], v[32:47]
    ds_read_b64_tr_b16 v[24:25], v2 offset:33792
    ds_read_b64_tr_b16 v[26:27], v2 offset:34048
    s_mov_b32 s57, 1966208
    s_add_u32 m0, s33, 76032
    s_nop 0
    buffer_load_dwordx4 v5, s[12:15], s57 offen lds
    v_mul_f32 v97, v97, v77
    v_mul_f32 v98, v98, v78
    v_mul_f32 v99, v99, v79
    v_exp_f32 v96, v96
    v_exp_f32 v97, v97
    v_exp_f32 v98, v98
    v_exp_f32 v99, v99
    v_fma_f32 v96, v96, v11, v11
    v_mfma_f32_32x32x16_bf16 v[48:63], v[28:31], v[124:127], v[48:63]
    ds_read_b64_tr_b16 v[28:29], v2 offset:33856
    ds_read_b64_tr_b16 v[30:31], v2 offset:34112
    v_fma_f32 v97, v97, v11, v11
    v_fma_f32 v98, v98, v11, v11
    v_fma_f32 v99, v99, v11, v11
    v_rcp_f32 v96, v96
    v_rcp_f32 v97, v97
    v_rcp_f32 v98, v98
    v_rcp_f32 v99, v99
    s_waitcnt lgkmcnt(4)
    v_smfmac_f32_16x16x64_bf16 v[104:107], v[6:9], v[16:23], v10
    v_mfma_f32_32x32x16_bf16 v[32:47], v[16:19], v[128:131], v[32:47]
    ds_read_b64_tr_b16 v[16:17], v3 offset:33792
    ds_read_b64_tr_b16 v[18:19], v3 offset:34048
    s_mov_b32 s58, 2211840
    s_add_u32 m0, s33, 84480
    s_nop 0
    buffer_load_dwordx4 v5, s[12:15], s58 offen lds
    v_mul_f32 v76, v96, v76
    v_mul_f32 v77, v97, v77
    v_mul_f32 v78, v98, v78
    v_mul_f32 v79, v99, v79
    v_add_f32 v100, v100, v76
    v_fmac_f32 v101, v76, v76
    v_add_f32 v102, v102, v77
    v_fmac_f32 v103, v77, v77
    v_add_f32 v100, v100, v78
    v_fmac_f32 v101, v78, v78
    v_add_f32 v102, v102, v79
    v_fmac_f32 v103, v79, v79
    v_mfma_f32_32x32x16_bf16 v[48:63], v[20:23], v[128:131], v[48:63]
    ds_read_b64_tr_b16 v[20:21], v3 offset:33856
    ds_read_b64_tr_b16 v[22:23], v3 offset:34112
    v_mul_f32 v100, s36, v100
    v_mul_f32 v101, s36, v101
    v_mul_f32 v102, s36, v102
    v_mul_f32 v103, s36, v103
    v_mul_f32 v96, v80, v80
    v_mul_f32 v97, v81, v81
    v_mul_f32 v98, v82, v82
    v_mul_f32 v99, v83, v83
    v_fma_f32 v96, v96, v14, v15
    v_fma_f32 v97, v97, v14, v15
    v_fma_f32 v98, v98, v14, v15
    s_waitcnt lgkmcnt(6)
    v_mfma_f32_32x32x16_bf16 v[32:47], v[24:27], v[132:135], v[32:47]
    ds_read_b64_tr_b16 v[24:25], v4 offset:33792
    ds_read_b64_tr_b16 v[26:27], v4 offset:34048
    s_mov_b32 s59, 2211968
    s_add_u32 m0, s33, 92928
    s_nop 0
    buffer_load_dwordx4 v5, s[12:15], s59 offen lds
    v_fma_f32 v99, v99, v14, v15
    v_mul_f32 v96, v96, v80
    v_mul_f32 v97, v97, v81
    v_mul_f32 v98, v98, v82
    v_mul_f32 v99, v99, v83
    v_exp_f32 v96, v96
    v_exp_f32 v97, v97
    v_exp_f32 v98, v98
    v_exp_f32 v99, v99
    s_waitcnt lgkmcnt(6)
    v_mfma_f32_32x32x16_bf16 v[48:63], v[28:31], v[132:135], v[48:63]
    ds_read_b64_tr_b16 v[28:29], v4 offset:33856
    ds_read_b64_tr_b16 v[30:31], v4 offset:34112
    v_fma_f32 v96, v96, v11, v11
    v_fma_f32 v97, v97, v11, v11
    v_fma_f32 v98, v98, v11, v11
    v_fma_f32 v99, v99, v11, v11
    v_rcp_f32 v96, v96
    v_rcp_f32 v97, v97
    v_rcp_f32 v98, v98
    s_waitcnt lgkmcnt(6)
    v_mfma_f32_32x32x16_bf16 v[32:47], v[16:19], v[136:139], v[32:47]
    ds_read_b64_tr_b16 v[16:17], v1 offset:50688
    ds_read_b64_tr_b16 v[18:19], v1 offset:50944
    v_rcp_f32 v99, v99
    v_mul_f32 v80, v96, v80
    v_mul_f32 v81, v97, v81
    v_mul_f32 v82, v98, v82
    v_mul_f32 v83, v99, v83
    v_add_f32 v100, v100, v80
    v_fmac_f32 v101, v80, v80
    v_add_f32 v102, v102, v81
    v_fmac_f32 v103, v81, v81
    v_add_f32 v100, v100, v82
    v_fmac_f32 v101, v82, v82
    s_waitcnt lgkmcnt(6)
    v_mfma_f32_32x32x16_bf16 v[48:63], v[20:23], v[136:139], v[48:63]
    ds_read_b64_tr_b16 v[20:21], v1 offset:50752
    ds_read_b64_tr_b16 v[22:23], v1 offset:51008
    v_add_f32 v102, v102, v83
    v_fmac_f32 v103, v83, v83
    s_lshl_b32 s48, s29, 10
    v_lshlrev_b32 v108, 3, v0
    v_add_u32 v108, s48, v108
    v_mov_b32 v109, 2130706432
    v_cndmask_b32 v108, v108, v109, s[38:39]
    v_bfe_u32 v109, v10, 24, 1
    v_xor_b32 v109, 1, v109
    v_mul_f32 v96, v84, v84
    v_mul_f32 v97, v85, v85
    v_mul_f32 v98, v86, v86
    s_waitcnt lgkmcnt(6)
    v_mfma_f32_32x32x16_bf16 v[32:47], v[24:27], v[140:143], v[32:47]
    ds_read_b64_tr_b16 v[24:25], v2 offset:50688
    ds_read_b64_tr_b16 v[26:27], v2 offset:50944
    v_mul_f32 v99, v87, v87
    v_fma_f32 v96, v96, v14, v15
    v_fma_f32 v97, v97, v14, v15
    v_fma_f32 v98, v98, v14, v15
    v_fma_f32 v99, v99, v14, v15
    v_mul_f32 v96, v96, v84
    v_mul_f32 v97, v97, v85
    v_mul_f32 v98, v98, v86
    v_mul_f32 v99, v99, v87
    v_exp_f32 v96, v96
    v_exp_f32 v97, v97
    s_waitcnt lgkmcnt(6)
    v_mfma_f32_32x32x16_bf16 v[48:63], v[28:31], v[140:143], v[48:63]
    ds_read_b64_tr_b16 v[28:29], v2 offset:50752
    ds_read_b64_tr_b16 v[30:31], v2 offset:51008
    v_exp_f32 v98, v98
    v_exp_f32 v99, v99
    v_fma_f32 v96, v96, v11, v11
    v_fma_f32 v97, v97, v11, v11
    v_fma_f32 v98, v98, v11, v11
    v_fma_f32 v99, v99, v11, v11
    v_rcp_f32 v96, v96
    s_waitcnt lgkmcnt(4)
    v_smfmac_f32_16x16x64_bf16 v[104:107], v[6:9], v[16:23], v10
    v_mfma_f32_32x32x16_bf16 v[32:47], v[16:19], v[144:147], v[32:47]
    ds_read_b64_tr_b16 v[16:17], v3 offset:50688
    ds_read_b64_tr_b16 v[18:19], v3 offset:50944
    v_rcp_f32 v97, v97
    v_rcp_f32 v98, v98
    v_rcp_f32 v99, v99
    v_mul_f32 v84, v96, v84
    v_mul_f32 v85, v97, v85
    v_mul_f32 v86, v98, v86
    v_mul_f32 v87, v99, v87
    v_add_f32 v100, v100, v84
    v_fmac_f32 v101, v84, v84
    v_mfma_f32_32x32x16_bf16 v[48:63], v[20:23], v[144:147], v[48:63]
    ds_read_b64_tr_b16 v[20:21], v3 offset:50752
    ds_read_b64_tr_b16 v[22:23], v3 offset:51008
    v_add_f32 v102, v102, v85
    v_fmac_f32 v103, v85, v85
    v_add_f32 v100, v100, v86
    v_fmac_f32 v101, v86, v86
    v_add_f32 v102, v102, v87
    v_fmac_f32 v103, v87, v87
    v_mul_f32 v96, v88, v88
    v_mul_f32 v97, v89, v89
    v_mul_f32 v98, v90, v90
    v_mul_f32 v99, v91, v91
    v_fma_f32 v96, v96, v14, v15
    s_waitcnt lgkmcnt(6)
    v_mfma_f32_32x32x16_bf16 v[32:47], v[24:27], v[148:151], v[32:47]
    ds_read_b64_tr_b16 v[24:25], v4 offset:50688
    ds_read_b64_tr_b16 v[26:27], v4 offset:50944
    v_fma_f32 v97, v97, v14, v15
    v_fma_f32 v98, v98, v14, v15
    v_fma_f32 v99, v99, v14, v15
    v_mul_f32 v96, v96, v88
    v_mul_f32 v97, v97, v89
    v_mul_f32 v98, v98, v90
    v_mul_f32 v99, v99, v91
    v_exp_f32 v96, v96
    v_exp_f32 v97, v97
    v_exp_f32 v98, v98
    s_waitcnt lgkmcnt(6)
    v_mfma_f32_32x32x16_bf16 v[48:63], v[28:31], v[148:151], v[48:63]
    ds_read_b64_tr_b16 v[28:29], v4 offset:50752
    ds_read_b64_tr_b16 v[30:31], v4 offset:51008
    v_exp_f32 v99, v99
    v_fma_f32 v96, v96, v11, v11
    v_fma_f32 v97, v97, v11, v11
    v_fma_f32 v98, v98, v11, v11
    v_fma_f32 v99, v99, v11, v11
    v_rcp_f32 v96, v96
    v_rcp_f32 v97, v97
    s_waitcnt lgkmcnt(6)
    v_mfma_f32_32x32x16_bf16 v[32:47], v[16:19], v[152:155], v[32:47]
    v_rcp_f32 v98, v98
    v_rcp_f32 v99, v99
    v_mul_f32 v88, v96, v88
    v_mul_f32 v89, v97, v89
    v_mul_f32 v90, v98, v90
    v_mul_f32 v91, v99, v91
    v_add_f32 v100, v100, v88
    v_fmac_f32 v101, v88, v88
    v_add_f32 v102, v102, v89
    v_fmac_f32 v103, v89, v89
    v_add_u32 v1, -67584, v1
    v_add_u32 v2, -67584, v2
    v_add_u32 v3, -67584, v3
    v_add_u32 v4, -67584, v4
    s_waitcnt lgkmcnt(0)
    s_waitcnt vmcnt(8)
    s_barrier
    ds_read_b64_tr_b16 v[16:17], v1 offset:0
    ds_read_b64_tr_b16 v[18:19], v1 offset:256
    v_mfma_f32_32x32x16_bf16 v[48:63], v[20:23], v[152:155], v[48:63]
    ds_read_b64_tr_b16 v[20:21], v1 offset:64
    ds_read_b64_tr_b16 v[22:23], v1 offset:320
    v_add_f32 v100, v100, v90
    v_fmac_f32 v101, v90, v90
    v_add_f32 v102, v102, v91
    v_fmac_f32 v103, v91, v91
    v_mul_f32 v96, v92, v92
    v_mul_f32 v97, v93, v93
    v_mul_f32 v98, v94, v94
    v_mul_f32 v99, v95, v95
    v_fma_f32 v96, v96, v14, v15
    v_fma_f32 v97, v97, v14, v15
    v_fma_f32 v98, v98, v14, v15
    v_fma_f32 v99, v99, v14, v15
    v_mfma_f32_32x32x16_bf16 v[32:47], v[24:27], v[156:159], v[32:47]
    ds_read_b64_tr_b16 v[24:25], v2 offset:0
    ds_read_b64_tr_b16 v[26:27], v2 offset:256
    v_mul_f32 v96, v96, v92
    v_mul_f32 v97, v97, v93
    v_mul_f32 v98, v98, v94
    v_mul_f32 v99, v99, v95
    v_exp_f32 v96, v96
    v_exp_f32 v97, v97
    v_exp_f32 v98, v98
    v_exp_f32 v99, v99
    v_mfma_f32_32x32x16_bf16 v[48:63], v[28:31], v[156:159], v[48:63]
    ds_read_b64_tr_b16 v[28:29], v2 offset:64
    ds_read_b64_tr_b16 v[30:31], v2 offset:320
    v_fma_f32 v96, v96, v11, v11
    v_fma_f32 v97, v97, v11, v11
    v_fma_f32 v98, v98, v11, v11
    v_fma_f32 v99, v99, v11, v11
    v_rcp_f32 v96, v96
    v_rcp_f32 v97, v97
    v_rcp_f32 v98, v98
    v_rcp_f32 v99, v99
    s_waitcnt lgkmcnt(4)
    v_smfmac_f32_16x16x64_bf16 v[104:107], v[6:9], v[16:23], v10
    v_mfma_f32_32x32x16_bf16 v[32:47], v[16:19], v[160:163], v[32:47]
    ds_read_b64_tr_b16 v[16:17], v3 offset:0
    ds_read_b64_tr_b16 v[18:19], v3 offset:256
    v_mul_f32 v92, v96, v92
    v_mul_f32 v93, v97, v93
    v_mul_f32 v94, v98, v94
    v_mul_f32 v95, v99, v95
    v_add_f32 v100, v100, v92
    v_fmac_f32 v101, v92, v92
    v_add_f32 v102, v102, v93
    v_fmac_f32 v103, v93, v93
    v_add_f32 v100, v100, v94
    v_fmac_f32 v101, v94, v94
    v_lshlrev_b32 v152, 4, v0
    v_add_u32 v152, 135168, v152
    v_mfma_f32_32x32x16_bf16 v[48:63], v[20:23], v[160:163], v[48:63]
    ds_read_b64_tr_b16 v[20:21], v3 offset:64
    ds_read_b64_tr_b16 v[22:23], v3 offset:320
    v_add_f32 v102, v102, v95
    v_fmac_f32 v103, v95, v95
    v_add_f32 v100, v100, v102
    v_add_f32 v101, v101, v103
    v_mov_b32 v102, v100
    v_mov_b32 v103, v101
    s_nop 0
    v_permlane32_swap_b32 v100, v102
    v_permlane32_swap_b32 v101, v103
    v_add_f32 v100, v100, v102
    v_add_f32 v101, v101, v103
    v_bfi_b32 v101, 1, v109, v101
    buffer_store_dwordx2 v[100:101], v108, s[20:23], s37 offen sc1
    v_lshlrev_b32 v154, 4, v0
    v_mul_f32 v155, s35, v15
    s_setprio 0
    s_waitcnt lgkmcnt(6)
    v_mfma_f32_32x32x16_bf16 v[32:47], v[24:27], v[164:167], v[32:47]
    ds_read_b64_tr_b16 v[24:25], v4 offset:0
    ds_read_b64_tr_b16 v[26:27], v4 offset:256
    s_waitcnt lgkmcnt(6)
    v_mfma_f32_32x32x16_bf16 v[48:63], v[28:31], v[164:167], v[48:63]
    ds_read_b64_tr_b16 v[28:29], v4 offset:64
    ds_read_b64_tr_b16 v[30:31], v4 offset:320
    s_waitcnt lgkmcnt(6)
    v_mfma_f32_32x32x16_bf16 v[32:47], v[16:19], v[168:171], v[32:47]
    ds_read_b64_tr_b16 v[16:17], v1 offset:16896
    ds_read_b64_tr_b16 v[18:19], v1 offset:17152
    s_waitcnt lgkmcnt(6)
    v_mfma_f32_32x32x16_bf16 v[48:63], v[20:23], v[168:171], v[48:63]
    ds_read_b64_tr_b16 v[20:21], v1 offset:16960
    ds_read_b64_tr_b16 v[22:23], v1 offset:17216
    s_waitcnt lgkmcnt(6)
    v_mfma_f32_32x32x16_bf16 v[32:47], v[24:27], v[172:175], v[32:47]
    ds_read_b64_tr_b16 v[24:25], v2 offset:16896
    ds_read_b64_tr_b16 v[26:27], v2 offset:17152
    s_waitcnt lgkmcnt(6)
    v_mfma_f32_32x32x16_bf16 v[48:63], v[28:31], v[172:175], v[48:63]
    ds_read_b64_tr_b16 v[28:29], v2 offset:16960
    ds_read_b64_tr_b16 v[30:31], v2 offset:17216
    s_waitcnt lgkmcnt(4)
    v_smfmac_f32_16x16x64_bf16 v[104:107], v[6:9], v[16:23], v10
    v_mfma_f32_32x32x16_bf16 v[32:47], v[16:19], v[176:179], v[32:47]
    ds_read_b64_tr_b16 v[16:17], v3 offset:16896
    ds_read_b64_tr_b16 v[18:19], v3 offset:17152
    v_mfma_f32_32x32x16_bf16 v[48:63], v[20:23], v[176:179], v[48:63]
    ds_read_b64_tr_b16 v[20:21], v3 offset:16960
    ds_read_b64_tr_b16 v[22:23], v3 offset:17216
    s_waitcnt lgkmcnt(6)
    v_mfma_f32_32x32x16_bf16 v[32:47], v[24:27], v[180:183], v[32:47]
    ds_read_b64_tr_b16 v[24:25], v4 offset:16896
    ds_read_b64_tr_b16 v[26:27], v4 offset:17152
    s_waitcnt lgkmcnt(6)
    v_mfma_f32_32x32x16_bf16 v[48:63], v[28:31], v[180:183], v[48:63]
    ds_read_b64_tr_b16 v[28:29], v4 offset:16960
    ds_read_b64_tr_b16 v[30:31], v4 offset:17216
    s_waitcnt lgkmcnt(6)
    v_mfma_f32_32x32x16_bf16 v[32:47], v[16:19], v[184:187], v[32:47]
    s_waitcnt lgkmcnt(0)
    s_waitcnt vmcnt(5)
    s_barrier
    ds_read_b64_tr_b16 v[16:17], v1 offset:33792
    ds_read_b64_tr_b16 v[18:19], v1 offset:34048
    v_mfma_f32_32x32x16_bf16 v[48:63], v[20:23], v[184:187], v[48:63]
    ds_read_b64_tr_b16 v[20:21], v1 offset:33856
    ds_read_b64_tr_b16 v[22:23], v1 offset:34112
    v_mfma_f32_32x32x16_bf16 v[32:47], v[24:27], v[188:191], v[32:47]
    ds_read_b64_tr_b16 v[24:25], v2 offset:33792
    ds_read_b64_tr_b16 v[26:27], v2 offset:34048
    v_mfma_f32_32x32x16_bf16 v[48:63], v[28:31], v[188:191], v[48:63]
    ds_read_b64_tr_b16 v[28:29], v2 offset:33856
    ds_read_b64_tr_b16 v[30:31], v2 offset:34112
    s_waitcnt lgkmcnt(4)
    v_smfmac_f32_16x16x64_bf16 v[104:107], v[6:9], v[16:23], v10
    v_mfma_f32_32x32x16_bf16 v[32:47], v[16:19], v[192:195], v[32:47]
    ds_read_b64_tr_b16 v[16:17], v3 offset:33792
    ds_read_b64_tr_b16 v[18:19], v3 offset:34048
    v_lshrrev_b32 v111, 5, v0
    v_mul_u32_u24 v111, 6912, v111
    v_lshl_add_u32 v110, v0, 3, v111
    v_mfma_f32_32x32x16_bf16 v[48:63], v[20:23], v[192:195], v[48:63]
    ds_read_b64_tr_b16 v[20:21], v3 offset:33856
    ds_read_b64_tr_b16 v[22:23], v3 offset:34112
    buffer_load_dwordx2 v[128:129], v110, s[20:23], s37 offen offset:0 sc1
    buffer_load_dwordx2 v[130:131], v110, s[20:23], s37 offen offset:1024 sc1
    buffer_load_dwordx2 v[132:133], v110, s[20:23], s37 offen offset:2048 sc1
    buffer_load_dwordx2 v[134:135], v110, s[20:23], s37 offen offset:3072 sc1
    buffer_load_dwordx2 v[136:137], v110, s[20:23], s43 offen offset:0 sc1
    buffer_load_dwordx2 v[138:139], v110, s[20:23], s43 offen offset:1024 sc1
    buffer_load_dwordx2 v[140:141], v110, s[20:23], s43 offen offset:2048 sc1
    s_waitcnt lgkmcnt(6)
    v_mfma_f32_32x32x16_bf16 v[32:47], v[24:27], v[196:199], v[32:47]
    ds_read_b64_tr_b16 v[24:25], v4 offset:33792
    ds_read_b64_tr_b16 v[26:27], v4 offset:34048
    s_waitcnt lgkmcnt(6)
    v_mfma_f32_32x32x16_bf16 v[48:63], v[28:31], v[196:199], v[48:63]
    ds_read_b64_tr_b16 v[28:29], v4 offset:33856
    ds_read_b64_tr_b16 v[30:31], v4 offset:34112
    s_waitcnt lgkmcnt(6)
    v_mfma_f32_32x32x16_bf16 v[32:47], v[16:19], v[200:203], v[32:47]
    ds_read_b64_tr_b16 v[16:17], v1 offset:50688
    ds_read_b64_tr_b16 v[18:19], v1 offset:50944
    s_waitcnt lgkmcnt(6)
    v_mfma_f32_32x32x16_bf16 v[48:63], v[20:23], v[200:203], v[48:63]
    ds_read_b64_tr_b16 v[20:21], v1 offset:50752
    ds_read_b64_tr_b16 v[22:23], v1 offset:51008
    s_waitcnt lgkmcnt(6)
    v_mfma_f32_32x32x16_bf16 v[32:47], v[24:27], v[204:207], v[32:47]
    ds_read_b64_tr_b16 v[24:25], v2 offset:50688
    ds_read_b64_tr_b16 v[26:27], v2 offset:50944
    s_waitcnt lgkmcnt(6)
    v_mfma_f32_32x32x16_bf16 v[48:63], v[28:31], v[204:207], v[48:63]
    ds_read_b64_tr_b16 v[28:29], v2 offset:50752
    ds_read_b64_tr_b16 v[30:31], v2 offset:51008
    s_waitcnt lgkmcnt(4)
    v_smfmac_f32_16x16x64_bf16 v[104:107], v[6:9], v[16:23], v10
    v_mfma_f32_32x32x16_bf16 v[32:47], v[16:19], v[208:211], v[32:47]
    ds_read_b64_tr_b16 v[16:17], v3 offset:50688
    ds_read_b64_tr_b16 v[18:19], v3 offset:50944
    v_mfma_f32_32x32x16_bf16 v[48:63], v[20:23], v[208:211], v[48:63]
    ds_read_b64_tr_b16 v[20:21], v3 offset:50752
    ds_read_b64_tr_b16 v[22:23], v3 offset:51008
    s_waitcnt lgkmcnt(6)
    v_mfma_f32_32x32x16_bf16 v[32:47], v[24:27], v[212:215], v[32:47]
    ds_read_b64_tr_b16 v[24:25], v4 offset:50688
    ds_read_b64_tr_b16 v[26:27], v4 offset:50944
    s_waitcnt lgkmcnt(6)
    v_mfma_f32_32x32x16_bf16 v[48:63], v[28:31], v[212:215], v[48:63]
    ds_read_b64_tr_b16 v[28:29], v4 offset:50752
    ds_read_b64_tr_b16 v[30:31], v4 offset:51008
    s_waitcnt vmcnt(6)
    v_lshlrev_b32 v96, 31, v129
    s_waitcnt vmcnt(5)
    v_alignbit_b32 v96, v131, v96, 1
    s_waitcnt vmcnt(4)
    v_alignbit_b32 v96, v133, v96, 1
    s_waitcnt vmcnt(3)
    v_alignbit_b32 v96, v135, v96, 1
    s_waitcnt vmcnt(2)
    v_alignbit_b32 v96, v137, v96, 1
    s_waitcnt vmcnt(1)
    v_alignbit_b32 v96, v139, v96, 1
    s_waitcnt vmcnt(0)
    v_alignbit_b32 v96, v141, v96, 1
    v_xor_b32 v96, v96, v10
    v_lshrrev_b32 v96, 25, v96
    v_cmp_ne_u32 vcc, 0x7f, v96
    s_cbranch_vccnz K1_0_poll
K1_0_go:
    s_waitcnt lgkmcnt(6)
    v_mfma_f32_32x32x16_bf16 v[32:47], v[16:19], v[216:219], v[32:47]
    v_add_f32 v128, v128, v130
    v_add_f32 v129, v129, v131
    v_add_f32 v132, v132, v134
    v_add_f32 v133, v133, v135
    v_add_f32 v136, v136, v138
    v_add_f32 v137, v137, v139
    v_add_u32 v1, 67584, v1
    v_add_u32 v2, 67584, v2
    v_add_u32 v3, 67584, v3
    v_add_u32 v4, 67584, v4
    s_waitcnt lgkmcnt(0)
    s_barrier
    ds_read_b64_tr_b16 v[16:17], v1 offset:0
    ds_read_b64_tr_b16 v[18:19], v1 offset:256
    v_mfma_f32_32x32x16_bf16 v[48:63], v[20:23], v[216:219], v[48:63]
    ds_read_b64_tr_b16 v[20:21], v1 offset:64
    ds_read_b64_tr_b16 v[22:23], v1 offset:320
    v_add_f32 v128, v128, v140
    v_add_f32 v129, v129, v141
    v_add_f32 v132, v132, v136
    v_add_f32 v133, v133, v137
    v_add_f32 v128, v128, v132
    v_mfma_f32_32x32x16_bf16 v[32:47], v[24:27], v[220:223], v[32:47]
    ds_read_b64_tr_b16 v[24:25], v2 offset:0
    ds_read_b64_tr_b16 v[26:27], v2 offset:256
    v_add_f32 v129, v129, v133
    v_mov_b32 v130, v128
    v_mov_b32 v131, v129
    s_nop 0
    v_permlane32_swap_b32 v128, v130
    v_permlane32_swap_b32 v129, v131
    v_add_f32 v128, v128, v130
    v_mfma_f32_32x32x16_bf16 v[48:63], v[28:31], v[220:223], v[48:63]
    ds_read_b64_tr_b16 v[28:29], v2 offset:64
    ds_read_b64_tr_b16 v[30:31], v2 offset:320
    v_add_f32 v129, v129, v131
    v_mul_f32 v128, 0xba97b426, v128
    v_mul_f32 v129, 0x3a97b426, v129
    v_fma_f32 v129, -v128, v128, v129
    v_max_f32 v129, 0, v129
    s_waitcnt lgkmcnt(4)
    v_smfmac_f32_16x16x64_bf16 v[104:107], v[6:9], v[16:23], v10
    v_mfma_f32_32x32x16_bf16 v[32:47], v[16:19], v[224:227], v[32:47]
    ds_read_b64_tr_b16 v[16:17], v3 offset:0
    ds_read_b64_tr_b16 v[18:19], v3 offset:256
    v_add_f32 v129, 0x3727c5ac, v129
    v_rsq_f32 v130, v129
    v_cndmask_b32 v134, 0, 1, s[52:53]
    v_mul_f32 v131, v128, v130
    v_mfma_f32_32x32x16_bf16 v[48:63], v[20:23], v[224:227], v[48:63]
    ds_read_b64_tr_b16 v[20:21], v3 offset:64
    ds_read_b64_tr_b16 v[22:23], v3 offset:320
    v_cndmask_b32 v130, v130, 1.0, s[52:53]
    v_cndmask_b32 v131, v131, 0, s[52:53]
    v_cndmask_b32 v132, v130, 1.0, s[44:45]
    v_cndmask_b32 v133, v131, 0, s[44:45]
    v_add_u32 v135, s42, v154
    v_fma_f32 v80, v80, v130, v131
    s_waitcnt lgkmcnt(6)
    v_mfma_f32_32x32x16_bf16 v[32:47], v[24:27], v[228:231], v[32:47]
    ds_read_b64_tr_b16 v[24:25], v4 offset:0
    ds_read_b64_tr_b16 v[26:27], v4 offset:256
    v_fma_f32 v81, v81, v130, v131
    v_fma_f32 v82, v82, v130, v131
    v_fma_f32 v83, v83, v130, v131
    v_fma_f32 v84, v84, v130, v131
    v_fma_f32 v85, v85, v130, v131
    s_waitcnt lgkmcnt(6)
    v_mfma_f32_32x32x16_bf16 v[48:63], v[28:31], v[228:231], v[48:63]
    ds_read_b64_tr_b16 v[28:29], v4 offset:64
    ds_read_b64_tr_b16 v[30:31], v4 offset:320
    v_fma_f32 v86, v86, v130, v131
    v_fma_f32 v87, v87, v130, v131
    v_cvt_pk_bf16_f32 v184, v80, v81
    v_cvt_pk_bf16_f32 v185, v82, v83
    v_cvt_pk_bf16_f32 v186, v84, v85
    v_cvt_pk_bf16_f32 v187, v86, v87
    s_waitcnt lgkmcnt(6)
    v_mfma_f32_32x32x16_bf16 v[32:47], v[16:19], v[232:235], v[32:47]
    ds_read_b64_tr_b16 v[16:17], v1 offset:16896
    ds_read_b64_tr_b16 v[18:19], v1 offset:17152
    buffer_store_dwordx4 v[184:187], v135, s[20:23], s40 offen offset:2048 sc1
    v_fma_f32 v88, v88, v130, v131
    v_fma_f32 v89, v89, v130, v131
    v_fma_f32 v90, v90, v130, v131
    v_fma_f32 v91, v91, v130, v131
    v_fma_f32 v92, v92, v130, v131
    s_waitcnt lgkmcnt(6)
    v_mfma_f32_32x32x16_bf16 v[48:63], v[20:23], v[232:235], v[48:63]
    ds_read_b64_tr_b16 v[20:21], v1 offset:16960
    ds_read_b64_tr_b16 v[22:23], v1 offset:17216
    v_fma_f32 v93, v93, v130, v131
    v_fma_f32 v94, v94, v130, v131
    v_fma_f32 v95, v95, v130, v131
    v_cvt_pk_bf16_f32 v188, v88, v89
    v_cvt_pk_bf16_f32 v189, v90, v91
    s_waitcnt lgkmcnt(6)
    v_mfma_f32_32x32x16_bf16 v[32:47], v[24:27], v[236:239], v[32:47]
    ds_read_b64_tr_b16 v[24:25], v2 offset:16896
    ds_read_b64_tr_b16 v[26:27], v2 offset:17152
    v_cvt_pk_bf16_f32 v190, v92, v93
    v_cvt_pk_bf16_f32 v191, v94, v95
    buffer_store_dwordx4 v[188:191], v135, s[20:23], s40 offen offset:3072 sc1
    v_fma_f32 v64, v64, v132, v133
    v_fma_f32 v65, v65, v132, v133
    v_fma_f32 v66, v66, v132, v133
    s_waitcnt lgkmcnt(6)
    v_mfma_f32_32x32x16_bf16 v[48:63], v[28:31], v[236:239], v[48:63]
    ds_read_b64_tr_b16 v[28:29], v2 offset:16960
    ds_read_b64_tr_b16 v[30:31], v2 offset:17216
    v_fma_f32 v67, v67, v132, v133
    v_fma_f32 v68, v68, v132, v133
    v_fma_f32 v69, v69, v132, v133
    v_fma_f32 v70, v70, v132, v133
    v_fma_f32 v71, v71, v132, v133
    v_cvt_pk_bf16_f32 v176, v64, v65
    s_waitcnt lgkmcnt(4)
    v_smfmac_f32_16x16x64_bf16 v[104:107], v[6:9], v[16:23], v10
    v_mfma_f32_32x32x16_bf16 v[32:47], v[16:19], v[240:243], v[32:47]
    ds_read_b64_tr_b16 v[16:17], v3 offset:16896
    ds_read_b64_tr_b16 v[18:19], v3 offset:17152
    v_cvt_pk_bf16_f32 v177, v66, v67
    v_cvt_pk_bf16_f32 v178, v68, v69
    v_cvt_pk_bf16_f32 v179, v70, v71
    buffer_store_dwordx4 v[176:179], v135, s[20:23], s40 offen offset:0 sc1
    v_fma_f32 v72, v72, v132, v133
    v_fma_f32 v73, v73, v132, v133
    v_mfma_f32_32x32x16_bf16 v[48:63], v[20:23], v[240:243], v[48:63]
    ds_read_b64_tr_b16 v[20:21], v3 offset:16960
    ds_read_b64_tr_b16 v[22:23], v3 offset:17216
    v_fma_f32 v74, v74, v132, v133
    v_fma_f32 v75, v75, v132, v133
    v_fma_f32 v76, v76, v132, v133
    v_fma_f32 v77, v77, v132, v133
    v_fma_f32 v78, v78, v132, v133
    s_waitcnt lgkmcnt(6)
    v_mfma_f32_32x32x16_bf16 v[32:47], v[24:27], v[244:247], v[32:47]
    ds_read_b64_tr_b16 v[24:25], v4 offset:16896
    ds_read_b64_tr_b16 v[26:27], v4 offset:17152
    v_fma_f32 v79, v79, v132, v133
    v_cvt_pk_bf16_f32 v180, v72, v73
    v_cvt_pk_bf16_f32 v181, v74, v75
    v_cvt_pk_bf16_f32 v182, v76, v77
    v_cvt_pk_bf16_f32 v183, v78, v79
    buffer_store_dwordx4 v[180:183], v135, s[20:23], s40 offen offset:1024 sc1
    s_waitcnt lgkmcnt(6)
    v_mfma_f32_32x32x16_bf16 v[48:63], v[28:31], v[244:247], v[48:63]
    ds_read_b64_tr_b16 v[28:29], v4 offset:16960
    ds_read_b64_tr_b16 v[30:31], v4 offset:17216
    s_lshl_b32 s47, s31, 2
    v_add_u32 v153, s47, v152
    v_add_f32 v104, v104, v105
    ds_write_b32 v153, v104 offset:4096
    s_waitcnt lgkmcnt(7)
    v_mfma_f32_32x32x16_bf16 v[32:47], v[16:19], v[248:251], v[32:47]
    s_waitcnt lgkmcnt(0)
    s_barrier
    ds_read_b128 v[144:147], v152 offset:4096
    v_mfma_f32_32x32x16_bf16 v[48:63], v[20:23], v[248:251], v[48:63]
    v_mfma_f32_32x32x16_bf16 v[32:47], v[24:27], v[252:255], v[32:47]
    s_waitcnt lgkmcnt(0)
    v_add_f32 v144, v144, v145
    v_add_f32 v146, v146, v147
    v_add_f32 v144, v144, v146
    v_cvt_pk_bf16_f32 v145, v144, v144
    v_and_b32 v145, s55, v145
    v_sub_f32 v146, v144, v145
    v_cvt_pk_bf16_f32 v148, v144, v146
    v_mfma_f32_32x32x16_bf16 v[48:63], v[28:31], v[252:255], v[48:63]
    v_and_b32 v145, s55, v148
    v_sub_f32 v146, v146, v145
    v_cvt_pk_bf16_f32 v150, v146, v144
    s_nop 1
    v_permlane32_swap_b32 v148, v150
    v_mov_b32 v149, v148
    v_mov_b32 v151, v150
    s_nop 0
    v_mfma_f32_32x32x8bf16_1k v[32:47], v[148:149], v[12:13], v[32:47]
    v_mfma_f32_32x32x8bf16_1k v[48:63], v[150:151], v[12:13], v[48:63]
    s_nop 10
    v_mul_f32 v32, v155, v32
    v_mul_f32 v33, v155, v33
    v_mul_f32 v34, v155, v34
    v_mul_f32 v35, v155, v35
    v_mul_f32 v36, v155, v36
    v_mul_f32 v37, v155, v37
    v_mul_f32 v38, v155, v38
    v_mul_f32 v39, v155, v39
    v_cvt_pk_bf16_f32 v160, v32, v33
    v_cvt_pk_bf16_f32 v161, v34, v35
    v_cvt_pk_bf16_f32 v162, v36, v37
    v_cvt_pk_bf16_f32 v163, v38, v39
    buffer_store_dwordx4 v[160:163], v154, s[20:23], s41 offen offset:0 sc1
    v_mul_f32 v40, v155, v40
    v_mul_f32 v41, v155, v41
    v_mul_f32 v42, v155, v42
    v_mul_f32 v43, v155, v43
    v_mul_f32 v44, v155, v44
    v_mul_f32 v45, v155, v45
    v_mul_f32 v46, v155, v46
    v_mul_f32 v47, v155, v47
    v_cvt_pk_bf16_f32 v164, v40, v41
    v_cvt_pk_bf16_f32 v165, v42, v43
    v_cvt_pk_bf16_f32 v166, v44, v45
    v_cvt_pk_bf16_f32 v167, v46, v47
    buffer_store_dwordx4 v[164:167], v154, s[20:23], s41 offen offset:1024 sc1
    v_mul_f32 v48, v155, v48
    v_mul_f32 v49, v155, v49
    v_mul_f32 v50, v155, v50
    v_mul_f32 v51, v155, v51
    v_mul_f32 v52, v155, v52
    v_mul_f32 v53, v155, v53
    v_mul_f32 v54, v155, v54
    v_mul_f32 v55, v155, v55
    v_cvt_pk_bf16_f32 v168, v48, v49
    v_cvt_pk_bf16_f32 v169, v50, v51
    v_cvt_pk_bf16_f32 v170, v52, v53
    v_cvt_pk_bf16_f32 v171, v54, v55
    buffer_store_dwordx4 v[168:171], v154, s[20:23], s41 offen offset:2048 sc1
    v_mul_f32 v56, v155, v56
    v_mul_f32 v57, v155, v57
    v_mul_f32 v58, v155, v58
    v_mul_f32 v59, v155, v59
    v_mul_f32 v60, v155, v60
    v_mul_f32 v61, v155, v61
    v_mul_f32 v62, v155, v62
    v_mul_f32 v63, v155, v63
    v_cvt_pk_bf16_f32 v172, v56, v57
    v_cvt_pk_bf16_f32 v173, v58, v59
    v_cvt_pk_bf16_f32 v174, v60, v61
    v_cvt_pk_bf16_f32 v175, v62, v63
    buffer_store_dwordx4 v[172:175], v154, s[20:23], s41 offen offset:3072 sc1
    s_lshl_b32 s47, s28, 2
    s_add_u32 s47, s47, s31
    s_lshl_b32 s48, s29, 6
    s_add_u32 s47, s47, s48
    s_add_u32 s47, s47, 14942208
    s_mov_b64 exec, 1
    buffer_store_byte v134, v135, s[20:23], s47 offen
    s_endpgm
K1_0_poll:
    s_cmp_ge_u32 s51, 64
    s_cbranch_scc1 K1_0_tmo
    s_add_u32 s51, s51, 1
    buffer_load_dwordx2 v[128:129], v110, s[20:23], s37 offen offset:0 sc1
    buffer_load_dwordx2 v[130:131], v110, s[20:23], s37 offen offset:1024 sc1
    buffer_load_dwordx2 v[132:133], v110, s[20:23], s37 offen offset:2048 sc1
    buffer_load_dwordx2 v[134:135], v110, s[20:23], s37 offen offset:3072 sc1
    buffer_load_dwordx2 v[136:137], v110, s[20:23], s43 offen offset:0 sc1
    buffer_load_dwordx2 v[138:139], v110, s[20:23], s43 offen offset:1024 sc1
    buffer_load_dwordx2 v[140:141], v110, s[20:23], s43 offen offset:2048 sc1
    s_waitcnt vmcnt(0)
    v_lshlrev_b32 v96, 31, v129
    v_alignbit_b32 v96, v131, v96, 1
    v_alignbit_b32 v96, v133, v96, 1
    v_alignbit_b32 v96, v135, v96, 1
    v_alignbit_b32 v96, v137, v96, 1
    v_alignbit_b32 v96, v139, v96, 1
    v_alignbit_b32 v96, v141, v96, 1
    v_xor_b32 v96, v96, v10
    v_lshrrev_b32 v96, 25, v96
    v_cmp_ne_u32 vcc, 0x7f, v96
    s_cbranch_vccnz K1_0_poll
    s_branch K1_0_go
K1_0_tmo:
    s_mov_b64 s[52:53], -1
    s_branch K1_0_go
K1_1:
    s_mov_b32 s60, 128
    s_add_u32 m0, s34, 33792
    s_nop 0
    buffer_load_dwordx4 v36, s[8:11], s60 offen lds
    s_mov_b32 s61, 128
    s_add_u32 m0, s34, 34816
    s_nop 0
    buffer_load_dwordx4 v37, s[8:11], s61 offen lds
    s_mov_b32 s62, 221184
    s_add_u32 m0, s33, 50688
    s_nop 0
    buffer_load_dwordx4 v38, s[16:19], s62 offen lds
    s_mov_b32 s63, 221184
    s_add_u32 m0, s33, 59136
    s_nop 0
    buffer_load_dwordx4 v39, s[16:19], s63 offen lds
    s_mov_b32 s38, 0
    s_mov_b32 s39, -1
    s_mov_b32 s55, 0xffff0000
    v_bfe_u32 v50, v0, 3, 1
    v_mul_u32_u24 v1, 1088, v50
    v_and_b32 v50, 4, v0
    v_lshl_add_u32 v1, v50, 5, v1
    v_and_b32 v50, 33, v0
    v_lshl_add_u32 v1, v50, 4, v1
    v_and_b32 v50, 16, v0
    v_lshl_add_u32 v1, v50, 1, v1
    v_and_b32 v50, 2, v0
    v_lshl_add_u32 v1, v50, 2, v1
    s_xor_b32 s47, s31, 3
    s_mul_i32 s47, s47, 2112
    s_add_u32 s47, s47, 8448
    v_add_u32 v4, s47, v1
    s_xor_b32 s47, s31, 2
    s_mul_i32 s47, s47, 2112
    s_add_u32 s47, s47, 8448
    v_add_u32 v3, s47, v1
    s_xor_b32 s47, s31, 1
    s_mul_i32 s47, s47, 2112
    s_add_u32 s47, s47, 8448
    v_add_u32 v2, s47, v1
    s_xor_b32 s47, s31, 0
    s_mul_i32 s47, s47, 2112
    s_add_u32 s47, s47, 8448
    v_add_u32 v1, s47, v1
    v_and_b32 v50, 31, v0
    v_bfe_u32 v51, v0, 1, 3
    v_lshrrev_b32 v52, 5, v0
    v_xor_b32 v51, v51, v52
    v_lshlrev_b32 v51, 4, v51
    v_lshl_add_u32 v32, v50, 7, v51
    s_mul_i32 s47, s31, 4128
    v_xor_b32 v32, s47, v32
    v_xor_b32 v33, 32, v32
    v_xor_b32 v34, 64, v32
    v_xor_b32 v35, 96, v32
    v_mov_b32 v50, 0x3f803f80
    s_mov_b32 s44, 0x000f000f
    s_mov_b32 s45, 0x0f000f00
    v_cndmask_b32 v6, 0, v50, s[44:45]
    v_cndmask_b32 v7, 0, v50, s[44:45]
    s_lshl_b64 s[44:45], s[44:45], 4
    v_cndmask_b32 v8, 0, v50, s[44:45]
    v_cndmask_b32 v9, 0, v50, s[44:45]
    v_and_b32 v50, 1, v0
    v_mul_u32_u24 v50, 0xaaaa, v50
    v_add_u32 v10, 0x4444, v50
    v_mov_b32 v40, 0
    v_mov_b32 v41, 0
    v_mov_b32 v42, 0
    v_mov_b32 v43, 0
    v_mov_b32 v44, 0
    v_mov_b32 v45, 0
    v_mov_b32 v46, 0
    v_mov_b32 v47, 0
    v_mov_b32 v48, 0
    v_mov_b32 v49, 0
    s_lshl_b32 s50, s28, 2
    s_add_u32 s50, s50, s31
    s_mul_i32 s41, s50, 122880
    s_lshl_b32 s47, s29, 13
    s_add_u32 s41, s41, s47
    s_add_u32 s41, s41, 4096
    s_mul_i32 s40, s50, 110592
    s_lshl_b32 s47, s29, 12
    s_add_u32 s40, s40, s47
    s_add_u32 s40, s40, 7864320
    s_cmp_lt_u32 s29, 5
    s_mov_b32 s35, 0xbede652a
    s_cmov_b32 s35, 0xbe0f7cdf
    s_cmp_lt_u32 s29, 13
    s_cselect_b32 s42, 0, 2130706432
    s_waitcnt vmcnt(4)
    s_barrier
    ds_read_b128 v[96:99], v32 offset:0
    ds_read_b64_tr_b16 v[16:17], v1 offset:16896
    ds_read_b64_tr_b16 v[18:19], v1 offset:17152
    ds_read_b64_tr_b16 v[20:21], v1 offset:16960
    ds_read_b64_tr_b16 v[22:23], v1 offset:17216
    ds_read_b128 v[100:103], v33 offset:0
    ds_read_b64_tr_b16 v[24:25], v2 offset:16896
    ds_read_b64_tr_b16 v[26:27], v2 offset:17152
    ds_read_b64_tr_b16 v[28:29], v2 offset:16960
    ds_read_b64_tr_b16 v[30:31], v2 offset:17216
    s_waitcnt lgkmcnt(5)
    v_smfmac_f32_16x16x64_bf16 v[40:43], v[6:9], v[16:23], v10
    v_mfma_f32_32x32x16_bf16 v[64:79], v[16:19], v[96:99], 0
    ds_read_b128 v[104:107], v34 offset:0
    ds_read_b64_tr_b16 v[16:17], v3 offset:16896
    ds_read_b64_tr_b16 v[18:19], v3 offset:17152
    s_mov_b32 s56, 256
    s_add_u32 m0, s34, 67584
    s_nop 0
    buffer_load_dwordx4 v36, s[8:11], s56 offen lds
    v_mfma_f32_32x32x16_bf16 v[80:95], v[20:23], v[96:99], 0
    ds_read_b64_tr_b16 v[20:21], v3 offset:16960
    ds_read_b64_tr_b16 v[22:23], v3 offset:17216
    s_mov_b32 s57, 256
    s_add_u32 m0, s34, 68608
    s_nop 0
    buffer_load_dwordx4 v37, s[8:11], s57 offen lds
    s_waitcnt lgkmcnt(7)
    v_mfma_f32_32x32x16_bf16 v[64:79], v[24:27], v[100:103], v[64:79]
    ds_read_b128 v[108:111], v35 offset:0
    ds_read_b64_tr_b16 v[24:25], v4 offset:16896
    ds_read_b64_tr_b16 v[26:27], v4 offset:17152
    s_mov_b32 s58, 442368
    s_add_u32 m0, s33, 84480
    s_nop 0
    buffer_load_dwordx4 v38, s[16:19], s58 offen lds
    s_waitcnt lgkmcnt(8)
    v_mfma_f32_32x32x16_bf16 v[80:95], v[28:31], v[100:103], v[80:95]
    ds_read_b64_tr_b16 v[28:29], v4 offset:16960
    ds_read_b64_tr_b16 v[30:31], v4 offset:17216
    s_mov_b32 s59, 442368
    s_add_u32 m0, s33, 92928
    s_nop 0
    buffer_load_dwordx4 v39, s[16:19], s59 offen lds
    s_waitcnt lgkmcnt(7)
    v_mfma_f32_32x32x16_bf16 v[64:79], v[16:19], v[104:107], v[64:79]
    s_mov_b32 s60, 384
    s_add_u32 m0, s34, 101376
    s_nop 0
    buffer_load_dwordx4 v36, s[8:11], s60 offen lds
    v_lshlrev_b32 v50, 16, v104
    v_and_b32 v51, s55, v104
    v_lshlrev_b32 v52, 16, v105
    v_and_b32 v53, s55, v105
    s_waitcnt lgkmcnt(0)
    s_waitcnt vmcnt(5)
    s_barrier
    ds_read_b128 v[112:115], v32 offset:33792
    ds_read_b64_tr_b16 v[16:17], v1 offset:50688
    ds_read_b64_tr_b16 v[18:19], v1 offset:50944
    v_mfma_f32_32x32x16_bf16 v[80:95], v[20:23], v[104:107], v[80:95]
    ds_read_b64_tr_b16 v[20:21], v1 offset:50752
    ds_read_b64_tr_b16 v[22:23], v1 offset:51008
    s_mov_b32 s61, 384
    s_add_u32 m0, s34, 102400
    s_nop 0
    buffer_load_dwordx4 v37, s[8:11], s61 offen lds
    v_fmac_f32 v48, v50, v50
    v_fmac_f32 v49, v51, v51
    v_fmac_f32 v48, v52, v52
    v_fmac_f32 v49, v53, v53
    v_mfma_f32_32x32x16_bf16 v[64:79], v[24:27], v[108:111], v[64:79]
    ds_read_b128 v[116:119], v33 offset:33792
    ds_read_b64_tr_b16 v[24:25], v2 offset:50688
    ds_read_b64_tr_b16 v[26:27], v2 offset:50944
    s_mov_b32 s62, 663552
    s_add_u32 m0, s33, 118272
    s_nop 0
    buffer_load_dwordx4 v38, s[16:19], s62 offen lds
    v_lshlrev_b32 v50, 16, v106
    v_and_b32 v51, s55, v106
    v_lshlrev_b32 v52, 16, v107
    v_and_b32 v53, s55, v107
    v_mfma_f32_32x32x16_bf16 v[80:95], v[28:31], v[108:111], v[80:95]
    ds_read_b64_tr_b16 v[28:29], v2 offset:50752
    ds_read_b64_tr_b16 v[30:31], v2 offset:51008
    s_mov_b32 s63, 663552
    s_add_u32 m0, s33, 126720
    s_nop 0
    buffer_load_dwordx4 v39, s[16:19], s63 offen lds
    v_fmac_f32 v48, v50, v50
    v_fmac_f32 v49, v51, v51
    v_fmac_f32 v48, v52, v52
    v_fmac_f32 v49, v53, v53
    v_smfmac_f32_16x16x64_bf16 v[44:47], v[6:9], v[104:111], v10
    s_waitcnt lgkmcnt(5)
    v_smfmac_f32_16x16x64_bf16 v[40:43], v[6:9], v[16:23], v10
    v_mfma_f32_32x32x16_bf16 v[64:79], v[16:19], v[112:115], v[64:79]
    ds_read_b128 v[120:123], v34 offset:33792
    ds_read_b64_tr_b16 v[16:17], v3 offset:50688
    ds_read_b64_tr_b16 v[18:19], v3 offset:50944
    s_mov_b32 s56, 512
    s_add_u32 m0, s34, 0
    s_nop 0
    buffer_load_dwordx4 v36, s[8:11], s56 offen lds
    v_lshlrev_b32 v50, 16, v108
    v_and_b32 v51, s55, v108
    v_lshlrev_b32 v52, 16, v109
    v_and_b32 v53, s55, v109
    v_mfma_f32_32x32x16_bf16 v[80:95], v[20:23], v[112:115], v[80:95]
    ds_read_b64_tr_b16 v[20:21], v3 offset:50752
    ds_read_b64_tr_b16 v[22:23], v3 offset:51008
    v_fmac_f32 v48, v50, v50
    v_fmac_f32 v49, v51, v51
    v_fmac_f32 v48, v52, v52
    v_fmac_f32 v49, v53, v53
    s_waitcnt lgkmcnt(7)
    v_mfma_f32_32x32x16_bf16 v[64:79], v[24:27], v[116:119], v[64:79]
    ds_read_b128 v[124:127], v35 offset:33792
    ds_read_b64_tr_b16 v[24:25], v4 offset:50688
    ds_read_b64_tr_b16 v[26:27], v4 offset:50944
    s_mov_b32 s57, 512
    s_add_u32 m0, s34, 1024
    s_nop 0
    buffer_load_dwordx4 v37, s[8:11], s57 offen lds
    v_lshlrev_b32 v50, 16, v110
    v_and_b32 v51, s55, v110
    v_lshlrev_b32 v52, 16, v111
    v_and_b32 v53, s55, v111
    s_waitcnt lgkmcnt(8)
    v_mfma_f32_32x32x16_bf16 v[80:95], v[28:31], v[116:119], v[80:95]
    ds_read_b64_tr_b16 v[28:29], v4 offset:50752
    ds_read_b64_tr_b16 v[30:31], v4 offset:51008
    v_fmac_f32 v48, v50, v50
    v_fmac_f32 v49, v51, v51
    v_fmac_f32 v48, v52, v52
    v_fmac_f32 v49, v53, v53
    s_waitcnt lgkmcnt(7)
    v_mfma_f32_32x32x16_bf16 v[64:79], v[16:19], v[120:123], v[64:79]
    s_mov_b32 s58, 884736
    s_add_u32 m0, s33, 16896
    s_nop 0
    buffer_load_dwordx4 v38, s[16:19], s58 offen lds
    v_lshlrev_b32 v50, 16, v120
    v_and_b32 v51, s55, v120
    v_lshlrev_b32 v52, 16, v121
    v_and_b32 v53, s55, v121
    v_add_u32 v1, 67584, v1
    v_add_u32 v2, 67584, v2
    v_add_u32 v3, 67584, v3
    v_add_u32 v4, 67584, v4
    v_add_u32 v32, 67584, v32
    v_add_u32 v33, 67584, v33
    v_add_u32 v34, 67584, v34
    v_add_u32 v35, 67584, v35
    s_waitcnt lgkmcnt(0)
    s_waitcnt vmcnt(7)
    s_barrier
    ds_read_b128 v[128:131], v32 offset:0
    ds_read_b64_tr_b16 v[16:17], v1 offset:16896
    ds_read_b64_tr_b16 v[18:19], v1 offset:17152
    v_mfma_f32_32x32x16_bf16 v[80:95], v[20:23], v[120:123], v[80:95]
    ds_read_b64_tr_b16 v[20:21], v1 offset:16960
    ds_read_b64_tr_b16 v[22:23], v1 offset:17216
    s_mov_b32 s59, 884736
    s_add_u32 m0, s33, 25344
    s_nop 0
    buffer_load_dwordx4 v39, s[16:19], s59 offen lds
    v_fmac_f32 v48, v50, v50
    v_fmac_f32 v49, v51, v51
    v_fmac_f32 v48, v52, v52
    v_fmac_f32 v49, v53, v53
    v_mfma_f32_32x32x16_bf16 v[64:79], v[24:27], v[124:127], v[64:79]
    ds_read_b128 v[132:135], v33 offset:0
    ds_read_b64_tr_b16 v[24:25], v2 offset:16896
    ds_read_b64_tr_b16 v[26:27], v2 offset:17152
    s_mov_b32 s60, 640
    s_add_u32 m0, s34, 33792
    s_nop 0
    buffer_load_dwordx4 v36, s[8:11], s60 offen lds
    v_lshlrev_b32 v50, 16, v122
    v_and_b32 v51, s55, v122
    v_lshlrev_b32 v52, 16, v123
    v_and_b32 v53, s55, v123
    v_mfma_f32_32x32x16_bf16 v[80:95], v[28:31], v[124:127], v[80:95]
    ds_read_b64_tr_b16 v[28:29], v2 offset:16960
    ds_read_b64_tr_b16 v[30:31], v2 offset:17216
    v_fmac_f32 v48, v50, v50
    v_fmac_f32 v49, v51, v51
    v_fmac_f32 v48, v52, v52
    v_fmac_f32 v49, v53, v53
    v_smfmac_f32_16x16x64_bf16 v[44:47], v[6:9], v[120:127], v10
    s_waitcnt lgkmcnt(5)
    v_smfmac_f32_16x16x64_bf16 v[40:43], v[6:9], v[16:23], v10
    v_mfma_f32_32x32x16_bf16 v[64:79], v[16:19], v[128:131], v[64:79]
    ds_read_b128 v[136:139], v34 offset:0
    ds_read_b64_tr_b16 v[16:17], v3 offset:16896
    ds_read_b64_tr_b16 v[18:19], v3 offset:17152
    s_mov_b32 s61, 640
    s_add_u32 m0, s34, 34816
    s_nop 0
    buffer_load_dwordx4 v37, s[8:11], s61 offen lds
    v_lshlrev_b32 v50, 16, v124
    v_and_b32 v51, s55, v124
    v_lshlrev_b32 v52, 16, v125
    v_and_b32 v53, s55, v125
    v_mfma_f32_32x32x16_bf16 v[80:95], v[20:23], v[128:131], v[80:95]
    ds_read_b64_tr_b16 v[20:21], v3 offset:16960
    ds_read_b64_tr_b16 v[22:23], v3 offset:17216
    v_fmac_f32 v48, v50, v50
    v_fmac_f32 v49, v51, v51
    v_fmac_f32 v48, v52, v52
    v_fmac_f32 v49, v53, v53
    s_waitcnt lgkmcnt(7)
    v_mfma_f32_32x32x16_bf16 v[64:79], v[24:27], v[132:135], v[64:79]
    ds_read_b128 v[140:143], v35 offset:0
    ds_read_b64_tr_b16 v[24:25], v4 offset:16896
    ds_read_b64_tr_b16 v[26:27], v4 offset:17152
    s_mov_b32 s62, 1105920
    s_add_u32 m0, s33, 50688
    s_nop 0
    buffer_load_dwordx4 v38, s[16:19], s62 offen lds
    v_lshlrev_b32 v50, 16, v126
    v_and_b32 v51, s55, v126
    v_lshlrev_b32 v52, 16, v127
    v_and_b32 v53, s55, v127
    s_waitcnt lgkmcnt(8)
    v_mfma_f32_32x32x16_bf16 v[80:95], v[28:31], v[132:135], v[80:95]
    ds_read_b64_tr_b16 v[28:29], v4 offset:16960
    ds_read_b64_tr_b16 v[30:31], v4 offset:17216
    v_fmac_f32 v48, v50, v50
    v_fmac_f32 v49, v51, v51
    v_fmac_f32 v48, v52, v52
    v_fmac_f32 v49, v53, v53
    s_waitcnt lgkmcnt(7)
    v_mfma_f32_32x32x16_bf16 v[64:79], v[16:19], v[136:139], v[64:79]
    s_mov_b32 s63, 1105920
    s_add_u32 m0, s33, 59136
    s_nop 0
    buffer_load_dwordx4 v39, s[16:19], s63 offen lds
    v_lshlrev_b32 v50, 16, v136
    v_and_b32 v51, s55, v136
    v_lshlrev_b32 v52, 16, v137
    v_and_b32 v53, s55, v137
    s_waitcnt lgkmcnt(0)
    s_waitcnt vmcnt(8)
    s_barrier
    ds_read_b128 v[144:147], v32 offset:33792
    ds_read_b64_tr_b16 v[16:17], v1 offset:50688
    ds_read_b64_tr_b16 v[18:19], v1 offset:50944
    v_mfma_f32_32x32x16_bf16 v[80:95], v[20:23], v[136:139], v[80:95]
    ds_read_b64_tr_b16 v[20:21], v1 offset:50752
    ds_read_b64_tr_b16 v[22:23], v1 offset:51008
    s_mov_b32 s56, 768
    s_add_u32 m0, s34, 67584
    s_nop 0
    buffer_load_dwordx4 v36, s[8:11], s56 offen lds
    v_fmac_f32 v48, v50, v50
    v_fmac_f32 v49, v51, v51
    v_fmac_f32 v48, v52, v52
    v_fmac_f32 v49, v53, v53
    v_mfma_f32_32x32x16_bf16 v[64:79], v[24:27], v[140:143], v[64:79]
    ds_read_b128 v[148:151], v33 offset:33792
    ds_read_b64_tr_b16 v[24:25], v2 offset:50688
    ds_read_b64_tr_b16 v[26:27], v2 offset:50944
    s_mov_b32 s57, 768
    s_add_u32 m0, s34, 68608
    s_nop 0
    buffer_load_dwordx4 v37, s[8:11], s57 offen lds
    v_lshlrev_b32 v50, 16, v138
    v_and_b32 v51, s55, v138
    v_lshlrev_b32 v52, 16, v139
    v_and_b32 v53, s55, v139
    v_mfma_f32_32x32x16_bf16 v[80:95], v[28:31], v[140:143], v[80:95]
    ds_read_b64_tr_b16 v[28:29], v2 offset:50752
    ds_read_b64_tr_b16 v[30:31], v2 offset:51008
    v_fmac_f32 v48, v50, v50
    v_fmac_f32 v49, v51, v51
    v_fmac_f32 v48, v52, v52
    v_fmac_f32 v49, v53, v53
    v_smfmac_f32_16x16x64_bf16 v[44:47], v[6:9], v[136:143], v10
    s_waitcnt lgkmcnt(5)
    v_smfmac_f32_16x16x64_bf16 v[40:43], v[6:9], v[16:23], v10
    v_mfma_f32_32x32x16_bf16 v[64:79], v[16:19], v[144:147], v[64:79]
    ds_read_b128 v[152:155], v34 offset:33792
    ds_read_b64_tr_b16 v[16:17], v3 offset:50688
    ds_read_b64_tr_b16 v[18:19], v3 offset:50944
    s_mov_b32 s58, 1327104
    s_add_u32 m0, s33, 84480
    s_nop 0
    buffer_load_dwordx4 v38, s[16:19], s58 offen lds
    v_lshlrev_b32 v50, 16, v140
    v_and_b32 v51, s55, v140
    v_lshlrev_b32 v52, 16, v141
    v_and_b32 v53, s55, v141
    v_mfma_f32_32x32x16_bf16 v[80:95], v[20:23], v[144:147], v[80:95]
    ds_read_b64_tr_b16 v[20:21], v3 offset:50752
    ds_read_b64_tr_b16 v[22:23], v3 offset:51008
    v_fmac_f32 v48, v50, v50
    v_fmac_f32 v49, v51, v51
    v_fmac_f32 v48, v52, v52
    v_fmac_f32 v49, v53, v53
    s_waitcnt lgkmcnt(7)
    v_mfma_f32_32x32x16_bf16 v[64:79], v[24:27], v[148:151], v[64:79]
    ds_read_b128 v[156:159], v35 offset:33792
    ds_read_b64_tr_b16 v[24:25], v4 offset:50688
    ds_read_b64_tr_b16 v[26:27], v4 offset:50944
    s_mov_b32 s59, 1327104
    s_add_u32 m0, s33, 92928
    s_nop 0
    buffer_load_dwordx4 v39, s[16:19], s59 offen lds
    v_lshlrev_b32 v50, 16, v142
    v_and_b32 v51, s55, v142
    v_lshlrev_b32 v52, 16, v143
    v_and_b32 v53, s55, v143
    s_waitcnt lgkmcnt(8)
    v_mfma_f32_32x32x16_bf16 v[80:95], v[28:31], v[148:151], v[80:95]
    ds_read_b64_tr_b16 v[28:29], v4 offset:50752
    ds_read_b64_tr_b16 v[30:31], v4 offset:51008
    v_fmac_f32 v48, v50, v50
    v_fmac_f32 v49, v51, v51
    v_fmac_f32 v48, v52, v52
    v_fmac_f32 v49, v53, v53
    s_waitcnt lgkmcnt(7)
    v_mfma_f32_32x32x16_bf16 v[64:79], v[16:19], v[152:155], v[64:79]
    v_lshlrev_b32 v50, 16, v152
    v_and_b32 v51, s55, v152
    v_lshlrev_b32 v52, 16, v153
    v_and_b32 v53, s55, v153
    v_add_u32 v1, -67584, v1
    v_add_u32 v2, -67584, v2
    v_add_u32 v3, -67584, v3
    v_add_u32 v4, -67584, v4
    v_add_u32 v32, -67584, v32
    v_add_u32 v33, -67584, v33
    v_add_u32 v34, -67584, v34
    v_add_u32 v35, -67584, v35
    s_waitcnt lgkmcnt(0)
    s_waitcnt vmcnt(8)
    s_barrier
    ds_read_b128 v[160:163], v32 offset:0
    ds_read_b64_tr_b16 v[16:17], v1 offset:16896
    ds_read_b64_tr_b16 v[18:19], v1 offset:17152
    v_mfma_f32_32x32x16_bf16 v[80:95], v[20:23], v[152:155], v[80:95]
    ds_read_b64_tr_b16 v[20:21], v1 offset:16960
    ds_read_b64_tr_b16 v[22:23], v1 offset:17216
    s_mov_b32 s60, 896
    s_add_u32 m0, s34, 101376
    s_nop 0
    buffer_load_dwordx4 v36, s[8:11], s60 offen lds
    v_fmac_f32 v48, v50, v50
    v_fmac_f32 v49, v51, v51
    v_fmac_f32 v48, v52, v52
    v_fmac_f32 v49, v53, v53
    v_mfma_f32_32x32x16_bf16 v[64:79], v[24:27], v[156:159], v[64:79]
    ds_read_b128 v[164:167], v33 offset:0
    ds_read_b64_tr_b16 v[24:25], v2 offset:16896
    ds_read_b64_tr_b16 v[26:27], v2 offset:17152
    s_mov_b32 s61, 896
    s_add_u32 m0, s34, 102400
    s_nop 0
    buffer_load_dwordx4 v37, s[8:11], s61 offen lds
    v_lshlrev_b32 v50, 16, v154
    v_and_b32 v51, s55, v154
    v_lshlrev_b32 v52, 16, v155
    v_and_b32 v53, s55, v155
    v_mfma_f32_32x32x16_bf16 v[80:95], v[28:31], v[156:159], v[80:95]
    ds_read_b64_tr_b16 v[28:29], v2 offset:16960
    ds_read_b64_tr_b16 v[30:31], v2 offset:17216
    v_fmac_f32 v48, v50, v50
    v_fmac_f32 v49, v51, v51
    v_fmac_f32 v48, v52, v52
    v_fmac_f32 v49, v53, v53
    v_smfmac_f32_16x16x64_bf16 v[44:47], v[6:9], v[152:159], v10
    s_waitcnt lgkmcnt(5)
    v_smfmac_f32_16x16x64_bf16 v[40:43], v[6:9], v[16:23], v10
    v_mfma_f32_32x32x16_bf16 v[64:79], v[16:19], v[160:163], v[64:79]
    ds_read_b128 v[168:171], v34 offset:0
    ds_read_b64_tr_b16 v[16:17], v3 offset:16896
    ds_read_b64_tr_b16 v[18:19], v3 offset:17152
    s_mov_b32 s62, 1548288
    s_add_u32 m0, s33, 118272
    s_nop 0
    buffer_load_dwordx4 v38, s[16:19], s62 offen lds
    v_lshlrev_b32 v50, 16, v156
    v_and_b32 v51, s55, v156
    v_lshlrev_b32 v52, 16, v157
    v_and_b32 v53, s55, v157
    v_mfma_f32_32x32x16_bf16 v[80:95], v[20:23], v[160:163], v[80:95]
    ds_read_b64_tr_b16 v[20:21], v3 offset:16960
    ds_read_b64_tr_b16 v[22:23], v3 offset:17216
    v_fmac_f32 v48, v50, v50
    v_fmac_f32 v49, v51, v51
    v_fmac_f32 v48, v52, v52
    v_fmac_f32 v49, v53, v53
    s_waitcnt lgkmcnt(7)
    v_mfma_f32_32x32x16_bf16 v[64:79], v[24:27], v[164:167], v[64:79]
    ds_read_b128 v[172:175], v35 offset:0
    ds_read_b64_tr_b16 v[24:25], v4 offset:16896
    ds_read_b64_tr_b16 v[26:27], v4 offset:17152
    s_mov_b32 s63, 1548288
    s_add_u32 m0, s33, 126720
    s_nop 0
    buffer_load_dwordx4 v39, s[16:19], s63 offen lds
    v_lshlrev_b32 v50, 16, v158
    v_and_b32 v51, s55, v158
    v_lshlrev_b32 v52, 16, v159
    v_and_b32 v53, s55, v159
    s_waitcnt lgkmcnt(8)
    v_mfma_f32_32x32x16_bf16 v[80:95], v[28:31], v[164:167], v[80:95]
    ds_read_b64_tr_b16 v[28:29], v4 offset:16960
    ds_read_b64_tr_b16 v[30:31], v4 offset:17216
    v_fmac_f32 v48, v50, v50
    v_fmac_f32 v49, v51, v51
    v_fmac_f32 v48, v52, v52
    v_fmac_f32 v49, v53, v53
    s_waitcnt lgkmcnt(7)
    v_mfma_f32_32x32x16_bf16 v[64:79], v[16:19], v[168:171], v[64:79]
    v_lshlrev_b32 v50, 16, v168
    v_and_b32 v51, s55, v168
    v_lshlrev_b32 v52, 16, v169
    v_and_b32 v53, s55, v169
    s_waitcnt lgkmcnt(0)
    s_waitcnt vmcnt(8)
    s_barrier
    ds_read_b128 v[176:179], v32 offset:33792
    ds_read_b64_tr_b16 v[16:17], v1 offset:50688
    ds_read_b64_tr_b16 v[18:19], v1 offset:50944
    v_mfma_f32_32x32x16_bf16 v[80:95], v[20:23], v[168:171], v[80:95]
    ds_read_b64_tr_b16 v[20:21], v1 offset:50752
    ds_read_b64_tr_b16 v[22:23], v1 offset:51008
    s_mov_b32 s56, 1024
    s_add_u32 m0, s34, 0
    s_nop 0
    buffer_load_dwordx4 v36, s[8:11], s56 offen lds
    v_fmac_f32 v48, v50, v50
    v_fmac_f32 v49, v51, v51
    v_fmac_f32 v48, v52, v52
    v_fmac_f32 v49, v53, v53
    v_mfma_f32_32x32x16_bf16 v[64:79], v[24:27], v[172:175], v[64:79]
    ds_read_b128 v[180:183], v33 offset:33792
    ds_read_b64_tr_b16 v[24:25], v2 offset:50688
    ds_read_b64_tr_b16 v[26:27], v2 offset:50944
    s_mov_b32 s57, 1024
    s_add_u32 m0, s34, 1024
    s_nop 0
    buffer_load_dwordx4 v37, s[8:11], s57 offen lds
    v_lshlrev_b32 v50, 16, v170
    v_and_b32 v51, s55, v170
    v_lshlrev_b32 v52, 16, v171
    v_and_b32 v53, s55, v171
    v_mfma_f32_32x32x16_bf16 v[80:95], v[28:31], v[172:175], v[80:95]
    ds_read_b64_tr_b16 v[28:29], v2 offset:50752
    ds_read_b64_tr_b16 v[30:31], v2 offset:51008
    v_fmac_f32 v48, v50, v50
    v_fmac_f32 v49, v51, v51
    v_fmac_f32 v48, v52, v52
    v_fmac_f32 v49, v53, v53
    v_smfmac_f32_16x16x64_bf16 v[44:47], v[6:9], v[168:175], v10
    s_waitcnt lgkmcnt(5)
    v_smfmac_f32_16x16x64_bf16 v[40:43], v[6:9], v[16:23], v10
    v_mfma_f32_32x32x16_bf16 v[64:79], v[16:19], v[176:179], v[64:79]
    ds_read_b128 v[184:187], v34 offset:33792
    ds_read_b64_tr_b16 v[16:17], v3 offset:50688
    ds_read_b64_tr_b16 v[18:19], v3 offset:50944
    s_mov_b32 s58, 1769472
    s_add_u32 m0, s33, 16896
    s_nop 0
    buffer_load_dwordx4 v38, s[16:19], s58 offen lds
    v_lshlrev_b32 v50, 16, v172
    v_and_b32 v51, s55, v172
    v_lshlrev_b32 v52, 16, v173
    v_and_b32 v53, s55, v173
    v_mfma_f32_32x32x16_bf16 v[80:95], v[20:23], v[176:179], v[80:95]
    ds_read_b64_tr_b16 v[20:21], v3 offset:50752
    ds_read_b64_tr_b16 v[22:23], v3 offset:51008
    v_fmac_f32 v48, v50, v50
    v_fmac_f32 v49, v51, v51
    v_fmac_f32 v48, v52, v52
    v_fmac_f32 v49, v53, v53
    s_waitcnt lgkmcnt(7)
    v_mfma_f32_32x32x16_bf16 v[64:79], v[24:27], v[180:183], v[64:79]
    ds_read_b128 v[188:191], v35 offset:33792
    ds_read_b64_tr_b16 v[24:25], v4 offset:50688
    ds_read_b64_tr_b16 v[26:27], v4 offset:50944
    s_mov_b32 s59, 1769472
    s_add_u32 m0, s33, 25344
    s_nop 0
    buffer_load_dwordx4 v39, s[16:19], s59 offen lds
    v_lshlrev_b32 v50, 16, v174
    v_and_b32 v51, s55, v174
    v_lshlrev_b32 v52, 16, v175
    v_and_b32 v53, s55, v175
    s_waitcnt lgkmcnt(8)
    v_mfma_f32_32x32x16_bf16 v[80:95], v[28:31], v[180:183], v[80:95]
    ds_read_b64_tr_b16 v[28:29], v4 offset:50752
    ds_read_b64_tr_b16 v[30:31], v4 offset:51008
    v_fmac_f32 v48, v50, v50
    v_fmac_f32 v49, v51, v51
    v_fmac_f32 v48, v52, v52
    v_fmac_f32 v49, v53, v53
    s_waitcnt lgkmcnt(7)
    v_mfma_f32_32x32x16_bf16 v[64:79], v[16:19], v[184:187], v[64:79]
    v_lshlrev_b32 v50, 16, v184
    v_and_b32 v51, s55, v184
    v_lshlrev_b32 v52, 16, v185
    v_and_b32 v53, s55, v185
    v_add_u32 v1, 67584, v1
    v_add_u32 v2, 67584, v2
    v_add_u32 v3, 67584, v3
    v_add_u32 v4, 67584, v4
    v_add_u32 v32, 67584, v32
    v_add_u32 v33, 67584, v33
    v_add_u32 v34, 67584, v34
    v_add_u32 v35, 67584, v35
    s_waitcnt lgkmcnt(0)
    s_waitcnt vmcnt(8)
    s_barrier
    ds_read_b128 v[192:195], v32 offset:0
    ds_read_b64_tr_b16 v[16:17], v1 offset:16896
    ds_read_b64_tr_b16 v[18:19], v1 offset:17152
    v_mfma_f32_32x32x16_bf16 v[80:95], v[20:23], v[184:187], v[80:95]
    ds_read_b64_tr_b16 v[20:21], v1 offset:16960
    ds_read_b64_tr_b16 v[22:23], v1 offset:17216
    s_mov_b32 s60, 1152
    s_add_u32 m0, s34, 33792
    s_nop 0
    buffer_load_dwordx4 v36, s[8:11], s60 offen lds
    v_fmac_f32 v48, v50, v50
    v_fmac_f32 v49, v51, v51
    v_fmac_f32 v48, v52, v52
    v_fmac_f32 v49, v53, v53
    v_mfma_f32_32x32x16_bf16 v[64:79], v[24:27], v[188:191], v[64:79]
    ds_read_b128 v[196:199], v33 offset:0
    ds_read_b64_tr_b16 v[24:25], v2 offset:16896
    ds_read_b64_tr_b16 v[26:27], v2 offset:17152
    s_mov_b32 s61, 1152
    s_add_u32 m0, s34, 34816
    s_nop 0
    buffer_load_dwordx4 v37, s[8:11], s61 offen lds
    v_lshlrev_b32 v50, 16, v186
    v_and_b32 v51, s55, v186
    v_lshlrev_b32 v52, 16, v187
    v_and_b32 v53, s55, v187
    v_mfma_f32_32x32x16_bf16 v[80:95], v[28:31], v[188:191], v[80:95]
    ds_read_b64_tr_b16 v[28:29], v2 offset:16960
    ds_read_b64_tr_b16 v[30:31], v2 offset:17216
    v_fmac_f32 v48, v50, v50
    v_fmac_f32 v49, v51, v51
    v_fmac_f32 v48, v52, v52
    v_fmac_f32 v49, v53, v53
    v_smfmac_f32_16x16x64_bf16 v[44:47], v[6:9], v[184:191], v10
    s_waitcnt lgkmcnt(5)
    v_smfmac_f32_16x16x64_bf16 v[40:43], v[6:9], v[16:23], v10
    v_mfma_f32_32x32x16_bf16 v[64:79], v[16:19], v[192:195], v[64:79]
    ds_read_b128 v[200:203], v34 offset:0
    ds_read_b64_tr_b16 v[16:17], v3 offset:16896
    ds_read_b64_tr_b16 v[18:19], v3 offset:17152
    s_mov_b32 s62, 1990656
    s_add_u32 m0, s33, 50688
    s_nop 0
    buffer_load_dwordx4 v38, s[16:19], s62 offen lds
    v_lshlrev_b32 v50, 16, v188
    v_and_b32 v51, s55, v188
    v_lshlrev_b32 v52, 16, v189
    v_and_b32 v53, s55, v189
    v_mfma_f32_32x32x16_bf16 v[80:95], v[20:23], v[192:195], v[80:95]
    ds_read_b64_tr_b16 v[20:21], v3 offset:16960
    ds_read_b64_tr_b16 v[22:23], v3 offset:17216
    v_fmac_f32 v48, v50, v50
    v_fmac_f32 v49, v51, v51
    v_fmac_f32 v48, v52, v52
    v_fmac_f32 v49, v53, v53
    s_waitcnt lgkmcnt(7)
    v_mfma_f32_32x32x16_bf16 v[64:79], v[24:27], v[196:199], v[64:79]
    ds_read_b128 v[204:207], v35 offset:0
    ds_read_b64_tr_b16 v[24:25], v4 offset:16896
    ds_read_b64_tr_b16 v[26:27], v4 offset:17152
    s_mov_b32 s63, 1990656
    s_add_u32 m0, s33, 59136
    s_nop 0
    buffer_load_dwordx4 v39, s[16:19], s63 offen lds
    v_lshlrev_b32 v50, 16, v190
    v_and_b32 v51, s55, v190
    v_lshlrev_b32 v52, 16, v191
    v_and_b32 v53, s55, v191
    s_waitcnt lgkmcnt(8)
    v_mfma_f32_32x32x16_bf16 v[80:95], v[28:31], v[196:199], v[80:95]
    ds_read_b64_tr_b16 v[28:29], v4 offset:16960
    ds_read_b64_tr_b16 v[30:31], v4 offset:17216
    v_fmac_f32 v48, v50, v50
    v_fmac_f32 v49, v51, v51
    v_fmac_f32 v48, v52, v52
    v_fmac_f32 v49, v53, v53
    s_waitcnt lgkmcnt(7)
    v_mfma_f32_32x32x16_bf16 v[64:79], v[16:19], v[200:203], v[64:79]
    v_lshlrev_b32 v50, 16, v200
    v_and_b32 v51, s55, v200
    v_lshlrev_b32 v52, 16, v201
    v_and_b32 v53, s55, v201
    s_waitcnt lgkmcnt(0)
    s_waitcnt vmcnt(8)
    s_barrier
    ds_read_b128 v[208:211], v32 offset:33792
    ds_read_b64_tr_b16 v[16:17], v1 offset:50688
    ds_read_b64_tr_b16 v[18:19], v1 offset:50944
    v_mfma_f32_32x32x16_bf16 v[80:95], v[20:23], v[200:203], v[80:95]
    ds_read_b64_tr_b16 v[20:21], v1 offset:50752
    ds_read_b64_tr_b16 v[22:23], v1 offset:51008
    s_mov_b32 s56, 0
    s_add_u32 m0, s33, 67584
    s_nop 0
    buffer_load_dwordx4 v5, s[12:15], s56 offen lds
    v_fmac_f32 v48, v50, v50
    v_fmac_f32 v49, v51, v51
    v_fmac_f32 v48, v52, v52
    v_fmac_f32 v49, v53, v53
    v_mfma_f32_32x32x16_bf16 v[64:79], v[24:27], v[204:207], v[64:79]
    ds_read_b128 v[212:215], v33 offset:33792
    ds_read_b64_tr_b16 v[24:25], v2 offset:50688
    ds_read_b64_tr_b16 v[26:27], v2 offset:50944
    s_mov_b32 s57, 128
    s_add_u32 m0, s33, 76032
    s_nop 0
    buffer_load_dwordx4 v5, s[12:15], s57 offen lds
    v_lshlrev_b32 v50, 16, v202
    v_and_b32 v51, s55, v202
    v_lshlrev_b32 v52, 16, v203
    v_and_b32 v53, s55, v203
    v_mfma_f32_32x32x16_bf16 v[80:95], v[28:31], v[204:207], v[80:95]
    ds_read_b64_tr_b16 v[28:29], v2 offset:50752
    ds_read_b64_tr_b16 v[30:31], v2 offset:51008
    v_fmac_f32 v48, v50, v50
    v_fmac_f32 v49, v51, v51
    v_fmac_f32 v48, v52, v52
    v_fmac_f32 v49, v53, v53
    v_smfmac_f32_16x16x64_bf16 v[44:47], v[6:9], v[200:207], v10
    s_waitcnt lgkmcnt(5)
    v_smfmac_f32_16x16x64_bf16 v[40:43], v[6:9], v[16:23], v10
    v_mfma_f32_32x32x16_bf16 v[64:79], v[16:19], v[208:211], v[64:79]
    ds_read_b128 v[216:219], v34 offset:33792
    ds_read_b64_tr_b16 v[16:17], v3 offset:50688
    ds_read_b64_tr_b16 v[18:19], v3 offset:50944
    s_mov_b32 s58, 245760
    s_add_u32 m0, s33, 84480
    s_nop 0
    buffer_load_dwordx4 v5, s[12:15], s58 offen lds
    v_lshlrev_b32 v50, 16, v204
    v_and_b32 v51, s55, v204
    v_lshlrev_b32 v52, 16, v205
    v_and_b32 v53, s55, v205
    v_mfma_f32_32x32x16_bf16 v[80:95], v[20:23], v[208:211], v[80:95]
    ds_read_b64_tr_b16 v[20:21], v3 offset:50752
    ds_read_b64_tr_b16 v[22:23], v3 offset:51008
    v_fmac_f32 v48, v50, v50
    v_fmac_f32 v49, v51, v51
    v_fmac_f32 v48, v52, v52
    v_fmac_f32 v49, v53, v53
    s_waitcnt lgkmcnt(7)
    v_mfma_f32_32x32x16_bf16 v[64:79], v[24:27], v[212:215], v[64:79]
    ds_read_b128 v[220:223], v35 offset:33792
    ds_read_b64_tr_b16 v[24:25], v4 offset:50688
    ds_read_b64_tr_b16 v[26:27], v4 offset:50944
    s_mov_b32 s59, 245888
    s_add_u32 m0, s33, 92928
    s_nop 0
    buffer_load_dwordx4 v5, s[12:15], s59 offen lds
    v_lshlrev_b32 v50, 16, v206
    v_and_b32 v51, s55, v206
    v_lshlrev_b32 v52, 16, v207
    v_and_b32 v53, s55, v207
    s_waitcnt lgkmcnt(8)
    v_mfma_f32_32x32x16_bf16 v[80:95], v[28:31], v[212:215], v[80:95]
    ds_read_b64_tr_b16 v[28:29], v4 offset:50752
    ds_read_b64_tr_b16 v[30:31], v4 offset:51008
    v_fmac_f32 v48, v50, v50
    v_fmac_f32 v49, v51, v51
    v_fmac_f32 v48, v52, v52
    v_fmac_f32 v49, v53, v53
    s_waitcnt lgkmcnt(7)
    v_mfma_f32_32x32x16_bf16 v[64:79], v[16:19], v[216:219], v[64:79]
    v_lshlrev_b32 v50, 16, v216
    v_and_b32 v51, s55, v216
    v_lshlrev_b32 v52, 16, v217
    v_and_b32 v53, s55, v217
    v_lshlrev_b32 v54, 4, v0
    v_add_u32 v54, 136192, v54
    v_add_u32 v1, -67584, v1
    v_add_u32 v2, -67584, v2
    v_add_u32 v3, -67584, v3
    v_add_u32 v4, -67584, v4
    v_add_u32 v32, -67584, v32
    v_add_u32 v33, -67584, v33
    v_add_u32 v34, -67584, v34
    v_add_u32 v35, -67584, v35
    s_waitcnt lgkmcnt(0)
    s_waitcnt vmcnt(8)
    s_barrier
    ds_read_b128 v[224:227], v32 offset:0
    ds_read_b64_tr_b16 v[16:17], v1 offset:16896
    ds_read_b64_tr_b16 v[18:19], v1 offset:17152
    v_mfma_f32_32x32x16_bf16 v[80:95], v[20:23], v[216:219], v[80:95]
    ds_read_b64_tr_b16 v[20:21], v1 offset:16960
    ds_read_b64_tr_b16 v[22:23], v1 offset:17216
    s_mov_b32 s60, 491520
    s_add_u32 m0, s33, 101376
    s_nop 0
    buffer_load_dwordx4 v5, s[12:15], s60 offen lds
    v_fmac_f32 v48, v50, v50
    v_fmac_f32 v49, v51, v51
    v_fmac_f32 v48, v52, v52
    v_fmac_f32 v49, v53, v53
    v_and_b32 v55, 31, v0
    v_lshlrev_b32 v55, 4, v55
    v_mfma_f32_32x32x16_bf16 v[64:79], v[24:27], v[220:223], v[64:79]
    ds_read_b128 v[228:231], v33 offset:0
    ds_read_b64_tr_b16 v[24:25], v2 offset:16896
    ds_read_b64_tr_b16 v[26:27], v2 offset:17152
    s_mov_b32 s61, 491648
    s_add_u32 m0, s33, 109824
    s_nop 0
    buffer_load_dwordx4 v5, s[12:15], s61 offen lds
    v_lshlrev_b32 v50, 16, v218
    v_and_b32 v51, s55, v218
    v_lshlrev_b32 v52, 16, v219
    v_and_b32 v53, s55, v219
    s_lshl_b32 s47, s31, 9
    s_add_u32 s47, s47, 135168
    v_add_u32 v55, s47, v55
    v_lshrrev_b32 v56, 5, v0
    v_mfma_f32_32x32x16_bf16 v[80:95], v[28:31], v[220:223], v[80:95]
    ds_read_b64_tr_b16 v[28:29], v2 offset:16960
    ds_read_b64_tr_b16 v[30:31], v2 offset:17216
    v_fmac_f32 v48, v50, v50
    v_fmac_f32 v49, v51, v51
    v_fmac_f32 v48, v52, v52
    v_fmac_f32 v49, v53, v53
    v_lshl_add_u32 v56, v56, 2, v55
    v_smfmac_f32_16x16x64_bf16 v[44:47], v[6:9], v[216:223], v10
    s_waitcnt lgkmcnt(5)
    v_smfmac_f32_16x16x64_bf16 v[40:43], v[6:9], v[16:23], v10
    v_mfma_f32_32x32x16_bf16 v[64:79], v[16:19], v[224:227], v[64:79]
    ds_read_b128 v[232:235], v34 offset:0
    ds_read_b64_tr_b16 v[16:17], v3 offset:16896
    ds_read_b64_tr_b16 v[18:19], v3 offset:17152
    s_mov_b32 s62, 737280
    s_add_u32 m0, s33, 118272
    s_nop 0
    buffer_load_dwordx4 v5, s[12:15], s62 offen lds
    v_lshlrev_b32 v50, 16, v220
    v_and_b32 v51, s55, v220
    v_lshlrev_b32 v52, 16, v221
    v_and_b32 v53, s55, v221
    v_mfma_f32_32x32x16_bf16 v[80:95], v[20:23], v[224:227], v[80:95]
    ds_read_b64_tr_b16 v[20:21], v3 offset:16960
    ds_read_b64_tr_b16 v[22:23], v3 offset:17216
    v_fmac_f32 v48, v50, v50
    v_fmac_f32 v49, v51, v51
    v_fmac_f32 v48, v52, v52
    v_fmac_f32 v49, v53, v53
    s_waitcnt lgkmcnt(7)
    v_mfma_f32_32x32x16_bf16 v[64:79], v[24:27], v[228:231], v[64:79]
    ds_read_b128 v[236:239], v35 offset:0
    ds_read_b64_tr_b16 v[24:25], v4 offset:16896
    ds_read_b64_tr_b16 v[26:27], v4 offset:17152
    s_mov_b32 s63, 737408
    s_add_u32 m0, s33, 126720
    s_nop 0
    buffer_load_dwordx4 v5, s[12:15], s63 offen lds
    v_lshlrev_b32 v50, 16, v222
    v_and_b32 v51, s55, v222
    v_lshlrev_b32 v52, 16, v223
    v_and_b32 v53, s55, v223
    s_waitcnt lgkmcnt(8)
    v_mfma_f32_32x32x16_bf16 v[80:95], v[28:31], v[228:231], v[80:95]
    ds_read_b64_tr_b16 v[28:29], v4 offset:16960
    ds_read_b64_tr_b16 v[30:31], v4 offset:17216
    v_fmac_f32 v48, v50, v50
    v_fmac_f32 v49, v51, v51
    v_fmac_f32 v48, v52, v52
    v_fmac_f32 v49, v53, v53
    s_waitcnt lgkmcnt(7)
    v_mfma_f32_32x32x16_bf16 v[64:79], v[16:19], v[232:235], v[64:79]
    v_lshlrev_b32 v50, 16, v232
    v_and_b32 v51, s55, v232
    v_lshlrev_b32 v52, 16, v233
    v_and_b32 v53, s55, v233
    v_fmac_f32 v48, v50, v50
    v_fmac_f32 v49, v51, v51
    v_fmac_f32 v48, v52, v52
    v_fmac_f32 v49, v53, v53
    s_waitcnt lgkmcnt(0)
    s_waitcnt vmcnt(8)
    s_barrier
    ds_read_b128 v[240:243], v32 offset:33792
    ds_read_b64_tr_b16 v[16:17], v1 offset:50688
    ds_read_b64_tr_b16 v[18:19], v1 offset:50944
    v_mfma_f32_32x32x16_bf16 v[80:95], v[20:23], v[232:235], v[80:95]
    ds_read_b64_tr_b16 v[20:21], v1 offset:50752
    ds_read_b64_tr_b16 v[22:23], v1 offset:51008
    s_mov_b32 s56, 983040
    s_add_u32 m0, s33, 0
    s_nop 0
    buffer_load_dwordx4 v5, s[12:15], s56 offen lds
    v_lshlrev_b32 v50, 16, v234
    v_and_b32 v51, s55, v234
    v_lshlrev_b32 v52, 16, v235
    v_and_b32 v53, s55, v235
    v_fmac_f32 v48, v50, v50
    v_fmac_f32 v49, v51, v51
    v_fmac_f32 v48, v52, v52
    v_fmac_f32 v49, v53, v53
    v_mfma_f32_32x32x16_bf16 v[64:79], v[24:27], v[236:239], v[64:79]
    ds_read_b128 v[244:247], v33 offset:33792
    ds_read_b64_tr_b16 v[24:25], v2 offset:50688
    ds_read_b64_tr_b16 v[26:27], v2 offset:50944
    s_mov_b32 s57, 983168
    s_add_u32 m0, s33, 8448
    s_nop 0
    buffer_load_dwordx4 v5, s[12:15], s57 offen lds
    v_lshlrev_b32 v50, 16, v236
    v_and_b32 v51, s55, v236
    v_lshlrev_b32 v52, 16, v237
    v_and_b32 v53, s55, v237
    v_fmac_f32 v48, v50, v50
    v_fmac_f32 v49, v51, v51
    v_fmac_f32 v48, v52, v52
    v_fmac_f32 v49, v53, v53
    v_mfma_f32_32x32x16_bf16 v[80:95], v[28:31], v[236:239], v[80:95]
    ds_read_b64_tr_b16 v[28:29], v2 offset:50752
    ds_read_b64_tr_b16 v[30:31], v2 offset:51008
    ds_read_b128 v[248:251], v34 offset:33792
    ds_read_b128 v[252:255], v35 offset:33792
    v_lshlrev_b32 v50, 16, v238
    v_and_b32 v51, s55, v238
    v_lshlrev_b32 v52, 16, v239
    v_and_b32 v53, s55, v239
    v_fmac_f32 v48, v50, v50
    v_fmac_f32 v49, v51, v51
    v_fmac_f32 v48, v52, v52
    v_fmac_f32 v49, v53, v53
    v_smfmac_f32_16x16x64_bf16 v[44:47], v[6:9], v[232:239], v10
    s_waitcnt lgkmcnt(7)
    v_smfmac_f32_16x16x64_bf16 v[40:43], v[6:9], v[16:23], v10
    v_mfma_f32_32x32x16_bf16 v[64:79], v[16:19], v[240:243], v[64:79]
    ds_read_b64_tr_b16 v[16:17], v3 offset:50688
    ds_read_b64_tr_b16 v[18:19], v3 offset:50944
    s_mov_b32 s58, 1228800
    s_add_u32 m0, s33, 16896
    s_nop 0
    buffer_load_dwordx4 v5, s[12:15], s58 offen lds
    s_waitcnt lgkmcnt(3)
    v_lshlrev_b32 v50, 16, v248
    v_and_b32 v51, s55, v248
    v_lshlrev_b32 v52, 16, v249
    v_and_b32 v53, s55, v249
    v_fmac_f32 v48, v50, v50
    v_fmac_f32 v49, v51, v51
    v_fmac_f32 v48, v52, v52
    v_fmac_f32 v49, v53, v53
    v_lshlrev_b32 v50, 16, v250
    v_and_b32 v51, s55, v250
    v_lshlrev_b32 v52, 16, v251
    v_mfma_f32_32x32x16_bf16 v[80:95], v[20:23], v[240:243], v[80:95]
    ds_read_b64_tr_b16 v[20:21], v3 offset:50752
    ds_read_b64_tr_b16 v[22:23], v3 offset:51008
    v_and_b32 v53, s55, v251
    v_fmac_f32 v48, v50, v50
    v_fmac_f32 v49, v51, v51
    v_fmac_f32 v48, v52, v52
    v_fmac_f32 v49, v53, v53
    s_waitcnt lgkmcnt(4)
    v_lshlrev_b32 v50, 16, v252
    v_and_b32 v51, s55, v252
    v_lshlrev_b32 v52, 16, v253
    v_and_b32 v53, s55, v253
    v_fmac_f32 v48, v50, v50
    v_fmac_f32 v49, v51, v51
    v_smfmac_f32_16x16x64_bf16 v[44:47], v[6:9], v[248:255], v10
    v_mfma_f32_32x32x16_bf16 v[64:79], v[24:27], v[244:247], v[64:79]
    ds_read_b64_tr_b16 v[24:25], v4 offset:50688
    ds_read_b64_tr_b16 v[26:27], v4 offset:50944
    s_mov_b32 s59, 1228928
    s_add_u32 m0, s33, 25344
    s_nop 0
    buffer_load_dwordx4 v5, s[12:15], s59 offen lds
    v_fmac_f32 v48, v52, v52
    v_fmac_f32 v49, v53, v53
    v_lshlrev_b32 v50, 16, v254
    v_and_b32 v51, s55, v254
    v_lshlrev_b32 v52, 16, v255
    v_and_b32 v53, s55, v255
    v_fmac_f32 v48, v50, v50
    v_fmac_f32 v49, v51, v51
    v_fmac_f32 v48, v52, v52
    v_fmac_f32 v49, v53, v53
    v_mfma_f32_32x32x16_bf16 v[80:95], v[28:31], v[244:247], v[80:95]
    ds_read_b64_tr_b16 v[28:29], v4 offset:50752
    ds_read_b64_tr_b16 v[30:31], v4 offset:51008
    s_lshl_b32 s47, s31, 2
    v_add_u32 v57, s47, v54
    v_add_f32 v40, v40, v41
    ds_write_b32 v57, v40 offset:2048
    v_add_f32 v44, v44, v45
    v_add_f32 v48, v48, v49
    s_nop 1
    v_permlane32_swap_b32 v44, v48
    v_add_f32 v44, v44, v48
    ds_write_b32 v56, v44 offset:8
    s_waitcnt lgkmcnt(8)
    v_mfma_f32_32x32x16_bf16 v[64:79], v[16:19], v[248:251], v[64:79]
    v_add_u32 v1, 67584, v1
    v_add_u32 v2, 67584, v2
    v_add_u32 v3, 67584, v3
    v_add_u32 v4, 67584, v4
    s_waitcnt lgkmcnt(0)
    s_waitcnt vmcnt(8)
    s_barrier
    ds_read_b64_tr_b16 v[16:17], v1 offset:0
    ds_read_b64_tr_b16 v[18:19], v1 offset:256
    ds_read_b128 v[56:59], v55
    ds_read_b128 v[60:63], v54 offset:2048
    v_mfma_f32_32x32x16_bf16 v[80:95], v[20:23], v[248:251], v[80:95]
    ds_read_b64_tr_b16 v[20:21], v1 offset:64
    ds_read_b64_tr_b16 v[22:23], v1 offset:320
    s_mov_b32 s60, 1474560
    s_add_u32 m0, s33, 33792
    s_nop 0
    buffer_load_dwordx4 v5, s[12:15], s60 offen lds
    v_mfma_f32_32x32x16_bf16 v[64:79], v[24:27], v[252:255], v[64:79]
    ds_read_b64_tr_b16 v[24:25], v2 offset:0
    ds_read_b64_tr_b16 v[26:27], v2 offset:256
    s_mov_b32 s61, 1474688
    s_add_u32 m0, s33, 42240
    s_nop 0
    buffer_load_dwordx4 v5, s[12:15], s61 offen lds
    s_waitcnt lgkmcnt(5)
    v_add_f32 v56, v56, v58
    v_add_f32 v57, v57, v59
    s_waitcnt lgkmcnt(4)
    v_add_f32 v60, v60, v61
    v_mul_f32 v56, 0xbacccccd, v56
    v_mul_f32 v57, 0x3acccccd, v57
    v_add_f32 v62, v62, v63
    v_cvt_pk_bf16_f32 v12, v56, v56
    v_fma_f32 v57, -v56, v56, v57
    v_add_f32 v60, v60, v62
    v_and_b32 v58, s55, v12
    v_cvt_pk_bf16_f32 v61, v60, v60
    v_max_f32 v57, 0, v57
    v_sub_f32 v58, v56, v58
    v_and_b32 v61, s55, v61
    v_add_f32 v57, 0x3727c5ac, v57
    v_cvt_pk_bf16_f32 v13, v58, v58
    v_sub_f32 v62, v60, v61
    v_rsq_f32 v14, v57
    v_mfma_f32_32x32x16_bf16 v[80:95], v[28:31], v[252:255], v[80:95]
    ds_read_b64_tr_b16 v[28:29], v2 offset:64
    ds_read_b64_tr_b16 v[30:31], v2 offset:320
    v_cvt_pk_bf16_f32 v40, v60, v62
    v_and_b32 v59, s55, v13
    v_sqrt_f32 v11, v57
    v_and_b32 v61, s55, v40
    v_sub_f32 v58, v58, v59
    v_cndmask_b32 v13, v13, 0, s[38:39]
    v_sub_f32 v62, v62, v61
    v_cvt_pk_bf16_f32 v58, v56, v58
    v_cvt_pk_bf16_f32 v42, v62, v60
    v_mul_f32 v15, 0xc0135761, v14
    v_cndmask_b32 v12, v12, v58, s[38:39]
    v_permlane32_swap_b32 v40, v42
    v_mul_f32 v14, v14, v14
    v_mul_f32 v14, 0x3d372713, v14
    v_mov_b32 v41, v40
    v_mul_f32 v14, v14, v15
    v_mov_b32 v43, v42
    v_mfma_f32_32x32x8bf16_1k v[64:79], v[40:41], v[12:13], v[64:79]
    s_nop 0
    v_mfma_f32_32x32x8bf16_1k v[80:95], v[42:43], v[12:13], v[80:95]
    v_mfma_f32_32x32x16_bf16 v[32:47], v[16:19], v[96:99], 0
    ds_read_b64_tr_b16 v[16:17], v3 offset:0
    ds_read_b64_tr_b16 v[18:19], v3 offset:256
    s_mov_b32 s62, 1720320
    s_add_u32 m0, s33, 50688
    s_nop 0
    buffer_load_dwordx4 v5, s[12:15], s62 offen lds
    s_waitcnt lgkmcnt(6)
    v_mfma_f32_32x32x16_bf16 v[48:63], v[20:23], v[96:99], 0
    ds_read_b64_tr_b16 v[20:21], v3 offset:64
    ds_read_b64_tr_b16 v[22:23], v3 offset:320
    s_waitcnt lgkmcnt(6)
    v_mfma_f32_32x32x16_bf16 v[32:47], v[24:27], v[100:103], v[32:47]
    ds_read_b64_tr_b16 v[24:25], v4 offset:0
    ds_read_b64_tr_b16 v[26:27], v4 offset:256
    s_mov_b32 s63, 1720448
    s_add_u32 m0, s33, 59136
    s_nop 0
    buffer_load_dwordx4 v5, s[12:15], s63 offen lds
    s_waitcnt lgkmcnt(6)
    v_mfma_f32_32x32x16_bf16 v[48:63], v[28:31], v[100:103], v[48:63]
    ds_read_b64_tr_b16 v[28:29], v4 offset:64
    ds_read_b64_tr_b16 v[30:31], v4 offset:320
    s_waitcnt lgkmcnt(6)
    v_mfma_f32_32x32x16_bf16 v[32:47], v[16:19], v[104:107], v[32:47]
    ds_read_b64_tr_b16 v[16:17], v1 offset:16896
    ds_read_b64_tr_b16 v[18:19], v1 offset:17152
    s_waitcnt lgkmcnt(6)
    v_mfma_f32_32x32x16_bf16 v[48:63], v[20:23], v[104:107], v[48:63]
    ds_read_b64_tr_b16 v[20:21], v1 offset:16960
    ds_read_b64_tr_b16 v[22:23], v1 offset:17216
    v_mov_b32 v104, 0
    v_mov_b32 v105, 0
    v_mov_b32 v106, 0
    v_mov_b32 v107, 0
    s_waitcnt lgkmcnt(4)
    s_nop 0
    v_smfmac_f32_16x16x64_bf16 v[104:107], v[6:9], v[24:31], v10
    v_mfma_f32_32x32x16_bf16 v[32:47], v[24:27], v[108:111], v[32:47]
    ds_read_b64_tr_b16 v[24:25], v2 offset:16896
    ds_read_b64_tr_b16 v[26:27], v2 offset:17152
    v_mfma_f32_32x32x16_bf16 v[48:63], v[28:31], v[108:111], v[48:63]
    ds_read_b64_tr_b16 v[28:29], v2 offset:16960
    ds_read_b64_tr_b16 v[30:31], v2 offset:17216
    s_waitcnt lgkmcnt(4)
    v_smfmac_f32_16x16x64_bf16 v[104:107], v[6:9], v[16:23], v10
    v_mfma_f32_32x32x16_bf16 v[32:47], v[16:19], v[112:115], v[32:47]
    ds_read_b64_tr_b16 v[16:17], v3 offset:16896
    ds_read_b64_tr_b16 v[18:19], v3 offset:17152
    v_mfma_f32_32x32x16_bf16 v[48:63], v[20:23], v[112:115], v[48:63]
    ds_read_b64_tr_b16 v[20:21], v3 offset:16960
    ds_read_b64_tr_b16 v[22:23], v3 offset:17216
    s_waitcnt lgkmcnt(6)
    v_mfma_f32_32x32x16_bf16 v[32:47], v[24:27], v[116:119], v[32:47]
    ds_read_b64_tr_b16 v[24:25], v4 offset:16896
    ds_read_b64_tr_b16 v[26:27], v4 offset:17152
    s_waitcnt lgkmcnt(6)
    v_mfma_f32_32x32x16_bf16 v[48:63], v[28:31], v[116:119], v[48:63]
    ds_read_b64_tr_b16 v[28:29], v4 offset:16960
    ds_read_b64_tr_b16 v[30:31], v4 offset:17216
    s_waitcnt lgkmcnt(6)
    v_mfma_f32_32x32x16_bf16 v[32:47], v[16:19], v[120:123], v[32:47]
    s_waitcnt lgkmcnt(0)
    s_waitcnt vmcnt(8)
    s_barrier
    ds_read_b64_tr_b16 v[16:17], v1 offset:33792
    ds_read_b64_tr_b16 v[18:19], v1 offset:34048
    v_mfma_f32_32x32x16_bf16 v[48:63], v[20:23], v[120:123], v[48:63]
    ds_read_b64_tr_b16 v[20:21], v1 offset:33856
    ds_read_b64_tr_b16 v[22:23], v1 offset:34112
    s_mov_b32 s56, 1966080
    s_add_u32 m0, s33, 67584
    s_nop 0
    buffer_load_dwordx4 v5, s[12:15], s56 offen lds
    v_mfma_f32_32x32x16_bf16 v[32:47], v[24:27], v[124:127], v[32:47]
    ds_read_b64_tr_b16 v[24:25], v2 offset:33792
    ds_read_b64_tr_b16 v[26:27], v2 offset:34048
    s_mov_b32 s57, 1966208
    s_add_u32 m0, s33, 76032
    s_nop 0
    buffer_load_dwordx4 v5, s[12:15], s57 offen lds
    v_mfma_f32_32x32x16_bf16 v[48:63], v[28:31], v[124:127], v[48:63]
    ds_read_b64_tr_b16 v[28:29], v2 offset:33856
    ds_read_b64_tr_b16 v[30:31], v2 offset:34112
    s_waitcnt lgkmcnt(4)
    v_smfmac_f32_16x16x64_bf16 v[104:107], v[6:9], v[16:23], v10
    v_mfma_f32_32x32x16_bf16 v[32:47], v[16:19], v[128:131], v[32:47]
    ds_read_b64_tr_b16 v[16:17], v3 offset:33792
    ds_read_b64_tr_b16 v[18:19], v3 offset:34048
    s_mov_b32 s58, 2211840
    s_add_u32 m0, s33, 84480
    s_nop 0
    buffer_load_dwordx4 v5, s[12:15], s58 offen lds
    v_mfma_f32_32x32x16_bf16 v[48:63], v[20:23], v[128:131], v[48:63]
    ds_read_b64_tr_b16 v[20:21], v3 offset:33856
    ds_read_b64_tr_b16 v[22:23], v3 offset:34112
    s_waitcnt lgkmcnt(6)
    v_mfma_f32_32x32x16_bf16 v[32:47], v[24:27], v[132:135], v[32:47]
    ds_read_b64_tr_b16 v[24:25], v4 offset:33792
    ds_read_b64_tr_b16 v[26:27], v4 offset:34048
    s_mov_b32 s59, 2211968
    s_add_u32 m0, s33, 92928
    s_nop 0
    buffer_load_dwordx4 v5, s[12:15], s59 offen lds
    s_waitcnt lgkmcnt(6)
    v_mfma_f32_32x32x16_bf16 v[48:63], v[28:31], v[132:135], v[48:63]
    ds_read_b64_tr_b16 v[28:29], v4 offset:33856
    ds_read_b64_tr_b16 v[30:31], v4 offset:34112
    s_waitcnt lgkmcnt(6)
    v_mfma_f32_32x32x16_bf16 v[32:47], v[16:19], v[136:139], v[32:47]
    ds_read_b64_tr_b16 v[16:17], v1 offset:50688
    ds_read_b64_tr_b16 v[18:19], v1 offset:50944
    s_waitcnt lgkmcnt(6)
    v_mfma_f32_32x32x16_bf16 v[48:63], v[20:23], v[136:139], v[48:63]
    ds_read_b64_tr_b16 v[20:21], v1 offset:50752
    ds_read_b64_tr_b16 v[22:23], v1 offset:51008
    s_waitcnt lgkmcnt(6)
    v_mfma_f32_32x32x16_bf16 v[32:47], v[24:27], v[140:143], v[32:47]
    ds_read_b64_tr_b16 v[24:25], v2 offset:50688
    ds_read_b64_tr_b16 v[26:27], v2 offset:50944
    s_waitcnt lgkmcnt(6)
    v_mfma_f32_32x32x16_bf16 v[48:63], v[28:31], v[140:143], v[48:63]
    ds_read_b64_tr_b16 v[28:29], v2 offset:50752
    ds_read_b64_tr_b16 v[30:31], v2 offset:51008
    s_waitcnt lgkmcnt(4)
    v_smfmac_f32_16x16x64_bf16 v[104:107], v[6:9], v[16:23], v10
    v_mfma_f32_32x32x16_bf16 v[32:47], v[16:19], v[144:147], v[32:47]
    ds_read_b64_tr_b16 v[16:17], v3 offset:50688
    ds_read_b64_tr_b16 v[18:19], v3 offset:50944
    v_mfma_f32_32x32x16_bf16 v[48:63], v[20:23], v[144:147], v[48:63]
    ds_read_b64_tr_b16 v[20:21], v3 offset:50752
    ds_read_b64_tr_b16 v[22:23], v3 offset:51008
    s_waitcnt lgkmcnt(6)
    v_mfma_f32_32x32x16_bf16 v[32:47], v[24:27], v[148:151], v[32:47]
    ds_read_b64_tr_b16 v[24:25], v4 offset:50688
    ds_read_b64_tr_b16 v[26:27], v4 offset:50944
    s_waitcnt lgkmcnt(6)
    v_mfma_f32_32x32x16_bf16 v[48:63], v[28:31], v[148:151], v[48:63]
    ds_read_b64_tr_b16 v[28:29], v4 offset:50752
    ds_read_b64_tr_b16 v[30:31], v4 offset:51008
    s_waitcnt lgkmcnt(6)
    v_mfma_f32_32x32x16_bf16 v[32:47], v[16:19], v[152:155], v[32:47]
    v_add_u32 v1, -67584, v1
    v_add_u32 v2, -67584, v2
    v_add_u32 v3, -67584, v3
    v_add_u32 v4, -67584, v4
    s_waitcnt lgkmcnt(0)
    s_waitcnt vmcnt(8)
    s_barrier
    ds_read_b64_tr_b16 v[16:17], v1 offset:0
    ds_read_b64_tr_b16 v[18:19], v1 offset:256
    v_mfma_f32_32x32x16_bf16 v[48:63], v[20:23], v[152:155], v[48:63]
    ds_read_b64_tr_b16 v[20:21], v1 offset:64
    ds_read_b64_tr_b16 v[22:23], v1 offset:320
    v_mfma_f32_32x32x16_bf16 v[32:47], v[24:27], v[156:159], v[32:47]
    ds_read_b64_tr_b16 v[24:25], v2 offset:0
    ds_read_b64_tr_b16 v[26:27], v2 offset:256
    v_mfma_f32_32x32x16_bf16 v[48:63], v[28:31], v[156:159], v[48:63]
    ds_read_b64_tr_b16 v[28:29], v2 offset:64
    ds_read_b64_tr_b16 v[30:31], v2 offset:320
    s_waitcnt lgkmcnt(4)
    v_smfmac_f32_16x16x64_bf16 v[104:107], v[6:9], v[16:23], v10
    v_mfma_f32_32x32x16_bf16 v[32:47], v[16:19], v[160:163], v[32:47]
    ds_read_b64_tr_b16 v[16:17], v3 offset:0
    ds_read_b64_tr_b16 v[18:19], v3 offset:256
    v_lshlrev_b32 v152, 4, v0
    v_add_u32 v152, 136192, v152
    v_mfma_f32_32x32x16_bf16 v[48:63], v[20:23], v[160:163], v[48:63]
    ds_read_b64_tr_b16 v[20:21], v3 offset:64
    ds_read_b64_tr_b16 v[22:23], v3 offset:320
    v_lshlrev_b32 v154, 4, v0
    v_mul_f32 v155, s35, v15
    s_waitcnt lgkmcnt(6)
    v_mfma_f32_32x32x16_bf16 v[32:47], v[24:27], v[164:167], v[32:47]
    ds_read_b64_tr_b16 v[24:25], v4 offset:0
    ds_read_b64_tr_b16 v[26:27], v4 offset:256
    s_waitcnt lgkmcnt(6)
    v_mfma_f32_32x32x16_bf16 v[48:63], v[28:31], v[164:167], v[48:63]
    ds_read_b64_tr_b16 v[28:29], v4 offset:64
    ds_read_b64_tr_b16 v[30:31], v4 offset:320
    s_setprio 1
    s_waitcnt lgkmcnt(6)
    v_mfma_f32_32x32x16_bf16 v[32:47], v[16:19], v[168:171], v[32:47]
    ds_read_b64_tr_b16 v[16:17], v1 offset:16896
    ds_read_b64_tr_b16 v[18:19], v1 offset:17152
    v_lshlrev_b32 v108, 4, v0
    v_add_u32 v108, s42, v108
    v_mul_f32 v96, v64, v64
    v_mul_f32 v97, v65, v65
    v_mul_f32 v98, v66, v66
    v_mul_f32 v99, v67, v67
    v_fma_f32 v96, v96, v14, v15
    v_fma_f32 v97, v97, v14, v15
    v_fma_f32 v98, v98, v14, v15
    s_waitcnt lgkmcnt(6)
    v_mfma_f32_32x32x16_bf16 v[48:63], v[20:23], v[168:171], v[48:63]
    ds_read_b64_tr_b16 v[20:21], v1 offset:16960
    ds_read_b64_tr_b16 v[22:23], v1 offset:17216
    v_fma_f32 v99, v99, v14, v15
    v_mul_f32 v96, v96, v64
    v_mul_f32 v97, v97, v65
    v_mul_f32 v98, v98, v66
    v_mul_f32 v99, v99, v67
    v_exp_f32 v96, v96
    v_exp_f32 v97, v97
    s_waitcnt lgkmcnt(6)
    v_mfma_f32_32x32x16_bf16 v[32:47], v[24:27], v[172:175], v[32:47]
    ds_read_b64_tr_b16 v[24:25], v2 offset:16896
    ds_read_b64_tr_b16 v[26:27], v2 offset:17152
    v_exp_f32 v98, v98
    v_exp_f32 v99, v99
    v_fma_f32 v96, v96, v11, v11
    v_fma_f32 v97, v97, v11, v11
    v_fma_f32 v98, v98, v11, v11
    s_waitcnt lgkmcnt(6)
    v_mfma_f32_32x32x16_bf16 v[48:63], v[28:31], v[172:175], v[48:63]
    ds_read_b64_tr_b16 v[28:29], v2 offset:16960
    ds_read_b64_tr_b16 v[30:31], v2 offset:17216
    v_fma_f32 v99, v99, v11, v11
    v_rcp_f32 v96, v96
    v_rcp_f32 v97, v97
    v_rcp_f32 v98, v98
    v_rcp_f32 v99, v99
    s_waitcnt lgkmcnt(4)
    v_smfmac_f32_16x16x64_bf16 v[104:107], v[6:9], v[16:23], v10
    v_mfma_f32_32x32x16_bf16 v[32:47], v[16:19], v[176:179], v[32:47]
    ds_read_b64_tr_b16 v[16:17], v3 offset:16896
    ds_read_b64_tr_b16 v[18:19], v3 offset:17152
    v_mul_f32 v64, v96, v64
    v_mul_f32 v65, v97, v65
    v_mul_f32 v66, v98, v66
    v_mul_f32 v67, v99, v67
    v_mul_f32 v96, v68, v68
    v_mul_f32 v97, v69, v69
    v_mul_f32 v98, v70, v70
    v_mfma_f32_32x32x16_bf16 v[48:63], v[20:23], v[176:179], v[48:63]
    ds_read_b64_tr_b16 v[20:21], v3 offset:16960
    ds_read_b64_tr_b16 v[22:23], v3 offset:17216
    v_mul_f32 v99, v71, v71
    v_fma_f32 v96, v96, v14, v15
    v_fma_f32 v97, v97, v14, v15
    v_fma_f32 v98, v98, v14, v15
    v_fma_f32 v99, v99, v14, v15
    v_mul_f32 v96, v96, v68
    v_mul_f32 v97, v97, v69
    v_mul_f32 v98, v98, v70
    s_waitcnt lgkmcnt(6)
    v_mfma_f32_32x32x16_bf16 v[32:47], v[24:27], v[180:183], v[32:47]
    ds_read_b64_tr_b16 v[24:25], v4 offset:16896
    ds_read_b64_tr_b16 v[26:27], v4 offset:17152
    v_mul_f32 v99, v99, v71
    v_exp_f32 v96, v96
    v_exp_f32 v97, v97
    v_exp_f32 v98, v98
    v_exp_f32 v99, v99
    s_waitcnt lgkmcnt(6)
    v_mfma_f32_32x32x16_bf16 v[48:63], v[28:31], v[180:183], v[48:63]
    ds_read_b64_tr_b16 v[28:29], v4 offset:16960
    ds_read_b64_tr_b16 v[30:31], v4 offset:17216
    v_fma_f32 v96, v96, v11, v11
    v_fma_f32 v97, v97, v11, v11
    v_fma_f32 v98, v98, v11, v11
    v_fma_f32 v99, v99, v11, v11
    v_rcp_f32 v96, v96
    v_rcp_f32 v97, v97
    s_waitcnt lgkmcnt(6)
    v_mfma_f32_32x32x16_bf16 v[32:47], v[16:19], v[184:187], v[32:47]
    v_rcp_f32 v98, v98
    v_rcp_f32 v99, v99
    v_mul_f32 v68, v96, v68
    v_mul_f32 v69, v97, v69
    v_mul_f32 v70, v98, v70
    s_waitcnt lgkmcnt(0)
    s_waitcnt vmcnt(4)
    s_barrier
    ds_read_b64_tr_b16 v[16:17], v1 offset:33792
    ds_read_b64_tr_b16 v[18:19], v1 offset:34048
    v_mfma_f32_32x32x16_bf16 v[48:63], v[20:23], v[184:187], v[48:63]
    ds_read_b64_tr_b16 v[20:21], v1 offset:33856
    ds_read_b64_tr_b16 v[22:23], v1 offset:34112
    v_mul_f32 v71, v99, v71
    v_cvt_pk_bf16_f32 v112, v64, v65
    v_cvt_pk_bf16_f32 v113, v66, v67
    v_cvt_pk_bf16_f32 v114, v68, v69
    v_cvt_pk_bf16_f32 v115, v70, v71
    buffer_store_dwordx4 v[112:115], v108, s[20:23], s40 offen offset:0 sc1
    v_mul_f32 v96, v72, v72
    v_mul_f32 v97, v73, v73
    v_mul_f32 v98, v74, v74
    v_mfma_f32_32x32x16_bf16 v[32:47], v[24:27], v[188:191], v[32:47]
    ds_read_b64_tr_b16 v[24:25], v2 offset:33792
    ds_read_b64_tr_b16 v[26:27], v2 offset:34048
    v_mul_f32 v99, v75, v75
    v_fma_f32 v96, v96, v14, v15
    v_fma_f32 v97, v97, v14, v15
    v_fma_f32 v98, v98, v14, v15
    v_fma_f32 v99, v99, v14, v15
    v_mul_f32 v96, v96, v72
    v_mul_f32 v97, v97, v73
    v_mul_f32 v98, v98, v74
    v_mfma_f32_32x32x16_bf16 v[48:63], v[28:31], v[188:191], v[48:63]
    ds_read_b64_tr_b16 v[28:29], v2 offset:33856
    ds_read_b64_tr_b16 v[30:31], v2 offset:34112
    v_mul_f32 v99, v99, v75
    v_exp_f32 v96, v96
    v_exp_f32 v97, v97
    v_exp_f32 v98, v98
    v_exp_f32 v99, v99
    s_waitcnt lgkmcnt(4)
    v_smfmac_f32_16x16x64_bf16 v[104:107], v[6:9], v[16:23], v10
    v_mfma_f32_32x32x16_bf16 v[32:47], v[16:19], v[192:195], v[32:47]
    ds_read_b64_tr_b16 v[16:17], v3 offset:33792
    ds_read_b64_tr_b16 v[18:19], v3 offset:34048
    v_fma_f32 v96, v96, v11, v11
    v_fma_f32 v97, v97, v11, v11
    v_fma_f32 v98, v98, v11, v11
    v_fma_f32 v99, v99, v11, v11
    v_rcp_f32 v96, v96
    v_rcp_f32 v97, v97
    v_mfma_f32_32x32x16_bf16 v[48:63], v[20:23], v[192:195], v[48:63]
    ds_read_b64_tr_b16 v[20:21], v3 offset:33856
    ds_read_b64_tr_b16 v[22:23], v3 offset:34112
    v_rcp_f32 v98, v98
    v_rcp_f32 v99, v99
    v_mul_f32 v72, v96, v72
    v_mul_f32 v73, v97, v73
    v_mul_f32 v74, v98, v74
    s_waitcnt lgkmcnt(6)
    v_mfma_f32_32x32x16_bf16 v[32:47], v[24:27], v[196:199], v[32:47]
    ds_read_b64_tr_b16 v[24:25], v4 offset:33792
    ds_read_b64_tr_b16 v[26:27], v4 offset:34048
    v_mul_f32 v75, v99, v75
    v_mul_f32 v96, v76, v76
    v_mul_f32 v97, v77, v77
    v_mul_f32 v98, v78, v78
    v_mul_f32 v99, v79, v79
    v_fma_f32 v96, v96, v14, v15
    v_fma_f32 v97, v97, v14, v15
    v_fma_f32 v98, v98, v14, v15
    s_waitcnt lgkmcnt(6)
    v_mfma_f32_32x32x16_bf16 v[48:63], v[28:31], v[196:199], v[48:63]
    ds_read_b64_tr_b16 v[28:29], v4 offset:33856
    ds_read_b64_tr_b16 v[30:31], v4 offset:34112
    v_fma_f32 v99, v99, v14, v15
    v_mul_f32 v96, v96, v76
    v_mul_f32 v97, v97, v77
    v_mul_f32 v98, v98, v78
    v_mul_f32 v99, v99, v79
    v_exp_f32 v96, v96
    v_exp_f32 v97, v97
    s_waitcnt lgkmcnt(6)
    v_mfma_f32_32x32x16_bf16 v[32:47], v[16:19], v[200:203], v[32:47]
    ds_read_b64_tr_b16 v[16:17], v1 offset:50688
    ds_read_b64_tr_b16 v[18:19], v1 offset:50944
    v_exp_f32 v98, v98
    v_exp_f32 v99, v99
    v_fma_f32 v96, v96, v11, v11
    v_fma_f32 v97, v97, v11, v11
    v_fma_f32 v98, v98, v11, v11
    v_fma_f32 v99, v99, v11, v11
    s_waitcnt lgkmcnt(6)
    v_mfma_f32_32x32x16_bf16 v[48:63], v[20:23], v[200:203], v[48:63]
    ds_read_b64_tr_b16 v[20:21], v1 offset:50752
    ds_read_b64_tr_b16 v[22:23], v1 offset:51008
    v_rcp_f32 v96, v96
    v_rcp_f32 v97, v97
    v_rcp_f32 v98, v98
    v_rcp_f32 v99, v99
    s_waitcnt lgkmcnt(6)
    v_mfma_f32_32x32x16_bf16 v[32:47], v[24:27], v[204:207], v[32:47]
    ds_read_b64_tr_b16 v[24:25], v2 offset:50688
    ds_read_b64_tr_b16 v[26:27], v2 offset:50944
    v_mul_f32 v76, v96, v76
    v_mul_f32 v77, v97, v77
    v_mul_f32 v78, v98, v78
    v_mul_f32 v79, v99, v79
    v_cvt_pk_bf16_f32 v116, v72, v73
    v_cvt_pk_bf16_f32 v117, v74, v75
    v_cvt_pk_bf16_f32 v118, v76, v77
    v_cvt_pk_bf16_f32 v119, v78, v79
    s_waitcnt lgkmcnt(6)
    v_mfma_f32_32x32x16_bf16 v[48:63], v[28:31], v[204:207], v[48:63]
    ds_read_b64_tr_b16 v[28:29], v2 offset:50752
    ds_read_b64_tr_b16 v[30:31], v2 offset:51008
    buffer_store_dwordx4 v[116:119], v108, s[20:23], s40 offen offset:1024 sc1
    v_mul_f32 v96, v80, v80
    v_mul_f32 v97, v81, v81
    v_mul_f32 v98, v82, v82
    v_mul_f32 v99, v83, v83
    v_fma_f32 v96, v96, v14, v15
    v_fma_f32 v97, v97, v14, v15
    v_fma_f32 v98, v98, v14, v15
    v_fma_f32 v99, v99, v14, v15
    s_waitcnt lgkmcnt(4)
    v_smfmac_f32_16x16x64_bf16 v[104:107], v[6:9], v[16:23], v10
    v_mfma_f32_32x32x16_bf16 v[32:47], v[16:19], v[208:211], v[32:47]
    ds_read_b64_tr_b16 v[16:17], v3 offset:50688
    ds_read_b64_tr_b16 v[18:19], v3 offset:50944
    v_mul_f32 v96, v96, v80
    v_mul_f32 v97, v97, v81
    v_mul_f32 v98, v98, v82
    v_mul_f32 v99, v99, v83
    v_exp_f32 v96, v96
    v_exp_f32 v97, v97
    v_mfma_f32_32x32x16_bf16 v[48:63], v[20:23], v[208:211], v[48:63]
    ds_read_b64_tr_b16 v[20:21], v3 offset:50752
    ds_read_b64_tr_b16 v[22:23], v3 offset:51008
    v_exp_f32 v98, v98
    v_exp_f32 v99, v99
    v_fma_f32 v96, v96, v11, v11
    v_fma_f32 v97, v97, v11, v11
    v_fma_f32 v98, v98, v11, v11
    v_fma_f32 v99, v99, v11, v11
    s_waitcnt lgkmcnt(6)
    v_mfma_f32_32x32x16_bf16 v[32:47], v[24:27], v[212:215], v[32:47]
    ds_read_b64_tr_b16 v[24:25], v4 offset:50688
    ds_read_b64_tr_b16 v[26:27], v4 offset:50944
    v_rcp_f32 v96, v96
    v_rcp_f32 v97, v97
    v_rcp_f32 v98, v98
    v_rcp_f32 v99, v99
    s_waitcnt lgkmcnt(6)
    v_mfma_f32_32x32x16_bf16 v[48:63], v[28:31], v[212:215], v[48:63]
    ds_read_b64_tr_b16 v[28:29], v4 offset:50752
    ds_read_b64_tr_b16 v[30:31], v4 offset:51008
    v_mul_f32 v80, v96, v80
    v_mul_f32 v81, v97, v81
    v_mul_f32 v82, v98, v82
    v_mul_f32 v83, v99, v83
    v_mul_f32 v96, v84, v84
    v_mul_f32 v97, v85, v85
    v_mul_f32 v98, v86, v86
    v_mul_f32 v99, v87, v87
    s_waitcnt lgkmcnt(6)
    v_mfma_f32_32x32x16_bf16 v[32:47], v[16:19], v[216:219], v[32:47]
    v_fma_f32 v96, v96, v14, v15
    v_fma_f32 v97, v97, v14, v15
    v_fma_f32 v98, v98, v14, v15
    v_fma_f32 v99, v99, v14, v15
    v_mul_f32 v96, v96, v84
    v_mul_f32 v97, v97, v85
    v_mul_f32 v98, v98, v86
    v_mul_f32 v99, v99, v87
    v_add_u32 v1, 67584, v1
    v_add_u32 v2, 67584, v2
    v_add_u32 v3, 67584, v3
    v_add_u32 v4, 67584, v4
    s_waitcnt lgkmcnt(0)
    s_waitcnt vmcnt(2)
    s_barrier
    ds_read_b64_tr_b16 v[16:17], v1 offset:0
    ds_read_b64_tr_b16 v[18:19], v1 offset:256
    v_mfma_f32_32x32x16_bf16 v[48:63], v[20:23], v[216:219], v[48:63]
    ds_read_b64_tr_b16 v[20:21], v1 offset:64
    ds_read_b64_tr_b16 v[22:23], v1 offset:320
    v_exp_f32 v96, v96
    v_exp_f32 v97, v97
    v_exp_f32 v98, v98
    v_exp_f32 v99, v99
    v_mfma_f32_32x32x16_bf16 v[32:47], v[24:27], v[220:223], v[32:47]
    ds_read_b64_tr_b16 v[24:25], v2 offset:0
    ds_read_b64_tr_b16 v[26:27], v2 offset:256
    v_fma_f32 v96, v96, v11, v11
    v_fma_f32 v97, v97, v11, v11
    v_fma_f32 v98, v98, v11, v11
    v_fma_f32 v99, v99, v11, v11
    v_rcp_f32 v96, v96
    v_rcp_f32 v97, v97
    v_mfma_f32_32x32x16_bf16 v[48:63], v[28:31], v[220:223], v[48:63]
    ds_read_b64_tr_b16 v[28:29], v2 offset:64
    ds_read_b64_tr_b16 v[30:31], v2 offset:320
    v_rcp_f32 v98, v98
    v_rcp_f32 v99, v99
    v_mul_f32 v84, v96, v84
    v_mul_f32 v85, v97, v85
    v_mul_f32 v86, v98, v86
    v_mul_f32 v87, v99, v87
    s_waitcnt lgkmcnt(4)
    v_smfmac_f32_16x16x64_bf16 v[104:107], v[6:9], v[16:23], v10
    v_mfma_f32_32x32x16_bf16 v[32:47], v[16:19], v[224:227], v[32:47]
    ds_read_b64_tr_b16 v[16:17], v3 offset:0
    ds_read_b64_tr_b16 v[18:19], v3 offset:256
    v_cvt_pk_bf16_f32 v112, v80, v81
    v_cvt_pk_bf16_f32 v113, v82, v83
    v_cvt_pk_bf16_f32 v114, v84, v85
    v_cvt_pk_bf16_f32 v115, v86, v87
    buffer_store_dwordx4 v[112:115], v108, s[20:23], s40 offen offset:2048 sc1
    v_mul_f32 v96, v88, v88
    v_mul_f32 v97, v89, v89
    v_mul_f32 v98, v90, v90
    v_mul_f32 v99, v91, v91
    v_mfma_f32_32x32x16_bf16 v[48:63], v[20:23], v[224:227], v[48:63]
    ds_read_b64_tr_b16 v[20:21], v3 offset:64
    ds_read_b64_tr_b16 v[22:23], v3 offset:320
    v_fma_f32 v96, v96, v14, v15
    v_fma_f32 v97, v97, v14, v15
    v_fma_f32 v98, v98, v14, v15
    v_fma_f32 v99, v99, v14, v15
    v_mul_f32 v96, v96, v88
    v_mul_f32 v97, v97, v89
    v_mul_f32 v98, v98, v90
    v_mul_f32 v99, v99, v91
    s_waitcnt lgkmcnt(6)
    v_mfma_f32_32x32x16_bf16 v[32:47], v[24:27], v[228:231], v[32:47]
    ds_read_b64_tr_b16 v[24:25], v4 offset:0
    ds_read_b64_tr_b16 v[26:27], v4 offset:256
    v_exp_f32 v96, v96
    v_exp_f32 v97, v97
    v_exp_f32 v98, v98
    v_exp_f32 v99, v99
    s_waitcnt lgkmcnt(6)
    v_mfma_f32_32x32x16_bf16 v[48:63], v[28:31], v[228:231], v[48:63]
    ds_read_b64_tr_b16 v[28:29], v4 offset:64
    ds_read_b64_tr_b16 v[30:31], v4 offset:320
    v_fma_f32 v96, v96, v11, v11
    v_fma_f32 v97, v97, v11, v11
    v_fma_f32 v98, v98, v11, v11
    v_fma_f32 v99, v99, v11, v11
    v_rcp_f32 v96, v96
    v_rcp_f32 v97, v97
    s_waitcnt lgkmcnt(6)
    v_mfma_f32_32x32x16_bf16 v[32:47], v[16:19], v[232:235], v[32:47]
    ds_read_b64_tr_b16 v[16:17], v1 offset:16896
    ds_read_b64_tr_b16 v[18:19], v1 offset:17152
    v_rcp_f32 v98, v98
    v_rcp_f32 v99, v99
    v_mul_f32 v88, v96, v88
    v_mul_f32 v89, v97, v89
    v_mul_f32 v90, v98, v90
    v_mul_f32 v91, v99, v91
    s_waitcnt lgkmcnt(6)
    v_mfma_f32_32x32x16_bf16 v[48:63], v[20:23], v[232:235], v[48:63]
    ds_read_b64_tr_b16 v[20:21], v1 offset:16960
    ds_read_b64_tr_b16 v[22:23], v1 offset:17216
    v_mul_f32 v96, v92, v92
    v_mul_f32 v97, v93, v93
    v_mul_f32 v98, v94, v94
    v_mul_f32 v99, v95, v95
    v_fma_f32 v96, v96, v14, v15
    v_fma_f32 v97, v97, v14, v15
    v_fma_f32 v98, v98, v14, v15
    v_fma_f32 v99, v99, v14, v15
    s_waitcnt lgkmcnt(6)
    v_mfma_f32_32x32x16_bf16 v[32:47], v[24:27], v[236:239], v[32:47]
    ds_read_b64_tr_b16 v[24:25], v2 offset:16896
    ds_read_b64_tr_b16 v[26:27], v2 offset:17152
    v_mul_f32 v96, v96, v92
    v_mul_f32 v97, v97, v93
    v_mul_f32 v98, v98, v94
    v_mul_f32 v99, v99, v95
    v_exp_f32 v96, v96
    v_exp_f32 v97, v97
    v_exp_f32 v98, v98
    s_waitcnt lgkmcnt(6)
    v_mfma_f32_32x32x16_bf16 v[48:63], v[28:31], v[236:239], v[48:63]
    ds_read_b64_tr_b16 v[28:29], v2 offset:16960
    ds_read_b64_tr_b16 v[30:31], v2 offset:17216
    v_exp_f32 v99, v99
    v_fma_f32 v96, v96, v11, v11
    v_fma_f32 v97, v97, v11, v11
    v_fma_f32 v98, v98, v11, v11
    v_fma_f32 v99, v99, v11, v11
    v_rcp_f32 v96, v96
    s_waitcnt lgkmcnt(4)
    v_smfmac_f32_16x16x64_bf16 v[104:107], v[6:9], v[16:23], v10
    v_mfma_f32_32x32x16_bf16 v[32:47], v[16:19], v[240:243], v[32:47]
    ds_read_b64_tr_b16 v[16:17], v3 offset:16896
    ds_read_b64_tr_b16 v[18:19], v3 offset:17152
    v_rcp_f32 v97, v97
    v_rcp_f32 v98, v98
    v_rcp_f32 v99, v99
    v_mul_f32 v92, v96, v92
    v_mfma_f32_32x32x16_bf16 v[48:63], v[20:23], v[240:243], v[48:63]
    ds_read_b64_tr_b16 v[20:21], v3 offset:16960
    ds_read_b64_tr_b16 v[22:23], v3 offset:17216
    v_mul_f32 v93, v97, v93
    v_mul_f32 v94, v98, v94
    v_mul_f32 v95, v99, v95
    v_cvt_pk_bf16_f32 v116, v88, v89
    v_cvt_pk_bf16_f32 v117, v90, v91
    v_cvt_pk_bf16_f32 v118, v92, v93
    v_cvt_pk_bf16_f32 v119, v94, v95
    buffer_store_dwordx4 v[116:119], v108, s[20:23], s40 offen offset:3072 sc1
    s_setprio 0
    s_waitcnt lgkmcnt(6)
    v_mfma_f32_32x32x16_bf16 v[32:47], v[24:27], v[244:247], v[32:47]
    ds_read_b64_tr_b16 v[24:25], v4 offset:16896
    ds_read_b64_tr_b16 v[26:27], v4 offset:17152
    s_waitcnt lgkmcnt(6)
    v_mfma_f32_32x32x16_bf16 v[48:63], v[28:31], v[244:247], v[48:63]
    ds_read_b64_tr_b16 v[28:29], v4 offset:16960
    ds_read_b64_tr_b16 v[30:31], v4 offset:17216
    s_lshl_b32 s47, s31, 2
    v_add_u32 v153, s47, v152
    v_add_f32 v104, v104, v105
    ds_write_b32 v153, v104 offset:4096
    s_waitcnt lgkmcnt(7)
    v_mfma_f32_32x32x16_bf16 v[32:47], v[16:19], v[248:251], v[32:47]
    s_waitcnt lgkmcnt(0)
    s_barrier
    ds_read_b128 v[144:147], v152 offset:4096
    v_mfma_f32_32x32x16_bf16 v[48:63], v[20:23], v[248:251], v[48:63]
    v_mfma_f32_32x32x16_bf16 v[32:47], v[24:27], v[252:255], v[32:47]
    s_waitcnt lgkmcnt(0)
    v_add_f32 v144, v144, v145
    v_add_f32 v146, v146, v147
    v_add_f32 v144, v144, v146
    v_cvt_pk_bf16_f32 v145, v144, v144
    v_and_b32 v145, s55, v145
    v_sub_f32 v146, v144, v145
    v_cvt_pk_bf16_f32 v148, v144, v146
    v_mfma_f32_32x32x16_bf16 v[48:63], v[28:31], v[252:255], v[48:63]
    v_and_b32 v145, s55, v148
    v_sub_f32 v146, v146, v145
    v_cvt_pk_bf16_f32 v150, v146, v144
    s_nop 1
    v_permlane32_swap_b32 v148, v150
    v_mov_b32 v149, v148
    v_mov_b32 v151, v150
    s_nop 0
    v_mfma_f32_32x32x8bf16_1k v[32:47], v[148:149], v[12:13], v[32:47]
    v_mfma_f32_32x32x8bf16_1k v[48:63], v[150:151], v[12:13], v[48:63]
    s_nop 10
    v_mul_f32 v32, v155, v32
    v_mul_f32 v33, v155, v33
    v_mul_f32 v34, v155, v34
    v_mul_f32 v35, v155, v35
    v_mul_f32 v36, v155, v36
    v_mul_f32 v37, v155, v37
    v_mul_f32 v38, v155, v38
    v_mul_f32 v39, v155, v39
    v_cvt_pk_bf16_f32 v160, v32, v33
    v_cvt_pk_bf16_f32 v161, v34, v35
    v_cvt_pk_bf16_f32 v162, v36, v37
    v_cvt_pk_bf16_f32 v163, v38, v39
    buffer_store_dwordx4 v[160:163], v154, s[20:23], s41 offen offset:0 sc1
    v_mul_f32 v40, v155, v40
    v_mul_f32 v41, v155, v41
    v_mul_f32 v42, v155, v42
    v_mul_f32 v43, v155, v43
    v_mul_f32 v44, v155, v44
    v_mul_f32 v45, v155, v45
    v_mul_f32 v46, v155, v46
    v_mul_f32 v47, v155, v47
    v_cvt_pk_bf16_f32 v164, v40, v41
    v_cvt_pk_bf16_f32 v165, v42, v43
    v_cvt_pk_bf16_f32 v166, v44, v45
    v_cvt_pk_bf16_f32 v167, v46, v47
    buffer_store_dwordx4 v[164:167], v154, s[20:23], s41 offen offset:1024 sc1
    v_mul_f32 v48, v155, v48
    v_mul_f32 v49, v155, v49
    v_mul_f32 v50, v155, v50
    v_mul_f32 v51, v155, v51
    v_mul_f32 v52, v155, v52
    v_mul_f32 v53, v155, v53
    v_mul_f32 v54, v155, v54
    v_mul_f32 v55, v155, v55
    v_cvt_pk_bf16_f32 v168, v48, v49
    v_cvt_pk_bf16_f32 v169, v50, v51
    v_cvt_pk_bf16_f32 v170, v52, v53
    v_cvt_pk_bf16_f32 v171, v54, v55
    buffer_store_dwordx4 v[168:171], v154, s[20:23], s41 offen offset:2048 sc1
    v_mul_f32 v56, v155, v56
    v_mul_f32 v57, v155, v57
    v_mul_f32 v58, v155, v58
    v_mul_f32 v59, v155, v59
    v_mul_f32 v60, v155, v60
    v_mul_f32 v61, v155, v61
    v_mul_f32 v62, v155, v62
    v_mul_f32 v63, v155, v63
    v_cvt_pk_bf16_f32 v172, v56, v57
    v_cvt_pk_bf16_f32 v173, v58, v59
    v_cvt_pk_bf16_f32 v174, v60, v61
    v_cvt_pk_bf16_f32 v175, v62, v63
    buffer_store_dwordx4 v[172:175], v154, s[20:23], s41 offen offset:3072 sc1
    s_endpgm
K1_WT:
    s_load_dwordx2 s[8:9], s[0:1], 16
    s_load_dwordx2 s[10:11], s[0:1], 56
    s_mul_i32 s47, s30, 5120
    v_lshlrev_b32 v1, 4, v0
    v_add_u32 v2, s47, v1
    s_mov_b32 s27, 0x00020000
    s_waitcnt lgkmcnt(0)
    s_mul_i32 s33, s28, 3
    s_add_u32 s33, s33, 0
    s_min_u32 s33, s33, 46
    s_cmp_lt_u32 s33, 20
    s_mov_b32 s26, 1105920
    s_cmov_b32 s26, 819200
    s_cselect_b32 s24, s8, s10
    s_cselect_b32 s25, s9, s11
    s_cselect_b32 s48, 0, 20
    s_sub_u32 s48, s33, s48
    s_mul_i32 s48, s48, 40960
    s_add_u32 m0, s47, 0
    s_nop 0
    buffer_load_dwordx4 v2, s[24:27], s48 offen offset:0 lds
    buffer_load_dwordx4 v2, s[24:27], s48 offen offset:1024 lds
    buffer_load_dwordx4 v2, s[24:27], s48 offen offset:2048 lds
    buffer_load_dwordx4 v2, s[24:27], s48 offen offset:3072 lds
    s_add_u32 s48, s48, 4096
    s_add_u32 m0, s47, 4096
    s_nop 0
    buffer_load_dwordx4 v2, s[24:27], s48 offen lds
    s_mul_i32 s34, s28, 3
    s_add_u32 s34, s34, 1
    s_min_u32 s34, s34, 46
    s_cmp_lt_u32 s34, 20
    s_mov_b32 s26, 1105920
    s_cmov_b32 s26, 819200
    s_cselect_b32 s24, s8, s10
    s_cselect_b32 s25, s9, s11
    s_cselect_b32 s48, 0, 20
    s_sub_u32 s48, s34, s48
    s_mul_i32 s48, s48, 40960
    s_add_u32 m0, s47, 40960
    s_nop 0
    buffer_load_dwordx4 v2, s[24:27], s48 offen offset:0 lds
    buffer_load_dwordx4 v2, s[24:27], s48 offen offset:1024 lds
    buffer_load_dwordx4 v2, s[24:27], s48 offen offset:2048 lds
    buffer_load_dwordx4 v2, s[24:27], s48 offen offset:3072 lds
    s_add_u32 s48, s48, 4096
    s_add_u32 m0, s47, 45056
    s_nop 0
    buffer_load_dwordx4 v2, s[24:27], s48 offen lds
    s_mul_i32 s35, s28, 3
    s_add_u32 s35, s35, 2
    s_min_u32 s35, s35, 46
    s_cmp_lt_u32 s35, 20
    s_mov_b32 s26, 1105920
    s_cmov_b32 s26, 819200
    s_cselect_b32 s24, s8, s10
    s_cselect_b32 s25, s9, s11
    s_cselect_b32 s48, 0, 20
    s_sub_u32 s48, s35, s48
    s_mul_i32 s48, s48, 40960
    s_add_u32 m0, s47, 81920
    s_nop 0
    buffer_load_dwordx4 v2, s[24:27], s48 offen offset:0 lds
    buffer_load_dwordx4 v2, s[24:27], s48 offen offset:1024 lds
    buffer_load_dwordx4 v2, s[24:27], s48 offen offset:2048 lds
    buffer_load_dwordx4 v2, s[24:27], s48 offen offset:3072 lds
    s_add_u32 s48, s48, 4096
    s_add_u32 m0, s47, 86016
    s_nop 0
    buffer_load_dwordx4 v2, s[24:27], s48 offen lds
    v_lshrrev_b32 v3, 4, v0
    v_bfe_u32 v4, v0, 2, 2
    v_lshl_add_u32 v3, v3, 3, v4
    v_mul_u32_u24 v3, 1280, v3
    v_and_b32 v4, 3, v0
    s_mul_i32 s48, s30, 160
    s_bitcmp1_b32 s30, 0
    s_cselect_b32 s49, 32, 0
    s_cselect_b32 s50, 0, 128
    s_add_u32 s49, s49, s48
    s_add_u32 s50, s50, s48
    v_lshl_add_u32 v5, v4, 4, v3
    v_lshl_add_u32 v6, v4, 3, v3
    v_add_u32 v5, s49, v5
    v_add_u32 v6, s50, v6
    s_lshl_b32 s47, s28, 3
    s_add_u32 s47, s47, s30
    s_lshl_b32 s47, s47, 9
    s_add_u32 s47, s47, 14946304
    v_lshlrev_b32 v7, 3, v0
    v_mov_b32 v8, 0
    v_mov_b32 v9, 0
    buffer_store_dwordx2 v[8:9], v7, s[20:23], s47 offen sc1
    s_lshl_b32 s47, s28, 3
    s_add_u32 s47, s47, s30
    s_mul_i32 s47, s47, 48128
    s_add_u32 s47, s47, 16515072
    v_mov_b32 v12, -1
    v_mov_b32 v13, -1
    v_mov_b32 v14, -1
    v_mov_b32 v15, -1
    buffer_store_dwordx4 v[12:15], v1, s[20:23], s47 offen offset:0 sc1
    buffer_store_dwordx4 v[12:15], v1, s[20:23], s47 offen offset:1024 sc1
    buffer_store_dwordx4 v[12:15], v1, s[20:23], s47 offen offset:2048 sc1
    buffer_store_dwordx4 v[12:15], v1, s[20:23], s47 offen offset:3072 sc1
    s_add_u32 s47, s47, 4096
    buffer_store_dwordx4 v[12:15], v1, s[20:23], s47 offen offset:0 sc1
    buffer_store_dwordx4 v[12:15], v1, s[20:23], s47 offen offset:1024 sc1
    buffer_store_dwordx4 v[12:15], v1, s[20:23], s47 offen offset:2048 sc1
    buffer_store_dwordx4 v[12:15], v1, s[20:23], s47 offen offset:3072 sc1
    s_add_u32 s47, s47, 4096
    buffer_store_dwordx4 v[12:15], v1, s[20:23], s47 offen offset:0 sc1
    buffer_store_dwordx4 v[12:15], v1, s[20:23], s47 offen offset:1024 sc1
    buffer_store_dwordx4 v[12:15], v1, s[20:23], s47 offen offset:2048 sc1
    buffer_store_dwordx4 v[12:15], v1, s[20:23], s47 offen offset:3072 sc1
    s_add_u32 s47, s47, 4096
    buffer_store_dwordx4 v[12:15], v1, s[20:23], s47 offen offset:0 sc1
    buffer_store_dwordx4 v[12:15], v1, s[20:23], s47 offen offset:1024 sc1
    buffer_store_dwordx4 v[12:15], v1, s[20:23], s47 offen offset:2048 sc1
    buffer_store_dwordx4 v[12:15], v1, s[20:23], s47 offen offset:3072 sc1
    s_add_u32 s47, s47, 4096
    buffer_store_dwordx4 v[12:15], v1, s[20:23], s47 offen offset:0 sc1
    buffer_store_dwordx4 v[12:15], v1, s[20:23], s47 offen offset:1024 sc1
    buffer_store_dwordx4 v[12:15], v1, s[20:23], s47 offen offset:2048 sc1
    buffer_store_dwordx4 v[12:15], v1, s[20:23], s47 offen offset:3072 sc1
    s_add_u32 s47, s47, 4096
    buffer_store_dwordx4 v[12:15], v1, s[20:23], s47 offen offset:0 sc1
    buffer_store_dwordx4 v[12:15], v1, s[20:23], s47 offen offset:1024 sc1
    buffer_store_dwordx4 v[12:15], v1, s[20:23], s47 offen offset:2048 sc1
    buffer_store_dwordx4 v[12:15], v1, s[20:23], s47 offen offset:3072 sc1
    s_add_u32 s47, s47, 4096
    buffer_store_dwordx4 v[12:15], v1, s[20:23], s47 offen offset:0 sc1
    buffer_store_dwordx4 v[12:15], v1, s[20:23], s47 offen offset:1024 sc1
    buffer_store_dwordx4 v[12:15], v1, s[20:23], s47 offen offset:2048 sc1
    buffer_store_dwordx4 v[12:15], v1, s[20:23], s47 offen offset:3072 sc1
    s_add_u32 s47, s47, 4096
    buffer_store_dwordx4 v[12:15], v1, s[20:23], s47 offen offset:0 sc1
    buffer_store_dwordx4 v[12:15], v1, s[20:23], s47 offen offset:1024 sc1
    buffer_store_dwordx4 v[12:15], v1, s[20:23], s47 offen offset:2048 sc1
    buffer_store_dwordx4 v[12:15], v1, s[20:23], s47 offen offset:3072 sc1
    s_add_u32 s47, s47, 4096
    buffer_store_dwordx4 v[12:15], v1, s[20:23], s47 offen offset:0 sc1
    buffer_store_dwordx4 v[12:15], v1, s[20:23], s47 offen offset:1024 sc1
    buffer_store_dwordx4 v[12:15], v1, s[20:23], s47 offen offset:2048 sc1
    buffer_store_dwordx4 v[12:15], v1, s[20:23], s47 offen offset:3072 sc1
    s_add_u32 s47, s47, 4096
    buffer_store_dwordx4 v[12:15], v1, s[20:23], s47 offen offset:0 sc1
    buffer_store_dwordx4 v[12:15], v1, s[20:23], s47 offen offset:1024 sc1
    buffer_store_dwordx4 v[12:15], v1, s[20:23], s47 offen offset:2048 sc1
    buffer_store_dwordx4 v[12:15], v1, s[20:23], s47 offen offset:3072 sc1
    s_add_u32 s47, s47, 4096
    buffer_store_dwordx4 v[12:15], v1, s[20:23], s47 offen offset:0 sc1
    buffer_store_dwordx4 v[12:15], v1, s[20:23], s47 offen offset:1024 sc1
    buffer_store_dwordx4 v[12:15], v1, s[20:23], s47 offen offset:2048 sc1
    buffer_store_dwordx4 v[12:15], v1, s[20:23], s47 offen offset:3072 sc1
    s_add_u32 s47, s47, 4096
    buffer_store_dwordx4 v[12:15], v1, s[20:23], s47 offen offset:0 sc1
    buffer_store_dwordx4 v[12:15], v1, s[20:23], s47 offen offset:1024 sc1
    buffer_store_dwordx4 v[12:15], v1, s[20:23], s47 offen offset:2048 sc1
    s_mul_i32 s47, s30, 240640
    s_add_u32 s47, s47, 22937600
    s_waitcnt vmcnt(47)
    s_barrier
    ds_read_b64_tr_b16 v[16:17], v5 offset:0
    ds_read_b64_tr_b16 v[18:19], v5 offset:5120
    ds_read_b64_tr_b16 v[20:21], v5 offset:8
    ds_read_b64_tr_b16 v[22:23], v5 offset:5128
    ds_read_b64_tr_b16 v[24:25], v5 offset:64
    ds_read_b64_tr_b16 v[26:27], v5 offset:5184
    ds_read_b64_tr_b16 v[28:29], v5 offset:72
    ds_read_b64_tr_b16 v[30:31], v5 offset:5192
    ds_read_b64_tr_b16 v[32:33], v6 offset:0
    ds_read_b64_tr_b16 v[34:35], v6 offset:5120
    s_mul_i32 s48, s33, 5120
    s_add_u32 s48, s48, s47
    s_add_u32 s49, s48, 4096
    s_waitcnt lgkmcnt(8)
    buffer_store_dwordx4 v[16:19], v1, s[20:23], s48 offen offset:0 sc1
    s_waitcnt lgkmcnt(6)
    buffer_store_dwordx4 v[20:23], v1, s[20:23], s48 offen offset:1024 sc1
    s_waitcnt lgkmcnt(4)
    buffer_store_dwordx4 v[24:27], v1, s[20:23], s48 offen offset:2048 sc1
    s_waitcnt lgkmcnt(2)
    buffer_store_dwordx4 v[28:31], v1, s[20:23], s48 offen offset:3072 sc1
    s_waitcnt lgkmcnt(0)
    buffer_store_dwordx4 v[32:35], v1, s[20:23], s49 offen offset:0 sc1
    v_add_u32 v5, 40960, v5
    v_add_u32 v6, 40960, v6
    ds_read_b64_tr_b16 v[36:37], v5 offset:0
    ds_read_b64_tr_b16 v[38:39], v5 offset:5120
    ds_read_b64_tr_b16 v[40:41], v5 offset:8
    ds_read_b64_tr_b16 v[42:43], v5 offset:5128
    ds_read_b64_tr_b16 v[44:45], v5 offset:64
    ds_read_b64_tr_b16 v[46:47], v5 offset:5184
    ds_read_b64_tr_b16 v[48:49], v5 offset:72
    ds_read_b64_tr_b16 v[50:51], v5 offset:5192
    ds_read_b64_tr_b16 v[52:53], v6 offset:0
    ds_read_b64_tr_b16 v[54:55], v6 offset:5120
    s_mul_i32 s48, s34, 5120
    s_add_u32 s48, s48, s47
    s_add_u32 s49, s48, 4096
    s_waitcnt lgkmcnt(8)
    buffer_store_dwordx4 v[36:39], v1, s[20:23], s48 offen offset:0 sc1
    s_waitcnt lgkmcnt(6)
    buffer_store_dwordx4 v[40:43], v1, s[20:23], s48 offen offset:1024 sc1
    s_waitcnt lgkmcnt(4)
    buffer_store_dwordx4 v[44:47], v1, s[20:23], s48 offen offset:2048 sc1
    s_waitcnt lgkmcnt(2)
    buffer_store_dwordx4 v[48:51], v1, s[20:23], s48 offen offset:3072 sc1
    s_waitcnt lgkmcnt(0)
    buffer_store_dwordx4 v[52:55], v1, s[20:23], s49 offen offset:0 sc1
    v_add_u32 v5, 40960, v5
    v_add_u32 v6, 40960, v6
    ds_read_b64_tr_b16 v[56:57], v5 offset:0
    ds_read_b64_tr_b16 v[58:59], v5 offset:5120
    ds_read_b64_tr_b16 v[60:61], v5 offset:8
    ds_read_b64_tr_b16 v[62:63], v5 offset:5128
    ds_read_b64_tr_b16 v[64:65], v5 offset:64
    ds_read_b64_tr_b16 v[66:67], v5 offset:5184
    ds_read_b64_tr_b16 v[68:69], v5 offset:72
    ds_read_b64_tr_b16 v[70:71], v5 offset:5192
    ds_read_b64_tr_b16 v[72:73], v6 offset:0
    ds_read_b64_tr_b16 v[74:75], v6 offset:5120
    s_mul_i32 s48, s35, 5120
    s_add_u32 s48, s48, s47
    s_add_u32 s49, s48, 4096
    s_waitcnt lgkmcnt(8)
    buffer_store_dwordx4 v[56:59], v1, s[20:23], s48 offen offset:0 sc1
    s_waitcnt lgkmcnt(6)
    buffer_store_dwordx4 v[60:63], v1, s[20:23], s48 offen offset:1024 sc1
    s_waitcnt lgkmcnt(4)
    buffer_store_dwordx4 v[64:67], v1, s[20:23], s48 offen offset:2048 sc1
    s_waitcnt lgkmcnt(2)
    buffer_store_dwordx4 v[68:71], v1, s[20:23], s48 offen offset:3072 sc1
    s_waitcnt lgkmcnt(0)
    buffer_store_dwordx4 v[72:75], v1, s[20:23], s49 offen offset:0 sc1
    s_endpgm
K1_END:
    s_endpgm
.globl k23_kernel
.p2align 8
.type k23_kernel,@function
k23_kernel:
    s_cmp_ge_u32 s2, 256
    s_cbranch_scc1 K2_END
    s_mov_b32 s54, s2
    s_movk_i32 s55, 400
K2_TOP:
    s_mov_b32 s50, 7917568
    s_mov_b64 s[48:49], -1
K2_GO:
    s_load_dwordx2 s[8:9], s[0:1], 80
    s_load_dwordx4 s[12:15], s[0:1], 40
    v_lshrrev_b32 v1, 6, v0
    v_and_b32 v0, 63, v0
    v_readfirstlane_b32 s20, v1
    s_and_b32 s31, s2, 7
    s_lshr_b32 s32, s2, 3
    s_lshl_b32 s22, s31, 2
    s_lshr_b32 s33, s32, 3
    s_add_u32 s22, s22, s33
    s_and_b32 s23, s32, 7
    s_lshl_b32 s24, s31, 1
    s_and_b32 s33, s32, 1
    s_add_u32 s24, s24, s33
    s_lshr_b32 s25, s32, 1
    s_and_b32 s21, s20, 3
    s_lshl_b32 s26, s20, 12
    s_lshr_b32 s39, s22, 1
    s_mul_i32 s39, s39, 2560
    s_and_b32 s51, s22, 1
    s_lshl_b32 s31, s23, 2
    s_add_u32 s31, s31, s21
    s_mul_i32 s40, s31, 245760
    s_add_u32 s40, s40, s39
    s_add_u32 s39, s39, 40960
    s_add_u32 s52, s40, 122880
    s_add_u32 s53, s39, 122880
    s_mul_i32 s31, s51, 1536
    s_lshl_b32 s32, s51, 3
    s_mov_b32 s33, 14942208
    s_mov_b32 s36, 0
    s_mov_b32 s37, -1
    s_mov_b32 s10, 31940608
    s_mov_b32 s11, 0x00020000
    v_lshlrev_b32 v6, 4, v0
    v_and_b32 v9, 31, v0
    v_lshrrev_b32 v10, 5, v0
    v_mov_b32 v11, 2130706432
    v_add_u32 v7, s31, v6
    v_add_u32 v8, s32, v6
    v_cndmask_b32 v8, v8, v11, s[36:37]
    v_cmp_gt_u32 vcc, 56, v0
    s_nop 1
    v_cndmask_b32 v12, v11, v6, vcc
    s_waitcnt lgkmcnt(0)
    buffer_load_dwordx4 v[112:115], v7, s[8:11], s40 offen
    buffer_load_dwordx4 v[124:127], v7, s[8:11], s39 offen
    buffer_load_dwordx4 v[116:119], v7, s[8:11], s52 offen
    buffer_load_dwordx4 v[132:135], v7, s[8:11], s53 offen
    buffer_load_dwordx2 v[120:121], v8, s[8:11], s40 offen offset:1024
    buffer_load_dwordx2 v[128:129], v8, s[8:11], s39 offen offset:1024
    buffer_load_dwordx2 v[122:123], v8, s[8:11], s52 offen offset:1024
    buffer_load_dwordx2 v[136:137], v8, s[8:11], s53 offen offset:1024
    buffer_load_dwordx4 v[164:167], v12, s[8:11], s33 offen
    s_mov_b32 s16, s14
    s_mov_b32 s17, s15
    s_mov_b32 s18, 4096
    s_mov_b32 s19, 0x00020000
    s_mov_b32 s14, 8388608
    s_mov_b32 s15, 0x00020000
    s_lshl_b32 s31, s24, 3
    s_add_u32 s31, s31, s20
    s_lshl_b32 s31, s31, 16
    v_lshrrev_b32 v1, 3, v0
    v_lshlrev_b32 v1, 12, v1
    v_lshrrev_b32 v2, 4, v0
    v_and_b32 v12, 7, v0
    v_xor_b32 v2, v2, v12
    v_lshl_add_u32 v1, v2, 4, v1
    v_add_u32 v1, s31, v1
    v_xor_b32 v2, 64, v1
    v_add_u32 v2, 31744, v2
    s_mul_i32 s31, s25, 7
    s_mul_i32 s32, s25, 6
    s_add_u32 s32, s32, 12
    s_cmp_lt_u32 s25, 12
    s_cselect_b32 s41, s31, s32
    s_cselect_b32 s42, 7, 6
    s_lshl_b32 s41, s41, 9
    s_and_b32 s31, s21, 2
    v_add_u32 v12, s31, v10
    v_lshlrev_b32 v12, 6, v12
    v_xor_b32 v3, v12, v6
    s_lshr_b32 s31, s20, 2
    s_mul_i32 s31, s31, 110592
    s_lshl_b32 s32, s21, 10
    s_add_u32 s31, s31, s32
    s_add_u32 s31, s31, s41
    s_add_u32 s31, s31, s50
    v_add_u32 v3, s31, v3
    s_lshl_b32 s32, s21, 1
    v_add_u32 v12, s32, v10
    v_cmp_gt_u32 vcc, s42, v12
    s_nop 1
    v_cndmask_b32 v3, v11, v3, vcc
    s_mov_b32 s27, 0
    s_mov_b32 s28, 0
    s_mov_b32 s29, 0
    s_cmp_ge_u32 s20, 4
    s_cbranch_scc1 K2_1
    s_add_u32 s31, s39, -3072
    s_cmp_eq_u32 s21, 3
    s_cselect_b32 s31, 2130706432, s31
    s_cselect_b32 s46, 0, -1
    s_cselect_b32 s47, 0x80000000, -1
    s_cmp_eq_u32 s51, 0
    s_mov_b32 s32, 0x243243
    s_cmov_b32 s32, 0x210210
    v_cmp_lt_u32 vcc, 2, v12
    v_lshlrev_b32 v12, 2, v12
    v_bfe_u32 v4, s32, v12, 4
    v_lshlrev_b32 v4, 5, v4
    v_cndmask_b32 v5, 0, 1, vcc
    s_movk_i32 s32, 7680
    v_mad_u32_u24 v4, v5, s32, v4
    v_add_u32 v4, v4, v9
    v_lshl_add_u32 v4, v4, 4, s31
    s_cmp_eq_u32 s21, 3
    s_mov_b32 s6, 245760
    s_cmov_b32 s6, 256
    s_cselect_b32 s7, 0x80000000, -1
    s_add_u32 m0, s26, 0
    s_nop 0
    buffer_load_dwordx4 v1, s[12:15], s27 offen lds
    buffer_load_dwordx4 v2, s[12:15], s27 offen offset:1024 lds
    buffer_load_dwordx4 v3, s[8:11], s28 offen offset:2048 lds
    s_mov_b64 exec, s[46:47]
    buffer_load_dwordx4 v4, s[8:11], s29 offen offset:3072 lds
    s_mov_b64 exec, -1
    s_add_u32 s29, s29, s6
    s_add_u32 s27, s27, 128
    s_add_u32 s28, s28, 221184
    s_add_u32 m0, s26, 32768
    s_nop 0
    buffer_load_dwordx4 v1, s[12:15], s27 offen lds
    buffer_load_dwordx4 v2, s[12:15], s27 offen offset:1024 lds
    buffer_load_dwordx4 v3, s[8:11], s28 offen offset:2048 lds
    s_mov_b64 exec, s[46:47]
    buffer_load_dwordx4 v4, s[8:11], s29 offen offset:3072 lds
    s_mov_b64 exec, -1
    s_add_u32 s29, s29, s6
    s_add_u32 s27, s27, 128
    s_add_u32 s28, s28, 221184
    s_add_u32 m0, s26, 65536
    s_nop 0
    buffer_load_dwordx4 v1, s[12:15], s27 offen lds
    buffer_load_dwordx4 v2, s[12:15], s27 offen offset:1024 lds
    buffer_load_dwordx4 v3, s[8:11], s28 offen offset:2048 lds
    s_mov_b64 exec, s[46:47]
    buffer_load_dwordx4 v4, s[8:11], s29 offen offset:3072 lds
    s_mov_b64 exec, -1
    s_add_u32 s29, s29, s6
    s_add_u32 s27, s27, 128
    s_add_u32 s28, s28, 221184
    s_setprio 1
    v_bfe_u32 v13, v0, 1, 3
    v_xor_b32 v13, v13, v10
    v_and_b32 v14, 15, v0
    v_lshlrev_b32 v14, 7, v14
    v_lshl_add_u32 v13, v13, 4, v14
    v_bfe_u32 v14, v0, 4, 1
    v_lshl_add_u32 v13, v14, 12, v13
    s_lshl_b32 s31, s21, 13
    v_add_u32 v172, s31, v13
    v_xor_b32 v173, 32, v172
    v_and_b32 v254, 12, v0
    v_lshlrev_b32 v254, 2, v254
    v_lshl_add_u32 v254, v10, 7, v254
    v_and_b32 v13, 1, v0
    v_lshl_add_u32 v15, v13, 1, v14
    v_lshlrev_b32 v15, 6, v15
    v_xor_b32 v15, v15, v254
    v_lshl_add_u32 v15, v13, 13, v15
    v_lshl_add_u32 v15, v14, 9, v15
    v_and_b32 v12, 2, v0
    v_lshl_add_u32 v15, v12, 2, v15
    v_add_u32 v174, 2048, v15
    v_xor_b32 v175, 64, v174
    v_and_b32 v13, 3, v0
    v_lshl_add_u32 v13, v14, 2, v13
    v_lshlrev_b32 v13, 2, v13
    s_mul_i32 s31, s51, 0x44440000
    s_xor_b32 s31, s31, 0x77725410
    v_bfe_u32 v13, s31, v13, 3
    v_and_b32 v15, 3, v13
    v_lshrrev_b32 v13, 2, v13
    v_lshl_add_u32 v254, v13, 3, v254
    v_lshl_add_u32 v255, v15, 9, v254
    v_min_u32 v13, 2, v15
    v_lshlrev_b32 v13, 6, v13
    v_xor_b32 v254, v13, v254
    v_lshlrev_b32 v15, 3, v15
    s_mov_b32 s31, 0x18080100
    v_bfe_u32 v15, s31, v15, 8
    v_lshl_add_u32 v254, v15, 9, v254
    v_add_u32 v176, 19456, v254
    v_xor_b32 v177, 64, v176
    s_movk_i32 s31, 512
    v_lshlrev_b32 v13, 4, v9
    v_mad_u32_u24 v15, v10, s31, v13
    v_add_u32 v178, 3072, v15
    s_movk_i32 s31, 8200
    v_mad_u32_u24 v15, v10, s31, v13
    s_lshl_b32 s31, s51, 3
    v_xor_b32 v15, s31, v15
    v_add_u32 v179, 7168, v15
    s_lshl_b32 s31, s21, 15
    v_lshl_add_u32 v13, v0, 3, s31
    v_mov_b32 v48, 1065369472
    v_mov_b32 v49, 1065369472
    ds_write_b64 v13, v[48:49] offset:15360
    s_waitcnt lgkmcnt(0)
    v_add_u32 v180, 0x10000, v172
    v_add_u32 v181, 0x10000, v173
    v_add_u32 v182, 0x10000, v174
    v_add_u32 v183, 0x10000, v175
    v_add_u32 v184, 0x10000, v176
    v_add_u32 v185, 0x10000, v177
    v_add_u32 v186, 0x10000, v178
    v_add_u32 v187, 0x10000, v179
    v_mov_b32 v5, 0xdddddddd
    s_mov_b32 s38, 0xffff0000
    v_mov_b32 v48, 0
    v_mov_b32 v49, 0
    v_mov_b32 v50, 0
    v_mov_b32 v51, 0
    v_mov_b32 v52, 0
    v_mov_b32 v53, 0
    v_mov_b32 v54, 0
    v_mov_b32 v55, 0
    v_mov_b32 v56, 0
    v_mov_b32 v57, 0
    v_mov_b32 v58, 0
    v_mov_b32 v59, 0
    v_mov_b32 v60, 0
    v_mov_b32 v61, 0
    v_mov_b32 v62, 0
    v_mov_b32 v63, 0
    v_mov_b32 v64, 0
    v_mov_b32 v65, 0
    v_mov_b32 v66, 0
    v_mov_b32 v67, 0
    v_mov_b32 v68, 0
    v_mov_b32 v69, 0
    v_mov_b32 v70, 0
    v_mov_b32 v71, 0
    v_mov_b32 v72, 0
    v_mov_b32 v73, 0
    v_mov_b32 v74, 0
    v_mov_b32 v75, 0
    v_mov_b32 v76, 0
    v_mov_b32 v77, 0
    v_mov_b32 v78, 0
    v_mov_b32 v79, 0
    v_lshlrev_b32 v13, 2, v10
    v_add_u32 v13, 0, v13
    v_lshlrev_b32 v15, 4, v9
    v_lshl_add_u32 v15, v13, 9, v15
    v_add_u32 v14, 1, v13
    v_cmp_gt_u32 vcc, s42, v13
    s_nop 1
    v_cndmask_b32 v13, v11, v15, vcc
    v_cmp_gt_u32 vcc, s42, v14
    s_nop 1
    v_cndmask_b32 v14, v11, v15, vcc
    s_lshl_b32 s31, s24, 2
    s_add_u32 s31, s31, s21
    s_mul_i32 s43, s31, 110592
    s_add_u32 s43, s43, s41
    s_add_u32 s43, s43, 7864320
    s_mul_i32 s44, s31, 96256
    s_add_u32 s44, s44, s41
    s_add_u32 s44, s44, 16556032
    s_lshl_b32 s31, s31, 6
    v_lshlrev_b32 v15, 1, v9
    v_add_u32 v15, s31, v15
    s_lshl_b32 s31, s23, 2
    s_add_u32 s31, s31, s21
    s_mul_i32 s45, s31, 192512
    s_add_u32 s45, s45, s39
    s_add_u32 s45, s45, 16474112
    s_load_dwordx2 s[56:57], s[0:1], 0
    s_load_dwordx2 s[60:61], s[0:1], 64
    s_and_b32 s31, s54, 7
    s_lshl_b32 s31, s31, 2
    s_bfe_u32 s65, s54, 0x20003
    s_add_u32 s65, s65, s31
    s_lshr_b32 s66, s54, 5
    s_mul_i32 s64, s66, 240640
    s_mul_i32 s31, s20, 30720
    s_add_u32 s64, s64, s31
    s_add_u32 s64, s64, 22937600
    s_mov_b32 s58, 2621440
    s_mov_b32 s59, 0x00020000
    s_mov_b32 s62, 2621440
    s_mov_b32 s63, 0x00020000
    s_mul_i32 s4, s65, 192512
    s_mul_i32 s31, s20, 12288
    s_add_u32 s4, s4, s31
    s_add_u32 s4, s4, 16515072
    s_and_b32 s31, s66, 1
    s_lshl_b32 s31, s31, 8
    s_add_u32 s4, s4, s31
    s_bitcmp1_b32 s66, 1
    s_cselect_b32 s31, 0, 96256
    s_cselect_b32 s32, 96256, 0
    s_add_u32 s97, s4, s31
    s_add_u32 s4, s4, s32
    s_add_u32 s5, s4, 4096
    s_add_u32 s96, s4, 8192
    s_add_u32 s98, s97, 4096
    s_add_u32 s99, s97, 8192
    s_lshl_b32 s33, s21, 3
    s_lshr_b32 s31, 0x1c120800, s33
    s_lshr_b32 s32, 0x70c0c0a, s33
    s_bfm_b64 s[100:101], s32, s31
    s_mov_b32 s68, 14946304
    s_lshl_b32 s69, s54, 7
    s_add_u32 s69, s69, 14979072
    s_lshl_b32 s31, s23, 5
    s_add_u32 s31, s31, s22
    s_lshl_b32 s31, s31, 7
    s_add_u32 s67, s31, s68
    s_cmp_eq_u32 s20, 7
    s_cselect_b32 s31, 2130706432, 0
    v_or_b32 v252, s31, v6
    s_waitcnt vmcnt(19)
    v_mfma_f32_32x32x16_bf16 v[16:31], v[124:127], v[112:115], 0
    s_waitcnt vmcnt(17)
    v_mfma_f32_32x32x16_bf16 v[80:95], v[132:135], v[112:115], 0
    v_mfma_f32_32x32x16_bf16 v[32:47], v[124:127], v[116:119], 0
    v_mfma_f32_32x32x16_bf16 v[96:111], v[132:135], v[116:119], 0
    s_waitcnt vmcnt(15)
    v_mfma_f32_32x32x8bf16_1k v[16:31], v[128:129], v[120:121], v[16:31]
    s_waitcnt vmcnt(13)
    v_mfma_f32_32x32x8bf16_1k v[80:95], v[136:137], v[120:121], v[80:95]
    v_mfma_f32_32x32x8bf16_1k v[32:47], v[128:129], v[122:123], v[32:47]
    v_mfma_f32_32x32x8bf16_1k v[96:111], v[136:137], v[122:123], v[96:111]
    s_waitcnt vmcnt(12)
    v_or3_b32 v164, v164, v165, v166
    v_or_b32 v164, v164, v167
    v_cmp_ne_u32 vcc, 0, v164
    s_and_b64 vcc, vcc, s[48:49]
    s_cbranch_scc1 K2_FIX
    s_nop 1
    v_max3_f32 v9, v16, v17, v18
    s_nop 1
    v_max3_f32 v10, v32, v33, v34
    v_max3_f32 v9, v9, v19, v20
    v_max3_f32 v10, v10, v35, v36
    v_max3_f32 v9, v9, v21, v22
    v_max3_f32 v10, v10, v37, v38
    v_max3_f32 v9, v9, v23, v24
    v_max3_f32 v10, v10, v39, v40
    v_max3_f32 v9, v9, v25, v26
    v_max3_f32 v10, v10, v41, v42
    v_max3_f32 v9, v9, v27, v28
    v_max3_f32 v10, v10, v43, v44
    v_max3_f32 v9, v9, v29, v30
    v_max3_f32 v10, v10, v45, v46
    v_max3_f32 v9, v9, v31, v80
    v_max3_f32 v10, v10, v47, v96
    v_max3_f32 v9, v9, v81, v82
    v_max3_f32 v10, v10, v97, v98
    v_max3_f32 v9, v9, v83, v84
    v_max3_f32 v10, v10, v99, v100
    v_max3_f32 v9, v9, v85, v86
    v_max3_f32 v10, v10, v101, v102
    v_max3_f32 v9, v9, v87, v88
    v_max3_f32 v10, v10, v103, v104
    v_max3_f32 v9, v9, v89, v90
    v_max3_f32 v10, v10, v105, v106
    v_max3_f32 v9, v9, v91, v92
    v_max3_f32 v10, v10, v107, v108
    v_max3_f32 v9, v9, v93, v94
    v_max3_f32 v10, v10, v109, v110
    v_max_f32 v9, v9, v95
    v_max_f32 v10, v10, v111
    s_nop 1
    v_permlane32_swap_b32 v9, v10
    v_max_f32 v9, v9, v10
    v_sub_f32 v9, 0xc2b00000, v9
    v_cvt_pk_bf16_f32 v10, v9, v9
    v_and_b32 v10, s38, v10
    v_sub_f32 v10, v9, v10
    v_cvt_pk_bf16_f32 v11, v9, v10
    v_and_b32 v9, s38, v11
    v_sub_f32 v10, v10, v9
    v_cvt_pk_bf16_f32 v12, v10, 0
    v_cndmask_b32 v122, v122, v11, s[36:37]
    v_cndmask_b32 v123, v123, v12, s[36:37]
    v_permlane32_swap_b32 v120, v11
    v_permlane32_swap_b32 v121, v12
    s_waitcnt vmcnt(8)
    s_barrier
    ds_read_b128 v[124:127], v178 offset:0
    ds_read_b64 v[128:129], v179 offset:0
    ds_read_b128 v[140:143], v172 offset:0
    ds_read_b64_tr_b16 v[148:149], v174 offset:0
    ds_read_b64_tr_b16 v[150:151], v175 offset:0
    ds_read_b64_tr_b16 v[152:153], v174 offset:4096
    ds_read_b64_tr_b16 v[154:155], v175 offset:4096
    ds_read_b128 v[144:147], v173 offset:0
    ds_read_b64_tr_b16 v[156:157], v174 offset:256
    ds_read_b64_tr_b16 v[158:159], v175 offset:256
    ds_read_b64_tr_b16 v[160:161], v174 offset:4352
    ds_read_b64_tr_b16 v[162:163], v175 offset:4352
    s_add_u32 m0, s26, 98304
    s_nop 0
    buffer_load_dwordx4 v1, s[12:15], s27 offen lds
    buffer_load_dwordx4 v2, s[12:15], s27 offen offset:1024 lds
    buffer_load_dwordx4 v3, s[8:11], s28 offen offset:2048 lds
    s_mov_b64 exec, s[46:47]
    buffer_load_dwordx4 v4, s[8:11], s29 offen offset:3072 lds
    s_mov_b64 exec, -1
    s_add_u32 s29, s29, s6
    s_add_u32 s27, s27, 128
    s_add_u32 s28, s28, 221184
    s_waitcnt lgkmcnt(0)
    s_waitcnt vmcnt(8)
    s_barrier
    v_mfma_f32_32x32x16_bf16 v[16:31], v[124:127], v[112:115], 0
    v_mfma_f32_32x32x8bf16_1k v[16:31], v[128:129], v[120:121], v[16:31]
    v_mfma_f32_32x32x16_bf16 v[80:95], v[148:151], v[140:143], 0
    v_mfma_f32_32x32x16_bf16 v[96:111], v[152:155], v[140:143], 0
    v_mfma_f32_32x32x16_bf16 v[32:47], v[124:127], v[116:119], 0
    s_nop 8
    v_exp_f32 v16, v16
    v_exp_f32 v17, v17
    v_exp_f32 v18, v18
    v_exp_f32 v19, v19
    v_mfma_f32_32x32x8bf16_1k v[32:47], v[128:129], v[122:123], v[32:47]
    v_exp_f32 v20, v20
    v_exp_f32 v21, v21
    v_exp_f32 v22, v22
    v_exp_f32 v23, v23
    v_mfma_f32_32x32x16_bf16 v[80:95], v[156:159], v[144:147], v[80:95]
    v_exp_f32 v24, v24
    v_exp_f32 v25, v25
    v_exp_f32 v26, v26
    v_exp_f32 v27, v27
    v_mfma_f32_32x32x16_bf16 v[96:111], v[160:163], v[144:147], v[96:111]
    v_exp_f32 v28, v28
    v_exp_f32 v29, v29
    v_exp_f32 v30, v30
    v_exp_f32 v31, v31
    s_mov_b32 s30, 0
K2_L0:
    ds_read_b64_tr_b16 v[132:133], v176 offset:32768
    ds_read_b64_tr_b16 v[134:135], v177 offset:32768
    ds_read_b64_tr_b16 v[136:137], v176 offset:33024
    ds_read_b64_tr_b16 v[138:139], v177 offset:33024
    ds_read_b128 v[124:127], v178 offset:32768
    ds_read_b64 v[128:129], v179 offset:32768
    ds_read_b128 v[140:143], v172 offset:32768
    ds_read_b64_tr_b16 v[148:149], v174 offset:32768
    ds_read_b64_tr_b16 v[150:151], v175 offset:32768
    ds_read_b64_tr_b16 v[152:153], v174 offset:36864
    ds_read_b64_tr_b16 v[154:155], v175 offset:36864
    ds_read_b128 v[144:147], v173 offset:32768
    ds_read_b64_tr_b16 v[156:157], v174 offset:33024
    ds_read_b64_tr_b16 v[158:159], v175 offset:33024
    ds_read_b64_tr_b16 v[160:161], v174 offset:37120
    ds_read_b64_tr_b16 v[162:163], v175 offset:37120
    s_add_u32 m0, s26, 0
    s_nop 0
    buffer_load_dwordx4 v1, s[12:15], s27 offen lds
    buffer_load_dwordx4 v2, s[12:15], s27 offen offset:1024 lds
    buffer_load_dwordx4 v3, s[8:11], s28 offen offset:2048 lds
    s_mov_b64 exec, s[46:47]
    buffer_load_dwordx4 v4, s[8:11], s29 offen offset:3072 lds
    s_mov_b64 exec, -1
    s_add_u32 s29, s29, s6
    s_add_u32 s27, s27, 128
    s_add_u32 s28, s28, 221184
    s_waitcnt lgkmcnt(0)
    s_waitcnt vmcnt(8)
    s_barrier
    v_smfmac_f32_32x32x32_bf16 v[48:63], v[132:135], v[16:23], v5
    v_exp_f32 v32, v32
    v_exp_f32 v33, v33
    v_smfmac_f32_32x32x32_bf16 v[48:63], v[136:139], v[24:31], v5
    v_exp_f32 v34, v34
    v_exp_f32 v35, v35
    v_mfma_f32_32x32x16_bf16 v[16:31], v[124:127], v[112:115], 0
    v_exp_f32 v36, v36
    v_exp_f32 v37, v37
    v_exp_f32 v38, v38
    v_mfma_f32_32x32x8bf16_1k v[16:31], v[128:129], v[120:121], v[16:31]
    v_exp_f32 v39, v39
    v_exp_f32 v40, v40
    v_exp_f32 v41, v41
    v_mfma_f32_32x32x16_bf16 v[80:95], v[148:151], v[140:143], v[80:95]
    v_exp_f32 v42, v42
    v_exp_f32 v43, v43
    v_exp_f32 v44, v44
    v_mfma_f32_32x32x16_bf16 v[96:111], v[152:155], v[140:143], v[96:111]
    v_exp_f32 v45, v45
    v_exp_f32 v46, v46
    v_exp_f32 v47, v47
    v_smfmac_f32_32x32x32_bf16 v[64:79], v[132:135], v[32:39], v5
    v_exp_f32 v16, v16
    v_exp_f32 v17, v17
    v_smfmac_f32_32x32x32_bf16 v[64:79], v[136:139], v[40:47], v5
    v_exp_f32 v18, v18
    v_exp_f32 v19, v19
    v_mfma_f32_32x32x16_bf16 v[32:47], v[124:127], v[116:119], 0
    v_exp_f32 v20, v20
    v_exp_f32 v21, v21
    v_exp_f32 v22, v22
    v_mfma_f32_32x32x8bf16_1k v[32:47], v[128:129], v[122:123], v[32:47]
    v_exp_f32 v23, v23
    v_exp_f32 v24, v24
    v_exp_f32 v25, v25
    v_mfma_f32_32x32x16_bf16 v[80:95], v[156:159], v[144:147], v[80:95]
    v_exp_f32 v26, v26
    v_exp_f32 v27, v27
    v_exp_f32 v28, v28
    v_mfma_f32_32x32x16_bf16 v[96:111], v[160:163], v[144:147], v[96:111]
    v_exp_f32 v29, v29
    v_exp_f32 v30, v30
    v_exp_f32 v31, v31
    ds_read_b64_tr_b16 v[132:133], v184 offset:0
    ds_read_b64_tr_b16 v[134:135], v185 offset:0
    ds_read_b64_tr_b16 v[136:137], v184 offset:256
    ds_read_b64_tr_b16 v[138:139], v185 offset:256
    ds_read_b128 v[124:127], v186 offset:0
    ds_read_b64 v[128:129], v187 offset:0
    ds_read_b128 v[140:143], v180 offset:0
    ds_read_b64_tr_b16 v[148:149], v182 offset:0
    ds_read_b64_tr_b16 v[150:151], v183 offset:0
    ds_read_b64_tr_b16 v[152:153], v182 offset:4096
    ds_read_b64_tr_b16 v[154:155], v183 offset:4096
    ds_read_b128 v[144:147], v181 offset:0
    ds_read_b64_tr_b16 v[156:157], v182 offset:256
    ds_read_b64_tr_b16 v[158:159], v183 offset:256
    ds_read_b64_tr_b16 v[160:161], v182 offset:4352
    ds_read_b64_tr_b16 v[162:163], v183 offset:4352
    s_add_u32 m0, s26, 32768
    s_nop 0
    buffer_load_dwordx4 v1, s[12:15], s27 offen lds
    buffer_load_dwordx4 v2, s[12:15], s27 offen offset:1024 lds
    buffer_load_dwordx4 v3, s[8:11], s28 offen offset:2048 lds
    s_mov_b64 exec, s[46:47]
    buffer_load_dwordx4 v4, s[8:11], s29 offen offset:3072 lds
    s_mov_b64 exec, -1
    s_add_u32 s29, s29, s6
    s_add_u32 s27, s27, 128
    s_add_u32 s28, s28, 221184
    s_waitcnt lgkmcnt(0)
    s_waitcnt vmcnt(8)
    s_barrier
    v_smfmac_f32_32x32x32_bf16 v[48:63], v[132:135], v[16:23], v5
    v_exp_f32 v32, v32
    v_exp_f32 v33, v33
    v_smfmac_f32_32x32x32_bf16 v[48:63], v[136:139], v[24:31], v5
    v_exp_f32 v34, v34
    v_exp_f32 v35, v35
    v_mfma_f32_32x32x16_bf16 v[16:31], v[124:127], v[112:115], 0
    v_exp_f32 v36, v36
    v_exp_f32 v37, v37
    v_exp_f32 v38, v38
    v_mfma_f32_32x32x8bf16_1k v[16:31], v[128:129], v[120:121], v[16:31]
    v_exp_f32 v39, v39
    v_exp_f32 v40, v40
    v_exp_f32 v41, v41
    v_mfma_f32_32x32x16_bf16 v[80:95], v[148:151], v[140:143], v[80:95]
    v_exp_f32 v42, v42
    v_exp_f32 v43, v43
    v_exp_f32 v44, v44
    v_mfma_f32_32x32x16_bf16 v[96:111], v[152:155], v[140:143], v[96:111]
    v_exp_f32 v45, v45
    v_exp_f32 v46, v46
    v_exp_f32 v47, v47
    v_smfmac_f32_32x32x32_bf16 v[64:79], v[132:135], v[32:39], v5
    v_exp_f32 v16, v16
    v_exp_f32 v17, v17
    v_smfmac_f32_32x32x32_bf16 v[64:79], v[136:139], v[40:47], v5
    v_exp_f32 v18, v18
    v_exp_f32 v19, v19
    v_mfma_f32_32x32x16_bf16 v[32:47], v[124:127], v[116:119], 0
    v_exp_f32 v20, v20
    v_exp_f32 v21, v21
    v_exp_f32 v22, v22
    v_mfma_f32_32x32x8bf16_1k v[32:47], v[128:129], v[122:123], v[32:47]
    v_exp_f32 v23, v23
    v_exp_f32 v24, v24
    v_exp_f32 v25, v25
    v_mfma_f32_32x32x16_bf16 v[80:95], v[156:159], v[144:147], v[80:95]
    v_exp_f32 v26, v26
    v_exp_f32 v27, v27
    v_exp_f32 v28, v28
    v_mfma_f32_32x32x16_bf16 v[96:111], v[160:163], v[144:147], v[96:111]
    v_exp_f32 v29, v29
    v_exp_f32 v30, v30
    v_exp_f32 v31, v31
    ds_read_b64_tr_b16 v[132:133], v184 offset:32768
    ds_read_b64_tr_b16 v[134:135], v185 offset:32768
    ds_read_b64_tr_b16 v[136:137], v184 offset:33024
    ds_read_b64_tr_b16 v[138:139], v185 offset:33024
    ds_read_b128 v[124:127], v186 offset:32768
    ds_read_b64 v[128:129], v187 offset:32768
    ds_read_b128 v[140:143], v180 offset:32768
    ds_read_b64_tr_b16 v[148:149], v182 offset:32768
    ds_read_b64_tr_b16 v[150:151], v183 offset:32768
    ds_read_b64_tr_b16 v[152:153], v182 offset:36864
    ds_read_b64_tr_b16 v[154:155], v183 offset:36864
    ds_read_b128 v[144:147], v181 offset:32768
    ds_read_b64_tr_b16 v[156:157], v182 offset:33024
    ds_read_b64_tr_b16 v[158:159], v183 offset:33024
    ds_read_b64_tr_b16 v[160:161], v182 offset:37120
    ds_read_b64_tr_b16 v[162:163], v183 offset:37120
    s_add_u32 m0, s26, 65536
    s_nop 0
    buffer_load_dwordx4 v1, s[12:15], s27 offen lds
    buffer_load_dwordx4 v2, s[12:15], s27 offen offset:1024 lds
    buffer_load_dwordx4 v3, s[8:11], s28 offen offset:2048 lds
    s_mov_b64 exec, s[46:47]
    buffer_load_dwordx4 v4, s[8:11], s29 offen offset:3072 lds
    s_mov_b64 exec, -1
    s_add_u32 s29, s29, s6
    s_add_u32 s27, s27, 128
    s_add_u32 s28, s28, 221184
    s_waitcnt lgkmcnt(0)
    s_waitcnt vmcnt(8)
    s_barrier
    v_smfmac_f32_32x32x32_bf16 v[48:63], v[132:135], v[16:23], v5
    v_exp_f32 v32, v32
    v_exp_f32 v33, v33
    v_smfmac_f32_32x32x32_bf16 v[48:63], v[136:139], v[24:31], v5
    v_exp_f32 v34, v34
    v_exp_f32 v35, v35
    v_mfma_f32_32x32x16_bf16 v[16:31], v[124:127], v[112:115], 0
    v_exp_f32 v36, v36
    v_exp_f32 v37, v37
    v_exp_f32 v38, v38
    v_mfma_f32_32x32x8bf16_1k v[16:31], v[128:129], v[120:121], v[16:31]
    v_exp_f32 v39, v39
    v_exp_f32 v40, v40
    v_exp_f32 v41, v41
    v_mfma_f32_32x32x16_bf16 v[80:95], v[148:151], v[140:143], v[80:95]
    v_exp_f32 v42, v42
    v_exp_f32 v43, v43
    v_exp_f32 v44, v44
    v_mfma_f32_32x32x16_bf16 v[96:111], v[152:155], v[140:143], v[96:111]
    v_exp_f32 v45, v45
    v_exp_f32 v46, v46
    v_exp_f32 v47, v47
    v_smfmac_f32_32x32x32_bf16 v[64:79], v[132:135], v[32:39], v5
    v_exp_f32 v16, v16
    v_exp_f32 v17, v17
    v_smfmac_f32_32x32x32_bf16 v[64:79], v[136:139], v[40:47], v5
    v_exp_f32 v18, v18
    v_exp_f32 v19, v19
    v_mfma_f32_32x32x16_bf16 v[32:47], v[124:127], v[116:119], 0
    v_exp_f32 v20, v20
    v_exp_f32 v21, v21
    v_exp_f32 v22, v22
    v_mfma_f32_32x32x8bf16_1k v[32:47], v[128:129], v[122:123], v[32:47]
    v_exp_f32 v23, v23
    v_exp_f32 v24, v24
    v_exp_f32 v25, v25
    v_mfma_f32_32x32x16_bf16 v[80:95], v[156:159], v[144:147], v[80:95]
    v_exp_f32 v26, v26
    v_exp_f32 v27, v27
    v_exp_f32 v28, v28
    v_mfma_f32_32x32x16_bf16 v[96:111], v[160:163], v[144:147], v[96:111]
    v_exp_f32 v29, v29
    v_exp_f32 v30, v30
    v_exp_f32 v31, v31
    ds_read_b64_tr_b16 v[132:133], v176 offset:0
    ds_read_b64_tr_b16 v[134:135], v177 offset:0
    ds_read_b64_tr_b16 v[136:137], v176 offset:256
    ds_read_b64_tr_b16 v[138:139], v177 offset:256
    ds_read_b128 v[124:127], v178 offset:0
    ds_read_b64 v[128:129], v179 offset:0
    ds_read_b128 v[140:143], v172 offset:0
    ds_read_b64_tr_b16 v[148:149], v174 offset:0
    ds_read_b64_tr_b16 v[150:151], v175 offset:0
    ds_read_b64_tr_b16 v[152:153], v174 offset:4096
    ds_read_b64_tr_b16 v[154:155], v175 offset:4096
    ds_read_b128 v[144:147], v173 offset:0
    ds_read_b64_tr_b16 v[156:157], v174 offset:256
    ds_read_b64_tr_b16 v[158:159], v175 offset:256
    ds_read_b64_tr_b16 v[160:161], v174 offset:4352
    ds_read_b64_tr_b16 v[162:163], v175 offset:4352
    s_add_u32 m0, s26, 98304
    s_nop 0
    buffer_load_dwordx4 v1, s[12:15], s27 offen lds
    buffer_load_dwordx4 v2, s[12:15], s27 offen offset:1024 lds
    buffer_load_dwordx4 v3, s[8:11], s28 offen offset:2048 lds
    s_mov_b64 exec, s[46:47]
    buffer_load_dwordx4 v4, s[8:11], s29 offen offset:3072 lds
    s_mov_b64 exec, -1
    s_add_u32 s29, s29, s6
    s_add_u32 s27, s27, 128
    s_add_u32 s28, s28, 221184
    s_waitcnt lgkmcnt(0)
    s_waitcnt vmcnt(8)
    s_barrier
    v_smfmac_f32_32x32x32_bf16 v[48:63], v[132:135], v[16:23], v5
    v_exp_f32 v32, v32
    v_exp_f32 v33, v33
    v_smfmac_f32_32x32x32_bf16 v[48:63], v[136:139], v[24:31], v5
    v_exp_f32 v34, v34
    v_exp_f32 v35, v35
    v_mfma_f32_32x32x16_bf16 v[16:31], v[124:127], v[112:115], 0
    v_exp_f32 v36, v36
    v_exp_f32 v37, v37
    v_exp_f32 v38, v38
    v_mfma_f32_32x32x8bf16_1k v[16:31], v[128:129], v[120:121], v[16:31]
    v_exp_f32 v39, v39
    v_exp_f32 v40, v40
    v_exp_f32 v41, v41
    v_mfma_f32_32x32x16_bf16 v[80:95], v[148:151], v[140:143], v[80:95]
    v_exp_f32 v42, v42
    v_exp_f32 v43, v43
    v_exp_f32 v44, v44
    v_mfma_f32_32x32x16_bf16 v[96:111], v[152:155], v[140:143], v[96:111]
    v_exp_f32 v45, v45
    v_exp_f32 v46, v46
    v_exp_f32 v47, v47
    v_smfmac_f32_32x32x32_bf16 v[64:79], v[132:135], v[32:39], v5
    v_exp_f32 v16, v16
    v_exp_f32 v17, v17
    v_smfmac_f32_32x32x32_bf16 v[64:79], v[136:139], v[40:47], v5
    v_exp_f32 v18, v18
    v_exp_f32 v19, v19
    v_mfma_f32_32x32x16_bf16 v[32:47], v[124:127], v[116:119], 0
    v_exp_f32 v20, v20
    v_exp_f32 v21, v21
    v_exp_f32 v22, v22
    v_mfma_f32_32x32x8bf16_1k v[32:47], v[128:129], v[122:123], v[32:47]
    v_exp_f32 v23, v23
    v_exp_f32 v24, v24
    v_exp_f32 v25, v25
    v_mfma_f32_32x32x16_bf16 v[80:95], v[156:159], v[144:147], v[80:95]
    v_exp_f32 v26, v26
    v_exp_f32 v27, v27
    v_exp_f32 v28, v28
    v_mfma_f32_32x32x16_bf16 v[96:111], v[160:163], v[144:147], v[96:111]
    v_exp_f32 v29, v29
    v_exp_f32 v30, v30
    v_exp_f32 v31, v31
    s_add_u32 s30, s30, 1
    s_cmp_lt_u32 s30, 7
    s_cbranch_scc1 K2_L0
    ds_read_b64_tr_b16 v[132:133], v176 offset:32768
    ds_read_b64_tr_b16 v[134:135], v177 offset:32768
    ds_read_b64_tr_b16 v[136:137], v176 offset:33024
    ds_read_b64_tr_b16 v[138:139], v177 offset:33024
    ds_read_b128 v[124:127], v178 offset:32768
    ds_read_b64 v[128:129], v179 offset:32768
    ds_read_b128 v[140:143], v172 offset:32768
    ds_read_b64_tr_b16 v[148:149], v174 offset:32768
    ds_read_b64_tr_b16 v[150:151], v175 offset:32768
    ds_read_b64_tr_b16 v[152:153], v174 offset:36864
    ds_read_b64_tr_b16 v[154:155], v175 offset:36864
    ds_read_b128 v[144:147], v173 offset:32768
    ds_read_b64_tr_b16 v[156:157], v174 offset:33024
    ds_read_b64_tr_b16 v[158:159], v175 offset:33024
    ds_read_b64_tr_b16 v[160:161], v174 offset:37120
    ds_read_b64_tr_b16 v[162:163], v175 offset:37120
    s_add_u32 s34, s64, 0
    buffer_load_dwordx4 v[188:191], v6, s[8:11], s34 offen offset:0
    buffer_load_dwordx4 v[192:195], v6, s[8:11], s34 offen offset:1024
    buffer_load_dwordx4 v[196:199], v6, s[8:11], s34 offen offset:2048
    buffer_load_dwordx4 v[200:203], v6, s[8:11], s34 offen offset:3072
    s_waitcnt lgkmcnt(0)
    s_waitcnt vmcnt(8)
    s_barrier
    v_smfmac_f32_32x32x32_bf16 v[48:63], v[132:135], v[16:23], v5
    v_exp_f32 v32, v32
    v_exp_f32 v33, v33
    v_smfmac_f32_32x32x32_bf16 v[48:63], v[136:139], v[24:31], v5
    v_exp_f32 v34, v34
    v_exp_f32 v35, v35
    v_mfma_f32_32x32x16_bf16 v[16:31], v[124:127], v[112:115], 0
    v_exp_f32 v36, v36
    v_exp_f32 v37, v37
    v_exp_f32 v38, v38
    v_mfma_f32_32x32x8bf16_1k v[16:31], v[128:129], v[120:121], v[16:31]
    v_exp_f32 v39, v39
    v_exp_f32 v40, v40
    v_exp_f32 v41, v41
    v_mfma_f32_32x32x16_bf16 v[80:95], v[148:151], v[140:143], v[80:95]
    v_exp_f32 v42, v42
    v_exp_f32 v43, v43
    v_exp_f32 v44, v44
    v_mfma_f32_32x32x16_bf16 v[96:111], v[152:155], v[140:143], v[96:111]
    v_exp_f32 v45, v45
    v_exp_f32 v46, v46
    v_exp_f32 v47, v47
    v_smfmac_f32_32x32x32_bf16 v[64:79], v[132:135], v[32:39], v5
    v_exp_f32 v16, v16
    v_exp_f32 v17, v17
    v_smfmac_f32_32x32x32_bf16 v[64:79], v[136:139], v[40:47], v5
    v_exp_f32 v18, v18
    v_exp_f32 v19, v19
    v_mfma_f32_32x32x16_bf16 v[32:47], v[124:127], v[116:119], 0
    v_exp_f32 v20, v20
    v_exp_f32 v21, v21
    v_exp_f32 v22, v22
    v_mfma_f32_32x32x8bf16_1k v[32:47], v[128:129], v[122:123], v[32:47]
    v_exp_f32 v23, v23
    v_exp_f32 v24, v24
    v_exp_f32 v25, v25
    v_mfma_f32_32x32x16_bf16 v[80:95], v[156:159], v[144:147], v[80:95]
    v_exp_f32 v26, v26
    v_exp_f32 v27, v27
    v_exp_f32 v28, v28
    v_mfma_f32_32x32x16_bf16 v[96:111], v[160:163], v[144:147], v[96:111]
    v_exp_f32 v29, v29
    v_exp_f32 v30, v30
    v_exp_f32 v31, v31
    ds_read_b64_tr_b16 v[132:133], v184 offset:0
    ds_read_b64_tr_b16 v[134:135], v185 offset:0
    ds_read_b64_tr_b16 v[136:137], v184 offset:256
    ds_read_b64_tr_b16 v[138:139], v185 offset:256
    ds_read_b128 v[124:127], v186 offset:0
    ds_read_b64 v[128:129], v187 offset:0
    ds_read_b128 v[140:143], v180 offset:0
    ds_read_b64_tr_b16 v[148:149], v182 offset:0
    ds_read_b64_tr_b16 v[150:151], v183 offset:0
    ds_read_b64_tr_b16 v[152:153], v182 offset:4096
    ds_read_b64_tr_b16 v[154:155], v183 offset:4096
    ds_read_b128 v[144:147], v181 offset:0
    ds_read_b64_tr_b16 v[156:157], v182 offset:256
    ds_read_b64_tr_b16 v[158:159], v183 offset:256
    ds_read_b64_tr_b16 v[160:161], v182 offset:4352
    ds_read_b64_tr_b16 v[162:163], v183 offset:4352
    s_add_u32 m0, s26, 32768
    s_add_u32 s34, s64, 13312
    buffer_load_dwordx4 v6, s[8:11], s34 offen offset:0 lds
    buffer_load_dwordx4 v6, s[8:11], s34 offen offset:1024 lds
    buffer_load_dwordx4 v6, s[8:11], s34 offen offset:2048 lds
    buffer_load_dwordx4 v6, s[8:11], s34 offen offset:3072 lds
    s_waitcnt lgkmcnt(0)
    s_waitcnt vmcnt(8)
    s_barrier
    v_smfmac_f32_32x32x32_bf16 v[48:63], v[132:135], v[16:23], v5
    v_exp_f32 v32, v32
    v_exp_f32 v33, v33
    v_smfmac_f32_32x32x32_bf16 v[48:63], v[136:139], v[24:31], v5
    v_exp_f32 v34, v34
    v_exp_f32 v35, v35
    v_mfma_f32_32x32x16_bf16 v[16:31], v[124:127], v[112:115], 0
    v_exp_f32 v36, v36
    v_exp_f32 v37, v37
    v_exp_f32 v38, v38
    v_mfma_f32_32x32x8bf16_1k v[16:31], v[128:129], v[120:121], v[16:31]
    v_exp_f32 v39, v39
    v_exp_f32 v40, v40
    v_exp_f32 v41, v41
    v_mfma_f32_32x32x16_bf16 v[80:95], v[148:151], v[140:143], v[80:95]
    v_exp_f32 v42, v42
    v_exp_f32 v43, v43
    v_exp_f32 v44, v44
    v_mfma_f32_32x32x16_bf16 v[96:111], v[152:155], v[140:143], v[96:111]
    v_exp_f32 v45, v45
    v_exp_f32 v46, v46
    v_exp_f32 v47, v47
    v_smfmac_f32_32x32x32_bf16 v[64:79], v[132:135], v[32:39], v5
    v_exp_f32 v16, v16
    v_exp_f32 v17, v17
    v_smfmac_f32_32x32x32_bf16 v[64:79], v[136:139], v[40:47], v5
    v_exp_f32 v18, v18
    v_exp_f32 v19, v19
    v_mfma_f32_32x32x16_bf16 v[32:47], v[124:127], v[116:119], 0
    v_exp_f32 v20, v20
    v_exp_f32 v21, v21
    v_exp_f32 v22, v22
    v_mfma_f32_32x32x8bf16_1k v[32:47], v[128:129], v[122:123], v[32:47]
    v_exp_f32 v23, v23
    v_exp_f32 v24, v24
    v_exp_f32 v25, v25
    v_mfma_f32_32x32x16_bf16 v[80:95], v[156:159], v[144:147], v[80:95]
    v_exp_f32 v26, v26
    v_exp_f32 v27, v27
    v_exp_f32 v28, v28
    v_mfma_f32_32x32x16_bf16 v[96:111], v[160:163], v[144:147], v[96:111]
    v_exp_f32 v29, v29
    v_exp_f32 v30, v30
    v_exp_f32 v31, v31
    buffer_load_dwordx4 v[164:167], v13, s[8:11], s43 offen offset:0
    buffer_load_dwordx4 v[168:171], v14, s[8:11], s43 offen offset:512
    buffer_load_ushort v15, v15, s[16:19], 0 offen
    ds_read_b64_tr_b16 v[132:133], v184 offset:32768
    ds_read_b64_tr_b16 v[134:135], v185 offset:32768
    ds_read_b64_tr_b16 v[136:137], v184 offset:33024
    ds_read_b64_tr_b16 v[138:139], v185 offset:33024
    ds_read_b128 v[124:127], v186 offset:32768
    ds_read_b64 v[128:129], v187 offset:32768
    ds_read_b128 v[140:143], v180 offset:32768
    ds_read_b64_tr_b16 v[148:149], v182 offset:32768
    ds_read_b64_tr_b16 v[150:151], v183 offset:32768
    ds_read_b64_tr_b16 v[152:153], v182 offset:36864
    ds_read_b64_tr_b16 v[154:155], v183 offset:36864
    ds_read_b128 v[144:147], v181 offset:32768
    ds_read_b64_tr_b16 v[156:157], v182 offset:33024
    ds_read_b64_tr_b16 v[158:159], v183 offset:33024
    ds_read_b64_tr_b16 v[160:161], v182 offset:37120
    ds_read_b64_tr_b16 v[162:163], v183 offset:37120
    s_add_u32 m0, s26, 65536
    s_add_u32 s34, s64, 17408
    buffer_load_dwordx4 v6, s[8:11], s34 offen offset:0 lds
    buffer_load_dwordx4 v6, s[8:11], s34 offen offset:1024 lds
    buffer_load_dwordx4 v6, s[8:11], s34 offen offset:2048 lds
    buffer_load_dwordx4 v6, s[8:11], s34 offen offset:3072 lds
    s_waitcnt lgkmcnt(0)
    s_barrier
    v_smfmac_f32_32x32x32_bf16 v[48:63], v[132:135], v[16:23], v5
    v_exp_f32 v32, v32
    v_exp_f32 v33, v33
    v_smfmac_f32_32x32x32_bf16 v[48:63], v[136:139], v[24:31], v5
    v_exp_f32 v34, v34
    v_exp_f32 v35, v35
    v_mfma_f32_32x32x16_bf16 v[16:31], v[124:127], v[112:115], 0
    v_exp_f32 v36, v36
    v_exp_f32 v37, v37
    v_exp_f32 v38, v38
    v_mfma_f32_32x32x8bf16_1k v[16:31], v[128:129], v[120:121], v[16:31]
    v_exp_f32 v39, v39
    v_exp_f32 v40, v40
    v_exp_f32 v41, v41
    v_mfma_f32_32x32x16_bf16 v[80:95], v[148:151], v[140:143], v[80:95]
    v_exp_f32 v42, v42
    v_exp_f32 v43, v43
    v_exp_f32 v44, v44
    v_mfma_f32_32x32x16_bf16 v[96:111], v[152:155], v[140:143], v[96:111]
    v_exp_f32 v45, v45
    v_exp_f32 v46, v46
    v_exp_f32 v47, v47
    v_smfmac_f32_32x32x32_bf16 v[64:79], v[132:135], v[32:39], v5
    v_exp_f32 v16, v16
    v_exp_f32 v17, v17
    v_smfmac_f32_32x32x32_bf16 v[64:79], v[136:139], v[40:47], v5
    v_exp_f32 v18, v18
    v_exp_f32 v19, v19
    v_mfma_f32_32x32x16_bf16 v[32:47], v[124:127], v[116:119], 0
    v_exp_f32 v20, v20
    v_exp_f32 v21, v21
    v_exp_f32 v22, v22
    v_mfma_f32_32x32x8bf16_1k v[32:47], v[128:129], v[122:123], v[32:47]
    v_exp_f32 v23, v23
    v_exp_f32 v24, v24
    v_exp_f32 v25, v25
    v_mfma_f32_32x32x16_bf16 v[80:95], v[156:159], v[144:147], v[80:95]
    v_exp_f32 v26, v26
    v_exp_f32 v27, v27
    v_exp_f32 v28, v28
    v_mfma_f32_32x32x16_bf16 v[96:111], v[160:163], v[144:147], v[96:111]
    v_exp_f32 v29, v29
    v_exp_f32 v30, v30
    v_exp_f32 v31, v31
    v_and_b32 v3, 48, v0
    v_lshl_add_u32 v1, v3, 4, v6
    v_lshl_add_u32 v253, v3, 4, v252
    s_lshr_b32 s31, s65, 2
    s_lshl_b32 s31, s31, 5
    s_and_b32 s32, s65, 2
    s_lshl_b32 s32, s32, 4
    s_and_b32 s33, s65, 28
    s_add_u32 s32, s32, s33
    v_bfe_u32 v3, v0, 2, 2
    v_and_b32 v4, 3, v0
    v_lshl_add_u32 v3, v4, 6, v3
    v_add_u32 v3, s32, v3
    v_add_u32 v4, s31, v0
    v_cmp_gt_u32 vcc, 32, v0
    s_nop 1
    v_cndmask_b32 v2, v3, v4, vcc
    v_lshlrev_b32 v2, 7, v2
    s_mov_b64 exec, s[100:101]
    buffer_load_dword v3, v2, s[8:11], s68 offen sc1
    s_mov_b64 exec, -1
    ds_read_b64_tr_b16 v[132:133], v176 offset:0
    ds_read_b64_tr_b16 v[134:135], v177 offset:0
    ds_read_b64_tr_b16 v[136:137], v176 offset:256
    ds_read_b64_tr_b16 v[138:139], v177 offset:256
    s_add_u32 m0, s26, 98304
    s_add_u32 s34, s64, 21504
    buffer_load_dwordx4 v6, s[8:11], s34 offen offset:0 lds
    buffer_load_dwordx4 v6, s[8:11], s34 offen offset:1024 lds
    buffer_load_dwordx4 v6, s[8:11], s34 offen offset:2048 lds
    buffer_load_dwordx4 v6, s[8:11], s34 offen offset:3072 lds
    s_add_u32 s34, s64, 28672
    buffer_load_dwordx4 v[180:183], v252, s[8:11], s34 offen offset:0
    buffer_load_dwordx4 v[184:187], v252, s[8:11], s34 offen offset:1024
    s_waitcnt lgkmcnt(0)
    s_barrier
    v_smfmac_f32_32x32x32_bf16 v[48:63], v[132:135], v[16:23], v5
    v_exp_f32 v32, v32
    v_exp_f32 v33, v33
    v_exp_f32 v34, v34
    v_exp_f32 v35, v35
    v_exp_f32 v36, v36
    v_exp_f32 v37, v37
    v_exp_f32 v38, v38
    v_exp_f32 v39, v39
    v_smfmac_f32_32x32x32_bf16 v[48:63], v[136:139], v[24:31], v5
    v_exp_f32 v40, v40
    v_exp_f32 v41, v41
    v_exp_f32 v42, v42
    v_exp_f32 v43, v43
    v_exp_f32 v44, v44
    v_exp_f32 v45, v45
    v_exp_f32 v46, v46
    v_exp_f32 v47, v47
    v_smfmac_f32_32x32x32_bf16 v[64:79], v[132:135], v[32:39], v5
    s_nop 0
    v_smfmac_f32_32x32x32_bf16 v[64:79], v[136:139], v[40:47], v5
    v_add_u32 v9, s26, v6
    v_add_u32 v10, 0x20000, v9
    ds_write_b128 v9, v[96:99] offset:0
    ds_write_b128 v9, v[100:103] offset:1024
    ds_write_b128 v9, v[104:107] offset:2048
    ds_write_b128 v9, v[108:111] offset:3072
    s_nop 5
    ds_write_b128 v10, v[64:67] offset:0
    ds_write_b128 v10, v[68:71] offset:1024
    ds_write_b128 v10, v[72:75] offset:2048
    ds_write_b128 v10, v[76:79] offset:3072
    s_add_u32 s34, s64, 4096
    buffer_load_dwordx4 v[204:207], v6, s[8:11], s34 offen offset:0
    buffer_load_dwordx4 v[208:211], v6, s[8:11], s34 offen offset:1024
    buffer_load_dwordx4 v[212:215], v6, s[8:11], s34 offen offset:2048
    buffer_load_dwordx4 v[216:219], v6, s[8:11], s34 offen offset:3072
    v_xor_b32 v9, 0x4000, v9
    v_xor_b32 v10, 0x4000, v10
    s_waitcnt vmcnt(15)
    v_lshlrev_b32 v15, 16, v15
    v_add_f32 v80, v80, v15
    v_add_f32 v81, v81, v15
    v_add_f32 v82, v82, v15
    v_add_f32 v83, v83, v15
    v_add_f32 v84, v84, v15
    v_add_f32 v85, v85, v15
    v_add_f32 v86, v86, v15
    v_add_f32 v87, v87, v15
    v_add_f32 v88, v88, v15
    v_add_f32 v89, v89, v15
    v_add_f32 v90, v90, v15
    v_add_f32 v91, v91, v15
    v_add_f32 v92, v92, v15
    v_add_f32 v93, v93, v15
    v_add_f32 v94, v94, v15
    v_add_f32 v95, v95, v15
    v_lshlrev_b32 v148, 16, v164
    v_and_b32 v149, s38, v164
    v_lshlrev_b32 v150, 16, v165
    v_and_b32 v151, s38, v165
    v_lshlrev_b32 v152, 16, v166
    v_and_b32 v153, s38, v166
    v_lshlrev_b32 v154, 16, v167
    v_and_b32 v155, s38, v167
    v_lshlrev_b32 v156, 16, v168
    v_and_b32 v157, s38, v168
    v_lshlrev_b32 v158, 16, v169
    v_and_b32 v159, s38, v169
    v_lshlrev_b32 v160, 16, v170
    v_and_b32 v161, s38, v170
    v_lshlrev_b32 v162, 16, v171
    v_and_b32 v163, s38, v171
    s_waitcnt lgkmcnt(0)
    s_barrier
    ds_read_b128 v[16:19], v9 offset:0
    ds_read_b128 v[20:23], v9 offset:1024
    ds_read_b128 v[24:27], v9 offset:2048
    ds_read_b128 v[28:31], v9 offset:3072
    ds_read_b128 v[32:35], v10 offset:0
    ds_read_b128 v[36:39], v10 offset:1024
    ds_read_b128 v[40:43], v10 offset:2048
    ds_read_b128 v[44:47], v10 offset:3072
    s_waitcnt lgkmcnt(7)
    v_add_f32 v80, v80, v16
    v_add_f32 v81, v81, v17
    v_add_f32 v82, v82, v18
    v_add_f32 v83, v83, v19
    s_waitcnt lgkmcnt(6)
    v_add_f32 v84, v84, v20
    v_add_f32 v85, v85, v21
    v_add_f32 v86, v86, v22
    v_add_f32 v87, v87, v23
    v_mul_f32 v80, v80, v148
    v_mul_f32 v81, v81, v149
    v_mul_f32 v82, v82, v150
    v_mul_f32 v83, v83, v151
    v_mul_f32 v84, v84, v152
    v_mul_f32 v85, v85, v153
    v_mul_f32 v86, v86, v154
    v_mul_f32 v87, v87, v155
    v_cvt_pk_bf16_f32 v140, v80, v81
    v_cvt_pk_bf16_f32 v141, v82, v83
    v_cvt_pk_bf16_f32 v142, v84, v85
    v_cvt_pk_bf16_f32 v143, v86, v87
    v_min_u32 v140, -2, v140
    v_min_u32 v141, -2, v141
    v_min_u32 v142, -2, v142
    v_min_u32 v143, -2, v143
    buffer_store_dwordx4 v[140:143], v13, s[8:11], s44 offen offset:0 sc1
    s_waitcnt lgkmcnt(5)
    v_add_f32 v88, v88, v24
    v_add_f32 v89, v89, v25
    v_add_f32 v90, v90, v26
    v_add_f32 v91, v91, v27
    s_waitcnt lgkmcnt(4)
    v_add_f32 v92, v92, v28
    v_add_f32 v93, v93, v29
    v_add_f32 v94, v94, v30
    v_add_f32 v95, v95, v31
    v_mul_f32 v88, v88, v156
    v_mul_f32 v89, v89, v157
    v_mul_f32 v90, v90, v158
    v_mul_f32 v91, v91, v159
    v_mul_f32 v92, v92, v160
    v_mul_f32 v93, v93, v161
    v_mul_f32 v94, v94, v162
    v_mul_f32 v95, v95, v163
    v_cvt_pk_bf16_f32 v144, v88, v89
    v_cvt_pk_bf16_f32 v145, v90, v91
    v_cvt_pk_bf16_f32 v146, v92, v93
    v_cvt_pk_bf16_f32 v147, v94, v95
    v_min_u32 v144, -2, v144
    v_min_u32 v145, -2, v145
    v_min_u32 v146, -2, v146
    v_min_u32 v147, -2, v147
    buffer_store_dwordx4 v[144:147], v14, s[8:11], s44 offen offset:512 sc1
    s_waitcnt lgkmcnt(3)
    v_add_f32 v48, v48, v32
    v_add_f32 v49, v49, v33
    v_add_f32 v50, v50, v34
    v_add_f32 v51, v51, v35
    s_waitcnt lgkmcnt(2)
    v_add_f32 v52, v52, v36
    v_add_f32 v53, v53, v37
    v_add_f32 v54, v54, v38
    v_add_f32 v55, v55, v39
    s_waitcnt lgkmcnt(1)
    v_add_f32 v56, v56, v40
    v_add_f32 v57, v57, v41
    v_add_f32 v58, v58, v42
    v_add_f32 v59, v59, v43
    s_waitcnt lgkmcnt(0)
    v_add_f32 v60, v60, v44
    v_rcp_f32 v9, v60
    s_nop 0
    v_mul_f32 v48, v48, v9
    v_mul_f32 v49, v49, v9
    v_mul_f32 v50, v50, v9
    v_mul_f32 v51, v51, v9
    v_mul_f32 v52, v52, v9
    v_mul_f32 v53, v53, v9
    v_mul_f32 v54, v54, v9
    v_mul_f32 v55, v55, v9
    v_mul_f32 v56, v56, v9
    v_mul_f32 v57, v57, v9
    v_mul_f32 v58, v58, v9
    v_mul_f32 v59, v59, v9
    s_mov_b32 s31, 0x4d800000
    v_mul_f32 v10, 0x43800000, v60
    v_fma_f32 v10, v9, s31, v10
    v_add_f32 v16, v48, v49
    v_add_f32 v17, v50, v51
    v_add_f32 v18, v52, v53
    v_add_f32 v19, v54, v55
    v_add_f32 v20, v56, v57
    v_add_f32 v21, v58, v59
    v_add_f32 v16, v16, v17
    v_add_f32 v18, v18, v19
    v_add_f32 v20, v20, v21
    v_add_f32 v16, v16, v18
    v_add_f32 v10, v10, v20
    v_add_f32 v10, v10, v16
    v_mov_b32 v16, 519
    v_cmp_class_f32 vcc, v10, v16
    s_cbranch_vccnz K2_SLOW0
    v_cvt_pk_bf16_f32 v124, v48, v49
    v_cvt_pk_bf16_f32 v125, v50, v51
    v_cvt_pk_bf16_f32 v126, v52, v53
    v_cvt_pk_bf16_f32 v127, v54, v55
    v_cvt_pk_bf16_f32 v128, v56, v57
    v_cvt_pk_bf16_f32 v129, v58, v59
    v_min_u32 v124, -2, v124
    v_min_u32 v125, -2, v125
    v_min_u32 v126, -2, v126
    v_min_u32 v127, -2, v127
    v_min_u32 v128, -2, v128
    v_min_u32 v129, -2, v129
    buffer_store_dwordx4 v[124:127], v7, s[8:11], s45 offen sc1
    buffer_store_dwordx2 v[128:129], v8, s[8:11], s45 offen offset:1024 sc1
    s_branch K3_GO
K2_1:
    s_add_u32 s31, s39, 37888
    s_cmp_eq_u32 s21, 3
    s_cselect_b32 s31, 2130706432, s31
    s_cselect_b32 s46, 0, -1
    s_cselect_b32 s47, 0x80000000, -1
    s_cmp_eq_u32 s51, 0
    s_mov_b32 s32, 0x243243
    s_cmov_b32 s32, 0x210210
    v_cmp_lt_u32 vcc, 2, v12
    v_lshlrev_b32 v12, 2, v12
    v_bfe_u32 v4, s32, v12, 4
    v_lshlrev_b32 v4, 5, v4
    v_cndmask_b32 v5, 0, 1, vcc
    s_movk_i32 s32, 7680
    v_mad_u32_u24 v4, v5, s32, v4
    v_add_u32 v4, v4, v9
    s_mov_b32 s32, 0x840840
    v_bfe_u32 v12, s32, v12, 4
    v_xor_b32 v4, v4, v12
    v_lshl_add_u32 v4, v4, 4, s31
    s_cmp_eq_u32 s21, 3
    s_mov_b32 s6, 245760
    s_cmov_b32 s6, 256
    s_cselect_b32 s7, 0x80000000, -1
    s_add_u32 m0, s26, 0
    s_nop 0
    buffer_load_dwordx4 v1, s[12:15], s27 offen lds
    buffer_load_dwordx4 v2, s[12:15], s27 offen offset:1024 lds
    buffer_load_dwordx4 v3, s[8:11], s28 offen offset:2048 lds
    s_add_u32 s27, s27, 128
    s_add_u32 s28, s28, 221184
    s_add_u32 m0, s26, 32768
    s_nop 0
    buffer_load_dwordx4 v1, s[12:15], s27 offen lds
    buffer_load_dwordx4 v2, s[12:15], s27 offen offset:1024 lds
    buffer_load_dwordx4 v3, s[8:11], s28 offen offset:2048 lds
    s_mov_b64 exec, s[46:47]
    buffer_load_dwordx4 v4, s[8:11], s29 offen offset:3072 lds
    s_mov_b64 exec, -1
    s_add_u32 s29, s29, s6
    s_add_u32 s27, s27, 128
    s_add_u32 s28, s28, 221184
    s_add_u32 m0, s26, 65536
    s_nop 0
    buffer_load_dwordx4 v1, s[12:15], s27 offen lds
    buffer_load_dwordx4 v2, s[12:15], s27 offen offset:1024 lds
    buffer_load_dwordx4 v3, s[8:11], s28 offen offset:2048 lds
    s_mov_b64 exec, s[46:47]
    buffer_load_dwordx4 v4, s[8:11], s29 offen offset:3072 lds
    s_mov_b64 exec, -1
    s_add_u32 s29, s29, s6
    s_add_u32 s27, s27, 128
    s_add_u32 s28, s28, 221184
    v_bfe_u32 v13, v0, 1, 3
    v_xor_b32 v13, v13, v10
    v_xor_b32 v13, 4, v13
    v_and_b32 v14, 15, v0
    v_lshlrev_b32 v14, 7, v14
    v_lshl_add_u32 v13, v13, 4, v14
    v_bfe_u32 v14, v0, 4, 1
    v_lshl_add_u32 v13, v14, 12, v13
    s_lshl_b32 s31, s21, 13
    v_add_u32 v172, s31, v13
    v_xor_b32 v173, 32, v172
    v_and_b32 v254, 12, v0
    v_lshlrev_b32 v254, 2, v254
    v_lshl_add_u32 v254, v10, 7, v254
    v_and_b32 v13, 1, v0
    v_lshl_add_u32 v15, v13, 1, v14
    v_lshlrev_b32 v15, 6, v15
    v_xor_b32 v15, v15, v254
    v_lshl_add_u32 v15, v13, 13, v15
    v_lshl_add_u32 v15, v14, 9, v15
    v_and_b32 v12, 2, v0
    v_lshl_add_u32 v15, v12, 2, v15
    v_add_u32 v174, 18432, v15
    v_xor_b32 v175, 64, v174
    v_and_b32 v13, 3, v0
    v_lshl_add_u32 v13, v14, 2, v13
    v_lshlrev_b32 v13, 2, v13
    s_mul_i32 s31, s51, 0x44440000
    s_xor_b32 s31, s31, 0x77725410
    v_bfe_u32 v13, s31, v13, 3
    v_and_b32 v15, 3, v13
    v_lshrrev_b32 v13, 2, v13
    v_lshl_add_u32 v254, v13, 3, v254
    v_lshl_add_u32 v255, v15, 9, v254
    v_min_u32 v13, 2, v15
    v_lshlrev_b32 v13, 6, v13
    v_xor_b32 v254, v13, v254
    v_lshlrev_b32 v15, 3, v15
    s_mov_b32 s31, 0xf080700
    v_bfe_u32 v15, s31, v15, 8
    v_lshl_add_u32 v254, v15, 9, v254
    v_add_u32 v176, 24064, v254
    v_xor_b32 v177, 64, v176
    s_movk_i32 s31, 3584
    v_lshlrev_b32 v13, 4, v9
    v_mad_u32_u24 v15, v10, s31, v13
    v_add_u32 v178, 7680, v15
    s_movk_i32 s31, 3592
    v_mad_u32_u24 v15, v10, s31, v13
    s_lshl_b32 s31, s51, 3
    v_xor_b32 v15, s31, v15
    v_add_u32 v179, 11776, v15
    s_lshl_b32 s31, s21, 15
    v_lshl_add_u32 v13, v0, 3, s31
    v_mov_b32 v48, 16256
    v_mov_b32 v49, 0
    ds_write_b64 v13, v[48:49] offset:31744
    s_waitcnt lgkmcnt(0)
    v_add_u32 v180, 0x10000, v172
    v_add_u32 v181, 0x10000, v173
    v_add_u32 v182, 0x10000, v174
    v_add_u32 v183, 0x10000, v175
    v_add_u32 v184, 0x10000, v176
    v_add_u32 v185, 0x10000, v177
    v_add_u32 v186, 0x10000, v178
    v_add_u32 v187, 0x10000, v179
    v_mov_b32 v5, 0xdddddddd
    s_mov_b32 s38, 0xffff0000
    v_mov_b32 v48, 0
    v_mov_b32 v49, 0
    v_mov_b32 v50, 0
    v_mov_b32 v51, 0
    v_mov_b32 v52, 0
    v_mov_b32 v53, 0
    v_mov_b32 v54, 0
    v_mov_b32 v55, 0
    v_mov_b32 v56, 0
    v_mov_b32 v57, 0
    v_mov_b32 v58, 0
    v_mov_b32 v59, 0
    v_mov_b32 v60, 0
    v_mov_b32 v61, 0
    v_mov_b32 v62, 0
    v_mov_b32 v63, 0
    v_mov_b32 v64, 0
    v_mov_b32 v65, 0
    v_mov_b32 v66, 0
    v_mov_b32 v67, 0
    v_mov_b32 v68, 0
    v_mov_b32 v69, 0
    v_mov_b32 v70, 0
    v_mov_b32 v71, 0
    v_mov_b32 v72, 0
    v_mov_b32 v73, 0
    v_mov_b32 v74, 0
    v_mov_b32 v75, 0
    v_mov_b32 v76, 0
    v_mov_b32 v77, 0
    v_mov_b32 v78, 0
    v_mov_b32 v79, 0
    v_lshlrev_b32 v13, 2, v10
    v_add_u32 v13, 2, v13
    v_lshlrev_b32 v15, 4, v9
    v_lshl_add_u32 v15, v13, 9, v15
    v_add_u32 v14, 1, v13
    v_cmp_gt_u32 vcc, s42, v13
    s_nop 1
    v_cndmask_b32 v13, v11, v15, vcc
    v_cmp_gt_u32 vcc, s42, v14
    s_nop 1
    v_cndmask_b32 v14, v11, v15, vcc
    s_lshl_b32 s31, s24, 2
    s_add_u32 s31, s31, s21
    s_mul_i32 s43, s31, 110592
    s_add_u32 s43, s43, s41
    s_add_u32 s43, s43, 7864320
    s_mul_i32 s44, s31, 96256
    s_add_u32 s44, s44, s41
    s_add_u32 s44, s44, 16556032
    s_lshl_b32 s31, s31, 6
    v_lshlrev_b32 v15, 1, v9
    v_add_u32 v15, s31, v15
    s_lshl_b32 s31, s23, 2
    s_add_u32 s31, s31, s21
    s_mul_i32 s45, s31, 192512
    s_add_u32 s45, s45, s39
    s_add_u32 s45, s45, 16570368
    s_load_dwordx2 s[56:57], s[0:1], 0
    s_load_dwordx2 s[60:61], s[0:1], 64
    s_and_b32 s31, s54, 7
    s_lshl_b32 s31, s31, 2
    s_bfe_u32 s65, s54, 0x20003
    s_add_u32 s65, s65, s31
    s_lshr_b32 s66, s54, 5
    s_mul_i32 s64, s66, 240640
    s_mul_i32 s31, s20, 30720
    s_add_u32 s64, s64, s31
    s_add_u32 s64, s64, 22937600
    s_mov_b32 s58, 2621440
    s_mov_b32 s59, 0x00020000
    s_mov_b32 s62, 2621440
    s_mov_b32 s63, 0x00020000
    s_mul_i32 s4, s65, 192512
    s_mul_i32 s31, s20, 12288
    s_add_u32 s4, s4, s31
    s_add_u32 s4, s4, 16515072
    s_and_b32 s31, s66, 1
    s_lshl_b32 s31, s31, 8
    s_add_u32 s4, s4, s31
    s_bitcmp1_b32 s66, 1
    s_cselect_b32 s31, 0, 96256
    s_cselect_b32 s32, 96256, 0
    s_add_u32 s97, s4, s31
    s_add_u32 s4, s4, s32
    s_add_u32 s5, s4, 4096
    s_add_u32 s96, s4, 8192
    s_add_u32 s98, s97, 4096
    s_add_u32 s99, s97, 8192
    s_lshl_b32 s33, s21, 3
    s_lshr_b32 s31, 0x2c292522, s33
    s_lshr_b32 s32, 0x4040504, s33
    s_bfm_b64 s[100:101], s32, s31
    s_mov_b32 s68, 14946304
    s_lshl_b32 s69, s54, 7
    s_add_u32 s69, s69, 14979072
    s_lshl_b32 s31, s23, 5
    s_add_u32 s31, s31, s22
    s_lshl_b32 s31, s31, 7
    s_add_u32 s67, s31, s68
    s_cmp_eq_u32 s20, 7
    s_cselect_b32 s31, 2130706432, 0
    v_or_b32 v252, s31, v6
    s_mov_b64 exec, 1
    buffer_store_dword v5, off, s[8:11], s67 sc1
    s_mov_b64 exec, -1
    s_waitcnt vmcnt(19)
    v_mfma_f32_32x32x16_bf16 v[16:31], v[124:127], v[112:115], 0
    s_waitcnt vmcnt(17)
    v_mfma_f32_32x32x16_bf16 v[80:95], v[132:135], v[112:115], 0
    v_mfma_f32_32x32x16_bf16 v[32:47], v[124:127], v[116:119], 0
    v_mfma_f32_32x32x16_bf16 v[96:111], v[132:135], v[116:119], 0
    s_waitcnt vmcnt(15)
    v_mfma_f32_32x32x8bf16_1k v[16:31], v[128:129], v[120:121], v[16:31]
    s_waitcnt vmcnt(13)
    v_mfma_f32_32x32x8bf16_1k v[80:95], v[136:137], v[120:121], v[80:95]
    v_mfma_f32_32x32x8bf16_1k v[32:47], v[128:129], v[122:123], v[32:47]
    v_mfma_f32_32x32x8bf16_1k v[96:111], v[136:137], v[122:123], v[96:111]
    s_waitcnt vmcnt(12)
    v_or3_b32 v164, v164, v165, v166
    v_or_b32 v164, v164, v167
    v_cmp_ne_u32 vcc, 0, v164
    s_and_b64 vcc, vcc, s[48:49]
    s_cbranch_scc1 K2_FIX
    s_nop 1
    v_max3_f32 v9, v16, v17, v18
    s_nop 1
    v_max3_f32 v10, v32, v33, v34
    v_max3_f32 v9, v9, v19, v20
    v_max3_f32 v10, v10, v35, v36
    v_max3_f32 v9, v9, v21, v22
    v_max3_f32 v10, v10, v37, v38
    v_max3_f32 v9, v9, v23, v24
    v_max3_f32 v10, v10, v39, v40
    v_max3_f32 v9, v9, v25, v26
    v_max3_f32 v10, v10, v41, v42
    v_max3_f32 v9, v9, v27, v28
    v_max3_f32 v10, v10, v43, v44
    v_max3_f32 v9, v9, v29, v30
    v_max3_f32 v10, v10, v45, v46
    v_max3_f32 v9, v9, v31, v80
    v_max3_f32 v10, v10, v47, v96
    v_max3_f32 v9, v9, v81, v82
    v_max3_f32 v10, v10, v97, v98
    v_max3_f32 v9, v9, v83, v84
    v_max3_f32 v10, v10, v99, v100
    v_max3_f32 v9, v9, v85, v86
    v_max3_f32 v10, v10, v101, v102
    v_max3_f32 v9, v9, v87, v88
    v_max3_f32 v10, v10, v103, v104
    v_max3_f32 v9, v9, v89, v90
    v_max3_f32 v10, v10, v105, v106
    v_max3_f32 v9, v9, v91, v92
    v_max3_f32 v10, v10, v107, v108
    v_max3_f32 v9, v9, v93, v94
    v_max3_f32 v10, v10, v109, v110
    v_max_f32 v9, v9, v95
    v_max_f32 v10, v10, v111
    s_nop 1
    v_permlane32_swap_b32 v9, v10
    v_max_f32 v9, v9, v10
    v_sub_f32 v9, 0xc2b00000, v9
    v_cvt_pk_bf16_f32 v10, v9, v9
    v_and_b32 v10, s38, v10
    v_sub_f32 v10, v9, v10
    v_cvt_pk_bf16_f32 v11, v9, v10
    v_and_b32 v9, s38, v11
    v_sub_f32 v10, v10, v9
    v_cvt_pk_bf16_f32 v12, v10, 0
    v_cndmask_b32 v122, v122, v11, s[36:37]
    v_cndmask_b32 v123, v123, v12, s[36:37]
    v_permlane32_swap_b32 v120, v11
    v_permlane32_swap_b32 v121, v12
    s_waitcnt vmcnt(9)
    s_barrier
    ds_read_b128 v[124:127], v178 offset:0
    ds_read_b64 v[128:129], v179 offset:0
    ds_read_b128 v[140:143], v172 offset:0
    ds_read_b64_tr_b16 v[148:149], v174 offset:0
    ds_read_b64_tr_b16 v[150:151], v175 offset:0
    ds_read_b64_tr_b16 v[152:153], v174 offset:4096
    ds_read_b64_tr_b16 v[154:155], v175 offset:4096
    ds_read_b128 v[144:147], v173 offset:0
    ds_read_b64_tr_b16 v[156:157], v174 offset:256
    ds_read_b64_tr_b16 v[158:159], v175 offset:256
    ds_read_b64_tr_b16 v[160:161], v174 offset:4352
    ds_read_b64_tr_b16 v[162:163], v175 offset:4352
    s_add_u32 m0, s26, 98304
    s_nop 0
    buffer_load_dwordx4 v1, s[12:15], s27 offen lds
    buffer_load_dwordx4 v2, s[12:15], s27 offen offset:1024 lds
    buffer_load_dwordx4 v3, s[8:11], s28 offen offset:2048 lds
    s_mov_b64 exec, s[46:47]
    buffer_load_dwordx4 v4, s[8:11], s29 offen offset:3072 lds
    s_mov_b64 exec, -1
    s_add_u32 s29, s29, s6
    s_add_u32 s27, s27, 128
    s_add_u32 s28, s28, 221184
    s_waitcnt lgkmcnt(0)
    v_mfma_f32_32x32x16_bf16 v[16:31], v[124:127], v[112:115], 0
    v_mfma_f32_32x32x8bf16_1k v[16:31], v[128:129], v[120:121], v[16:31]
    v_mfma_f32_32x32x16_bf16 v[80:95], v[148:151], v[140:143], 0
    v_mfma_f32_32x32x16_bf16 v[96:111], v[152:155], v[140:143], 0
    v_mfma_f32_32x32x16_bf16 v[32:47], v[124:127], v[116:119], 0
    s_nop 8
    v_exp_f32 v16, v16
    v_exp_f32 v17, v17
    v_exp_f32 v18, v18
    v_exp_f32 v19, v19
    v_mfma_f32_32x32x8bf16_1k v[32:47], v[128:129], v[122:123], v[32:47]
    v_exp_f32 v20, v20
    v_exp_f32 v21, v21
    v_exp_f32 v22, v22
    v_exp_f32 v23, v23
    v_mfma_f32_32x32x16_bf16 v[80:95], v[156:159], v[144:147], v[80:95]
    v_exp_f32 v24, v24
    v_exp_f32 v25, v25
    v_exp_f32 v26, v26
    v_exp_f32 v27, v27
    v_mfma_f32_32x32x16_bf16 v[96:111], v[160:163], v[144:147], v[96:111]
    v_exp_f32 v28, v28
    v_exp_f32 v29, v29
    v_exp_f32 v30, v30
    v_exp_f32 v31, v31
    s_mov_b32 s30, 0
K2_L1:
    s_waitcnt vmcnt(9)
    s_waitcnt vmcnt(8)
    s_barrier
    ds_read_b64_tr_b16 v[132:133], v176 offset:32768
    ds_read_b64_tr_b16 v[134:135], v177 offset:32768
    ds_read_b64_tr_b16 v[136:137], v176 offset:33024
    ds_read_b64_tr_b16 v[138:139], v177 offset:33024
    ds_read_b128 v[124:127], v178 offset:32768
    ds_read_b64 v[128:129], v179 offset:32768
    ds_read_b128 v[140:143], v172 offset:32768
    ds_read_b64_tr_b16 v[148:149], v174 offset:32768
    ds_read_b64_tr_b16 v[150:151], v175 offset:32768
    ds_read_b64_tr_b16 v[152:153], v174 offset:36864
    ds_read_b64_tr_b16 v[154:155], v175 offset:36864
    ds_read_b128 v[144:147], v173 offset:32768
    ds_read_b64_tr_b16 v[156:157], v174 offset:33024
    ds_read_b64_tr_b16 v[158:159], v175 offset:33024
    ds_read_b64_tr_b16 v[160:161], v174 offset:37120
    ds_read_b64_tr_b16 v[162:163], v175 offset:37120
    s_add_u32 m0, s26, 0
    s_nop 0
    buffer_load_dwordx4 v1, s[12:15], s27 offen lds
    buffer_load_dwordx4 v2, s[12:15], s27 offen offset:1024 lds
    buffer_load_dwordx4 v3, s[8:11], s28 offen offset:2048 lds
    s_mov_b64 exec, s[46:47]
    buffer_load_dwordx4 v4, s[8:11], s29 offen offset:3072 lds
    s_mov_b64 exec, -1
    s_add_u32 s29, s29, s6
    s_add_u32 s27, s27, 128
    s_add_u32 s28, s28, 221184
    s_waitcnt lgkmcnt(14)
    v_smfmac_f32_32x32x32_bf16 v[48:63], v[132:135], v[16:23], v5
    v_exp_f32 v32, v32
    v_exp_f32 v33, v33
    s_waitcnt lgkmcnt(12)
    v_smfmac_f32_32x32x32_bf16 v[48:63], v[136:139], v[24:31], v5
    v_exp_f32 v34, v34
    v_exp_f32 v35, v35
    s_waitcnt lgkmcnt(11)
    v_mfma_f32_32x32x16_bf16 v[16:31], v[124:127], v[112:115], 0
    v_exp_f32 v36, v36
    v_exp_f32 v37, v37
    v_exp_f32 v38, v38
    s_waitcnt lgkmcnt(10)
    v_mfma_f32_32x32x8bf16_1k v[16:31], v[128:129], v[120:121], v[16:31]
    v_exp_f32 v39, v39
    v_exp_f32 v40, v40
    v_exp_f32 v41, v41
    s_waitcnt lgkmcnt(7)
    v_mfma_f32_32x32x16_bf16 v[80:95], v[148:151], v[140:143], v[80:95]
    v_exp_f32 v42, v42
    v_exp_f32 v43, v43
    v_exp_f32 v44, v44
    s_waitcnt lgkmcnt(5)
    v_mfma_f32_32x32x16_bf16 v[96:111], v[152:155], v[140:143], v[96:111]
    v_exp_f32 v45, v45
    v_exp_f32 v46, v46
    v_exp_f32 v47, v47
    v_smfmac_f32_32x32x32_bf16 v[64:79], v[132:135], v[32:39], v5
    v_exp_f32 v16, v16
    v_exp_f32 v17, v17
    v_smfmac_f32_32x32x32_bf16 v[64:79], v[136:139], v[40:47], v5
    v_exp_f32 v18, v18
    v_exp_f32 v19, v19
    v_mfma_f32_32x32x16_bf16 v[32:47], v[124:127], v[116:119], 0
    v_exp_f32 v20, v20
    v_exp_f32 v21, v21
    v_exp_f32 v22, v22
    v_mfma_f32_32x32x8bf16_1k v[32:47], v[128:129], v[122:123], v[32:47]
    v_exp_f32 v23, v23
    v_exp_f32 v24, v24
    v_exp_f32 v25, v25
    s_waitcnt lgkmcnt(2)
    v_mfma_f32_32x32x16_bf16 v[80:95], v[156:159], v[144:147], v[80:95]
    v_exp_f32 v26, v26
    v_exp_f32 v27, v27
    v_exp_f32 v28, v28
    s_waitcnt lgkmcnt(0)
    v_mfma_f32_32x32x16_bf16 v[96:111], v[160:163], v[144:147], v[96:111]
    v_exp_f32 v29, v29
    v_exp_f32 v30, v30
    v_exp_f32 v31, v31
    s_waitcnt vmcnt(9)
    s_waitcnt vmcnt(8)
    s_barrier
    ds_read_b64_tr_b16 v[132:133], v184 offset:0
    ds_read_b64_tr_b16 v[134:135], v185 offset:0
    ds_read_b64_tr_b16 v[136:137], v184 offset:256
    ds_read_b64_tr_b16 v[138:139], v185 offset:256
    ds_read_b128 v[124:127], v186 offset:0
    ds_read_b64 v[128:129], v187 offset:0
    ds_read_b128 v[140:143], v180 offset:0
    ds_read_b64_tr_b16 v[148:149], v182 offset:0
    ds_read_b64_tr_b16 v[150:151], v183 offset:0
    ds_read_b64_tr_b16 v[152:153], v182 offset:4096
    ds_read_b64_tr_b16 v[154:155], v183 offset:4096
    ds_read_b128 v[144:147], v181 offset:0
    ds_read_b64_tr_b16 v[156:157], v182 offset:256
    ds_read_b64_tr_b16 v[158:159], v183 offset:256
    ds_read_b64_tr_b16 v[160:161], v182 offset:4352
    ds_read_b64_tr_b16 v[162:163], v183 offset:4352
    s_add_u32 m0, s26, 32768
    s_nop 0
    buffer_load_dwordx4 v1, s[12:15], s27 offen lds
    buffer_load_dwordx4 v2, s[12:15], s27 offen offset:1024 lds
    buffer_load_dwordx4 v3, s[8:11], s28 offen offset:2048 lds
    s_mov_b64 exec, s[46:47]
    buffer_load_dwordx4 v4, s[8:11], s29 offen offset:3072 lds
    s_mov_b64 exec, -1
    s_add_u32 s29, s29, s6
    s_add_u32 s27, s27, 128
    s_add_u32 s28, s28, 221184
    s_waitcnt lgkmcnt(14)
    v_smfmac_f32_32x32x32_bf16 v[48:63], v[132:135], v[16:23], v5
    v_exp_f32 v32, v32
    v_exp_f32 v33, v33
    s_waitcnt lgkmcnt(12)
    v_smfmac_f32_32x32x32_bf16 v[48:63], v[136:139], v[24:31], v5
    v_exp_f32 v34, v34
    v_exp_f32 v35, v35
    s_waitcnt lgkmcnt(11)
    v_mfma_f32_32x32x16_bf16 v[16:31], v[124:127], v[112:115], 0
    v_exp_f32 v36, v36
    v_exp_f32 v37, v37
    v_exp_f32 v38, v38
    s_waitcnt lgkmcnt(10)
    v_mfma_f32_32x32x8bf16_1k v[16:31], v[128:129], v[120:121], v[16:31]
    v_exp_f32 v39, v39
    v_exp_f32 v40, v40
    v_exp_f32 v41, v41
    s_waitcnt lgkmcnt(7)
    v_mfma_f32_32x32x16_bf16 v[80:95], v[148:151], v[140:143], v[80:95]
    v_exp_f32 v42, v42
    v_exp_f32 v43, v43
    v_exp_f32 v44, v44
    s_waitcnt lgkmcnt(5)
    v_mfma_f32_32x32x16_bf16 v[96:111], v[152:155], v[140:143], v[96:111]
    v_exp_f32 v45, v45
    v_exp_f32 v46, v46
    v_exp_f32 v47, v47
    v_smfmac_f32_32x32x32_bf16 v[64:79], v[132:135], v[32:39], v5
    v_exp_f32 v16, v16
    v_exp_f32 v17, v17
    v_smfmac_f32_32x32x32_bf16 v[64:79], v[136:139], v[40:47], v5
    v_exp_f32 v18, v18
    v_exp_f32 v19, v19
    v_mfma_f32_32x32x16_bf16 v[32:47], v[124:127], v[116:119], 0
    v_exp_f32 v20, v20
    v_exp_f32 v21, v21
    v_exp_f32 v22, v22
    v_mfma_f32_32x32x8bf16_1k v[32:47], v[128:129], v[122:123], v[32:47]
    v_exp_f32 v23, v23
    v_exp_f32 v24, v24
    v_exp_f32 v25, v25
    s_waitcnt lgkmcnt(2)
    v_mfma_f32_32x32x16_bf16 v[80:95], v[156:159], v[144:147], v[80:95]
    v_exp_f32 v26, v26
    v_exp_f32 v27, v27
    v_exp_f32 v28, v28
    s_waitcnt lgkmcnt(0)
    v_mfma_f32_32x32x16_bf16 v[96:111], v[160:163], v[144:147], v[96:111]
    v_exp_f32 v29, v29
    v_exp_f32 v30, v30
    v_exp_f32 v31, v31
    s_waitcnt vmcnt(8)
    s_barrier
    ds_read_b64_tr_b16 v[132:133], v184 offset:32768
    ds_read_b64_tr_b16 v[134:135], v185 offset:32768
    ds_read_b64_tr_b16 v[136:137], v184 offset:33024
    ds_read_b64_tr_b16 v[138:139], v185 offset:33024
    ds_read_b128 v[124:127], v186 offset:32768
    ds_read_b64 v[128:129], v187 offset:32768
    ds_read_b128 v[140:143], v180 offset:32768
    ds_read_b64_tr_b16 v[148:149], v182 offset:32768
    ds_read_b64_tr_b16 v[150:151], v183 offset:32768
    ds_read_b64_tr_b16 v[152:153], v182 offset:36864
    ds_read_b64_tr_b16 v[154:155], v183 offset:36864
    ds_read_b128 v[144:147], v181 offset:32768
    ds_read_b64_tr_b16 v[156:157], v182 offset:33024
    ds_read_b64_tr_b16 v[158:159], v183 offset:33024
    ds_read_b64_tr_b16 v[160:161], v182 offset:37120
    ds_read_b64_tr_b16 v[162:163], v183 offset:37120
    s_add_u32 m0, s26, 65536
    s_nop 0
    buffer_load_dwordx4 v1, s[12:15], s27 offen lds
    buffer_load_dwordx4 v2, s[12:15], s27 offen offset:1024 lds
    buffer_load_dwordx4 v3, s[8:11], s28 offen offset:2048 lds
    s_mov_b64 exec, s[46:47]
    buffer_load_dwordx4 v4, s[8:11], s29 offen offset:3072 lds
    s_mov_b64 exec, -1
    s_add_u32 s29, s29, s6
    s_add_u32 s27, s27, 128
    s_add_u32 s28, s28, 221184
    s_waitcnt lgkmcnt(14)
    v_smfmac_f32_32x32x32_bf16 v[48:63], v[132:135], v[16:23], v5
    v_exp_f32 v32, v32
    v_exp_f32 v33, v33
    s_waitcnt lgkmcnt(12)
    v_smfmac_f32_32x32x32_bf16 v[48:63], v[136:139], v[24:31], v5
    v_exp_f32 v34, v34
    v_exp_f32 v35, v35
    s_waitcnt lgkmcnt(11)
    v_mfma_f32_32x32x16_bf16 v[16:31], v[124:127], v[112:115], 0
    v_exp_f32 v36, v36
    v_exp_f32 v37, v37
    v_exp_f32 v38, v38
    s_waitcnt lgkmcnt(10)
    v_mfma_f32_32x32x8bf16_1k v[16:31], v[128:129], v[120:121], v[16:31]
    v_exp_f32 v39, v39
    v_exp_f32 v40, v40
    v_exp_f32 v41, v41
    s_waitcnt lgkmcnt(7)
    v_mfma_f32_32x32x16_bf16 v[80:95], v[148:151], v[140:143], v[80:95]
    v_exp_f32 v42, v42
    v_exp_f32 v43, v43
    v_exp_f32 v44, v44
    s_waitcnt lgkmcnt(5)
    v_mfma_f32_32x32x16_bf16 v[96:111], v[152:155], v[140:143], v[96:111]
    v_exp_f32 v45, v45
    v_exp_f32 v46, v46
    v_exp_f32 v47, v47
    v_smfmac_f32_32x32x32_bf16 v[64:79], v[132:135], v[32:39], v5
    v_exp_f32 v16, v16
    v_exp_f32 v17, v17
    v_smfmac_f32_32x32x32_bf16 v[64:79], v[136:139], v[40:47], v5
    v_exp_f32 v18, v18
    v_exp_f32 v19, v19
    v_mfma_f32_32x32x16_bf16 v[32:47], v[124:127], v[116:119], 0
    v_exp_f32 v20, v20
    v_exp_f32 v21, v21
    v_exp_f32 v22, v22
    v_mfma_f32_32x32x8bf16_1k v[32:47], v[128:129], v[122:123], v[32:47]
    v_exp_f32 v23, v23
    v_exp_f32 v24, v24
    v_exp_f32 v25, v25
    s_waitcnt lgkmcnt(2)
    v_mfma_f32_32x32x16_bf16 v[80:95], v[156:159], v[144:147], v[80:95]
    v_exp_f32 v26, v26
    v_exp_f32 v27, v27
    v_exp_f32 v28, v28
    s_waitcnt lgkmcnt(0)
    v_mfma_f32_32x32x16_bf16 v[96:111], v[160:163], v[144:147], v[96:111]
    v_exp_f32 v29, v29
    v_exp_f32 v30, v30
    v_exp_f32 v31, v31
    s_waitcnt vmcnt(8)
    s_barrier
    ds_read_b64_tr_b16 v[132:133], v176 offset:0
    ds_read_b64_tr_b16 v[134:135], v177 offset:0
    ds_read_b64_tr_b16 v[136:137], v176 offset:256
    ds_read_b64_tr_b16 v[138:139], v177 offset:256
    ds_read_b128 v[124:127], v178 offset:0
    ds_read_b64 v[128:129], v179 offset:0
    ds_read_b128 v[140:143], v172 offset:0
    ds_read_b64_tr_b16 v[148:149], v174 offset:0
    ds_read_b64_tr_b16 v[150:151], v175 offset:0
    ds_read_b64_tr_b16 v[152:153], v174 offset:4096
    ds_read_b64_tr_b16 v[154:155], v175 offset:4096
    ds_read_b128 v[144:147], v173 offset:0
    ds_read_b64_tr_b16 v[156:157], v174 offset:256
    ds_read_b64_tr_b16 v[158:159], v175 offset:256
    ds_read_b64_tr_b16 v[160:161], v174 offset:4352
    ds_read_b64_tr_b16 v[162:163], v175 offset:4352
    s_add_u32 m0, s26, 98304
    s_nop 0
    buffer_load_dwordx4 v1, s[12:15], s27 offen lds
    buffer_load_dwordx4 v2, s[12:15], s27 offen offset:1024 lds
    buffer_load_dwordx4 v3, s[8:11], s28 offen offset:2048 lds
    s_mov_b64 exec, s[46:47]
    buffer_load_dwordx4 v4, s[8:11], s29 offen offset:3072 lds
    s_mov_b64 exec, -1
    s_add_u32 s29, s29, s6
    s_add_u32 s27, s27, 128
    s_add_u32 s28, s28, 221184
    s_waitcnt lgkmcnt(14)
    v_smfmac_f32_32x32x32_bf16 v[48:63], v[132:135], v[16:23], v5
    v_exp_f32 v32, v32
    v_exp_f32 v33, v33
    s_waitcnt lgkmcnt(12)
    v_smfmac_f32_32x32x32_bf16 v[48:63], v[136:139], v[24:31], v5
    v_exp_f32 v34, v34
    v_exp_f32 v35, v35
    s_waitcnt lgkmcnt(11)
    v_mfma_f32_32x32x16_bf16 v[16:31], v[124:127], v[112:115], 0
    v_exp_f32 v36, v36
    v_exp_f32 v37, v37
    v_exp_f32 v38, v38
    s_waitcnt lgkmcnt(10)
    v_mfma_f32_32x32x8bf16_1k v[16:31], v[128:129], v[120:121], v[16:31]
    v_exp_f32 v39, v39
    v_exp_f32 v40, v40
    v_exp_f32 v41, v41
    s_waitcnt lgkmcnt(7)
    v_mfma_f32_32x32x16_bf16 v[80:95], v[148:151], v[140:143], v[80:95]
    v_exp_f32 v42, v42
    v_exp_f32 v43, v43
    v_exp_f32 v44, v44
    s_waitcnt lgkmcnt(5)
    v_mfma_f32_32x32x16_bf16 v[96:111], v[152:155], v[140:143], v[96:111]
    v_exp_f32 v45, v45
    v_exp_f32 v46, v46
    v_exp_f32 v47, v47
    v_smfmac_f32_32x32x32_bf16 v[64:79], v[132:135], v[32:39], v5
    v_exp_f32 v16, v16
    v_exp_f32 v17, v17
    v_smfmac_f32_32x32x32_bf16 v[64:79], v[136:139], v[40:47], v5
    v_exp_f32 v18, v18
    v_exp_f32 v19, v19
    v_mfma_f32_32x32x16_bf16 v[32:47], v[124:127], v[116:119], 0
    v_exp_f32 v20, v20
    v_exp_f32 v21, v21
    v_exp_f32 v22, v22
    v_mfma_f32_32x32x8bf16_1k v[32:47], v[128:129], v[122:123], v[32:47]
    v_exp_f32 v23, v23
    v_exp_f32 v24, v24
    v_exp_f32 v25, v25
    s_waitcnt lgkmcnt(2)
    v_mfma_f32_32x32x16_bf16 v[80:95], v[156:159], v[144:147], v[80:95]
    v_exp_f32 v26, v26
    v_exp_f32 v27, v27
    v_exp_f32 v28, v28
    s_waitcnt lgkmcnt(0)
    v_mfma_f32_32x32x16_bf16 v[96:111], v[160:163], v[144:147], v[96:111]
    v_exp_f32 v29, v29
    v_exp_f32 v30, v30
    v_exp_f32 v31, v31
    s_add_u32 s30, s30, 1
    s_cmp_lt_u32 s30, 7
    s_cbranch_scc1 K2_L1
    s_waitcnt vmcnt(8)
    s_barrier
    ds_read_b64_tr_b16 v[132:133], v176 offset:32768
    ds_read_b64_tr_b16 v[134:135], v177 offset:32768
    ds_read_b64_tr_b16 v[136:137], v176 offset:33024
    ds_read_b64_tr_b16 v[138:139], v177 offset:33024
    ds_read_b128 v[124:127], v178 offset:32768
    ds_read_b64 v[128:129], v179 offset:32768
    ds_read_b128 v[140:143], v172 offset:32768
    ds_read_b64_tr_b16 v[148:149], v174 offset:32768
    ds_read_b64_tr_b16 v[150:151], v175 offset:32768
    ds_read_b64_tr_b16 v[152:153], v174 offset:36864
    ds_read_b64_tr_b16 v[154:155], v175 offset:36864
    ds_read_b128 v[144:147], v173 offset:32768
    ds_read_b64_tr_b16 v[156:157], v174 offset:33024
    ds_read_b64_tr_b16 v[158:159], v175 offset:33024
    ds_read_b64_tr_b16 v[160:161], v174 offset:37120
    ds_read_b64_tr_b16 v[162:163], v175 offset:37120
    s_add_u32 m0, s26, 0
    s_mov_b64 exec, s[46:47]
    buffer_load_dwordx4 v4, s[8:11], s29 offen offset:3072 lds
    s_mov_b64 exec, -1
    s_add_u32 s29, s29, s6
    s_add_u32 s27, s27, 128
    s_add_u32 s28, s28, 221184
    s_add_u32 s34, s64, 0
    buffer_load_dwordx4 v[188:191], v6, s[8:11], s34 offen offset:0
    buffer_load_dwordx4 v[192:195], v6, s[8:11], s34 offen offset:1024
    buffer_load_dwordx4 v[196:199], v6, s[8:11], s34 offen offset:2048
    buffer_load_dwordx4 v[200:203], v6, s[8:11], s34 offen offset:3072
    s_waitcnt lgkmcnt(14)
    v_smfmac_f32_32x32x32_bf16 v[48:63], v[132:135], v[16:23], v5
    v_exp_f32 v32, v32
    v_exp_f32 v33, v33
    s_waitcnt lgkmcnt(12)
    v_smfmac_f32_32x32x32_bf16 v[48:63], v[136:139], v[24:31], v5
    v_exp_f32 v34, v34
    v_exp_f32 v35, v35
    s_waitcnt lgkmcnt(11)
    v_mfma_f32_32x32x16_bf16 v[16:31], v[124:127], v[112:115], 0
    v_exp_f32 v36, v36
    v_exp_f32 v37, v37
    v_exp_f32 v38, v38
    s_waitcnt lgkmcnt(10)
    v_mfma_f32_32x32x8bf16_1k v[16:31], v[128:129], v[120:121], v[16:31]
    v_exp_f32 v39, v39
    v_exp_f32 v40, v40
    v_exp_f32 v41, v41
    s_waitcnt lgkmcnt(7)
    v_mfma_f32_32x32x16_bf16 v[80:95], v[148:151], v[140:143], v[80:95]
    v_exp_f32 v42, v42
    v_exp_f32 v43, v43
    v_exp_f32 v44, v44
    s_waitcnt lgkmcnt(5)
    v_mfma_f32_32x32x16_bf16 v[96:111], v[152:155], v[140:143], v[96:111]
    v_exp_f32 v45, v45
    v_exp_f32 v46, v46
    v_exp_f32 v47, v47
    v_smfmac_f32_32x32x32_bf16 v[64:79], v[132:135], v[32:39], v5
    v_exp_f32 v16, v16
    v_exp_f32 v17, v17
    v_smfmac_f32_32x32x32_bf16 v[64:79], v[136:139], v[40:47], v5
    v_exp_f32 v18, v18
    v_exp_f32 v19, v19
    v_mfma_f32_32x32x16_bf16 v[32:47], v[124:127], v[116:119], 0
    v_exp_f32 v20, v20
    v_exp_f32 v21, v21
    v_exp_f32 v22, v22
    v_mfma_f32_32x32x8bf16_1k v[32:47], v[128:129], v[122:123], v[32:47]
    v_exp_f32 v23, v23
    v_exp_f32 v24, v24
    v_exp_f32 v25, v25
    s_waitcnt lgkmcnt(2)
    v_mfma_f32_32x32x16_bf16 v[80:95], v[156:159], v[144:147], v[80:95]
    v_exp_f32 v26, v26
    v_exp_f32 v27, v27
    v_exp_f32 v28, v28
    s_waitcnt lgkmcnt(0)
    v_mfma_f32_32x32x16_bf16 v[96:111], v[160:163], v[144:147], v[96:111]
    v_exp_f32 v29, v29
    v_exp_f32 v30, v30
    v_exp_f32 v31, v31
    s_waitcnt vmcnt(9)
    s_barrier
    ds_read_b64_tr_b16 v[132:133], v184 offset:0
    ds_read_b64_tr_b16 v[134:135], v185 offset:0
    ds_read_b64_tr_b16 v[136:137], v184 offset:256
    ds_read_b64_tr_b16 v[138:139], v185 offset:256
    ds_read_b128 v[124:127], v186 offset:0
    ds_read_b64 v[128:129], v187 offset:0
    ds_read_b128 v[140:143], v180 offset:0
    ds_read_b64_tr_b16 v[148:149], v182 offset:0
    ds_read_b64_tr_b16 v[150:151], v183 offset:0
    ds_read_b64_tr_b16 v[152:153], v182 offset:4096
    ds_read_b64_tr_b16 v[154:155], v183 offset:4096
    ds_read_b128 v[144:147], v181 offset:0
    ds_read_b64_tr_b16 v[156:157], v182 offset:256
    ds_read_b64_tr_b16 v[158:159], v183 offset:256
    ds_read_b64_tr_b16 v[160:161], v182 offset:4352
    ds_read_b64_tr_b16 v[162:163], v183 offset:4352
    s_add_u32 m0, s26, 32768
    s_add_u32 s34, s64, 13312
    buffer_load_dwordx4 v6, s[8:11], s34 offen offset:0 lds
    buffer_load_dwordx4 v6, s[8:11], s34 offen offset:1024 lds
    buffer_load_dwordx4 v6, s[8:11], s34 offen offset:2048 lds
    buffer_load_dwordx4 v6, s[8:11], s34 offen offset:3072 lds
    s_waitcnt lgkmcnt(14)
    v_smfmac_f32_32x32x32_bf16 v[48:63], v[132:135], v[16:23], v5
    v_exp_f32 v32, v32
    v_exp_f32 v33, v33
    s_waitcnt lgkmcnt(12)
    v_smfmac_f32_32x32x32_bf16 v[48:63], v[136:139], v[24:31], v5
    v_exp_f32 v34, v34
    v_exp_f32 v35, v35
    s_waitcnt lgkmcnt(11)
    v_mfma_f32_32x32x16_bf16 v[16:31], v[124:127], v[112:115], 0
    v_exp_f32 v36, v36
    v_exp_f32 v37, v37
    v_exp_f32 v38, v38
    s_waitcnt lgkmcnt(10)
    v_mfma_f32_32x32x8bf16_1k v[16:31], v[128:129], v[120:121], v[16:31]
    v_exp_f32 v39, v39
    v_exp_f32 v40, v40
    v_exp_f32 v41, v41
    s_waitcnt lgkmcnt(7)
    v_mfma_f32_32x32x16_bf16 v[80:95], v[148:151], v[140:143], v[80:95]
    v_exp_f32 v42, v42
    v_exp_f32 v43, v43
    v_exp_f32 v44, v44
    s_waitcnt lgkmcnt(5)
    v_mfma_f32_32x32x16_bf16 v[96:111], v[152:155], v[140:143], v[96:111]
    v_exp_f32 v45, v45
    v_exp_f32 v46, v46
    v_exp_f32 v47, v47
    v_smfmac_f32_32x32x32_bf16 v[64:79], v[132:135], v[32:39], v5
    v_exp_f32 v16, v16
    v_exp_f32 v17, v17
    v_smfmac_f32_32x32x32_bf16 v[64:79], v[136:139], v[40:47], v5
    v_exp_f32 v18, v18
    v_exp_f32 v19, v19
    v_mfma_f32_32x32x16_bf16 v[32:47], v[124:127], v[116:119], 0
    v_exp_f32 v20, v20
    v_exp_f32 v21, v21
    v_exp_f32 v22, v22
    v_mfma_f32_32x32x8bf16_1k v[32:47], v[128:129], v[122:123], v[32:47]
    v_exp_f32 v23, v23
    v_exp_f32 v24, v24
    v_exp_f32 v25, v25
    s_waitcnt lgkmcnt(2)
    v_mfma_f32_32x32x16_bf16 v[80:95], v[156:159], v[144:147], v[80:95]
    v_exp_f32 v26, v26
    v_exp_f32 v27, v27
    v_exp_f32 v28, v28
    s_waitcnt lgkmcnt(0)
    v_mfma_f32_32x32x16_bf16 v[96:111], v[160:163], v[144:147], v[96:111]
    v_exp_f32 v29, v29
    v_exp_f32 v30, v30
    v_exp_f32 v31, v31
    buffer_load_dwordx4 v[164:167], v13, s[8:11], s43 offen offset:0
    buffer_load_dwordx4 v[168:171], v14, s[8:11], s43 offen offset:512
    buffer_load_ushort v15, v15, s[16:19], 0 offen
    s_waitcnt vmcnt(12)
    s_barrier
    ds_read_b64_tr_b16 v[132:133], v184 offset:32768
    ds_read_b64_tr_b16 v[134:135], v185 offset:32768
    ds_read_b64_tr_b16 v[136:137], v184 offset:33024
    ds_read_b64_tr_b16 v[138:139], v185 offset:33024
    ds_read_b128 v[124:127], v186 offset:32768
    ds_read_b64 v[128:129], v187 offset:32768
    ds_read_b128 v[140:143], v180 offset:32768
    ds_read_b64_tr_b16 v[148:149], v182 offset:32768
    ds_read_b64_tr_b16 v[150:151], v183 offset:32768
    ds_read_b64_tr_b16 v[152:153], v182 offset:36864
    ds_read_b64_tr_b16 v[154:155], v183 offset:36864
    ds_read_b128 v[144:147], v181 offset:32768
    ds_read_b64_tr_b16 v[156:157], v182 offset:33024
    ds_read_b64_tr_b16 v[158:159], v183 offset:33024
    ds_read_b64_tr_b16 v[160:161], v182 offset:37120
    ds_read_b64_tr_b16 v[162:163], v183 offset:37120
    s_add_u32 m0, s26, 65536
    s_add_u32 s34, s64, 17408
    buffer_load_dwordx4 v6, s[8:11], s34 offen offset:0 lds
    buffer_load_dwordx4 v6, s[8:11], s34 offen offset:1024 lds
    buffer_load_dwordx4 v6, s[8:11], s34 offen offset:2048 lds
    buffer_load_dwordx4 v6, s[8:11], s34 offen offset:3072 lds
    s_waitcnt lgkmcnt(14)
    v_smfmac_f32_32x32x32_bf16 v[48:63], v[132:135], v[16:23], v5
    v_exp_f32 v32, v32
    v_exp_f32 v33, v33
    s_waitcnt lgkmcnt(12)
    v_smfmac_f32_32x32x32_bf16 v[48:63], v[136:139], v[24:31], v5
    v_exp_f32 v34, v34
    v_exp_f32 v35, v35
    s_waitcnt lgkmcnt(11)
    v_mfma_f32_32x32x16_bf16 v[16:31], v[124:127], v[112:115], 0
    v_exp_f32 v36, v36
    v_exp_f32 v37, v37
    v_exp_f32 v38, v38
    s_waitcnt lgkmcnt(10)
    v_mfma_f32_32x32x8bf16_1k v[16:31], v[128:129], v[120:121], v[16:31]
    v_exp_f32 v39, v39
    v_exp_f32 v40, v40
    v_exp_f32 v41, v41
    s_waitcnt lgkmcnt(7)
    v_mfma_f32_32x32x16_bf16 v[80:95], v[148:151], v[140:143], v[80:95]
    v_exp_f32 v42, v42
    v_exp_f32 v43, v43
    v_exp_f32 v44, v44
    s_waitcnt lgkmcnt(5)
    v_mfma_f32_32x32x16_bf16 v[96:111], v[152:155], v[140:143], v[96:111]
    v_exp_f32 v45, v45
    v_exp_f32 v46, v46
    v_exp_f32 v47, v47
    v_smfmac_f32_32x32x32_bf16 v[64:79], v[132:135], v[32:39], v5
    v_exp_f32 v16, v16
    v_exp_f32 v17, v17
    v_smfmac_f32_32x32x32_bf16 v[64:79], v[136:139], v[40:47], v5
    v_exp_f32 v18, v18
    v_exp_f32 v19, v19
    v_mfma_f32_32x32x16_bf16 v[32:47], v[124:127], v[116:119], 0
    v_exp_f32 v20, v20
    v_exp_f32 v21, v21
    v_exp_f32 v22, v22
    v_mfma_f32_32x32x8bf16_1k v[32:47], v[128:129], v[122:123], v[32:47]
    v_exp_f32 v23, v23
    v_exp_f32 v24, v24
    v_exp_f32 v25, v25
    s_waitcnt lgkmcnt(2)
    v_mfma_f32_32x32x16_bf16 v[80:95], v[156:159], v[144:147], v[80:95]
    v_exp_f32 v26, v26
    v_exp_f32 v27, v27
    v_exp_f32 v28, v28
    s_waitcnt lgkmcnt(0)
    v_mfma_f32_32x32x16_bf16 v[96:111], v[160:163], v[144:147], v[96:111]
    v_exp_f32 v29, v29
    v_exp_f32 v30, v30
    v_exp_f32 v31, v31
    v_and_b32 v3, 48, v0
    v_lshl_add_u32 v1, v3, 4, v6
    v_lshl_add_u32 v253, v3, 4, v252
    s_lshr_b32 s31, s65, 2
    s_lshl_b32 s31, s31, 5
    s_and_b32 s32, s65, 2
    s_lshl_b32 s32, s32, 4
    s_and_b32 s33, s65, 28
    s_add_u32 s32, s32, s33
    v_bfe_u32 v3, v0, 2, 2
    v_and_b32 v4, 3, v0
    v_lshl_add_u32 v3, v4, 6, v3
    v_add_u32 v3, s32, v3
    v_add_u32 v4, s31, v0
    v_cmp_gt_u32 vcc, 32, v0
    s_nop 1
    v_cndmask_b32 v2, v3, v4, vcc
    v_lshlrev_b32 v2, 7, v2
    s_mov_b64 exec, s[100:101]
    buffer_load_dword v3, v2, s[8:11], s68 offen sc1
    s_mov_b64 exec, -1
    s_waitcnt vmcnt(16)
    s_barrier
    ds_read_b64_tr_b16 v[132:133], v176 offset:0
    ds_read_b64_tr_b16 v[134:135], v177 offset:0
    ds_read_b64_tr_b16 v[136:137], v176 offset:256
    ds_read_b64_tr_b16 v[138:139], v177 offset:256
    s_add_u32 m0, s26, 98304
    s_add_u32 s34, s64, 21504
    buffer_load_dwordx4 v6, s[8:11], s34 offen offset:0 lds
    buffer_load_dwordx4 v6, s[8:11], s34 offen offset:1024 lds
    buffer_load_dwordx4 v6, s[8:11], s34 offen offset:2048 lds
    buffer_load_dwordx4 v6, s[8:11], s34 offen offset:3072 lds
    s_add_u32 s34, s64, 28672
    buffer_load_dwordx4 v[180:183], v252, s[8:11], s34 offen offset:0
    buffer_load_dwordx4 v[184:187], v252, s[8:11], s34 offen offset:1024
    s_waitcnt lgkmcnt(2)
    v_smfmac_f32_32x32x32_bf16 v[48:63], v[132:135], v[16:23], v5
    v_exp_f32 v32, v32
    v_exp_f32 v33, v33
    v_exp_f32 v34, v34
    v_exp_f32 v35, v35
    v_exp_f32 v36, v36
    v_exp_f32 v37, v37
    v_exp_f32 v38, v38
    v_exp_f32 v39, v39
    s_waitcnt lgkmcnt(0)
    v_smfmac_f32_32x32x32_bf16 v[48:63], v[136:139], v[24:31], v5
    v_exp_f32 v40, v40
    v_exp_f32 v41, v41
    v_exp_f32 v42, v42
    v_exp_f32 v43, v43
    v_exp_f32 v44, v44
    v_exp_f32 v45, v45
    v_exp_f32 v46, v46
    v_exp_f32 v47, v47
    v_smfmac_f32_32x32x32_bf16 v[64:79], v[132:135], v[32:39], v5
    s_nop 0
    v_smfmac_f32_32x32x32_bf16 v[64:79], v[136:139], v[40:47], v5
    s_barrier
    v_add_u32 v9, s26, v6
    v_add_u32 v10, 0x20000, v9
    ds_write_b128 v9, v[80:83] offset:0
    ds_write_b128 v9, v[84:87] offset:1024
    ds_write_b128 v9, v[88:91] offset:2048
    ds_write_b128 v9, v[92:95] offset:3072
    ds_write_b128 v10, v[48:51] offset:0
    ds_write_b128 v10, v[52:55] offset:1024
    ds_write_b128 v10, v[56:59] offset:2048
    ds_write_b128 v10, v[60:63] offset:3072
    s_add_u32 s34, s64, 4096
    buffer_load_dwordx4 v[204:207], v6, s[8:11], s34 offen offset:0
    buffer_load_dwordx4 v[208:211], v6, s[8:11], s34 offen offset:1024
    buffer_load_dwordx4 v[212:215], v6, s[8:11], s34 offen offset:2048
    buffer_load_dwordx4 v[216:219], v6, s[8:11], s34 offen offset:3072
    v_xor_b32 v9, 0x4000, v9
    v_xor_b32 v10, 0x4000, v10
    s_waitcnt vmcnt(15)
    v_lshlrev_b32 v15, 16, v15
    v_add_f32 v96, v96, v15
    v_add_f32 v97, v97, v15
    v_add_f32 v98, v98, v15
    v_add_f32 v99, v99, v15
    v_add_f32 v100, v100, v15
    v_add_f32 v101, v101, v15
    v_add_f32 v102, v102, v15
    v_add_f32 v103, v103, v15
    v_add_f32 v104, v104, v15
    v_add_f32 v105, v105, v15
    v_add_f32 v106, v106, v15
    v_add_f32 v107, v107, v15
    v_add_f32 v108, v108, v15
    v_add_f32 v109, v109, v15
    v_add_f32 v110, v110, v15
    v_add_f32 v111, v111, v15
    v_lshlrev_b32 v148, 16, v164
    v_and_b32 v149, s38, v164
    v_lshlrev_b32 v150, 16, v165
    v_and_b32 v151, s38, v165
    v_lshlrev_b32 v152, 16, v166
    v_and_b32 v153, s38, v166
    v_lshlrev_b32 v154, 16, v167
    v_and_b32 v155, s38, v167
    v_lshlrev_b32 v156, 16, v168
    v_and_b32 v157, s38, v168
    v_lshlrev_b32 v158, 16, v169
    v_and_b32 v159, s38, v169
    v_lshlrev_b32 v160, 16, v170
    v_and_b32 v161, s38, v170
    v_lshlrev_b32 v162, 16, v171
    v_and_b32 v163, s38, v171
    s_waitcnt lgkmcnt(0)
    s_barrier
    ds_read_b128 v[16:19], v9 offset:0
    ds_read_b128 v[20:23], v9 offset:1024
    ds_read_b128 v[24:27], v9 offset:2048
    ds_read_b128 v[28:31], v9 offset:3072
    ds_read_b128 v[32:35], v10 offset:0
    ds_read_b128 v[36:39], v10 offset:1024
    ds_read_b128 v[40:43], v10 offset:2048
    ds_read_b128 v[44:47], v10 offset:3072
    s_waitcnt lgkmcnt(7)
    v_add_f32 v96, v96, v16
    v_add_f32 v97, v97, v17
    v_add_f32 v98, v98, v18
    v_add_f32 v99, v99, v19
    s_waitcnt lgkmcnt(6)
    v_add_f32 v100, v100, v20
    v_add_f32 v101, v101, v21
    v_add_f32 v102, v102, v22
    v_add_f32 v103, v103, v23
    v_mul_f32 v96, v96, v148
    v_mul_f32 v97, v97, v149
    v_mul_f32 v98, v98, v150
    v_mul_f32 v99, v99, v151
    v_mul_f32 v100, v100, v152
    v_mul_f32 v101, v101, v153
    v_mul_f32 v102, v102, v154
    v_mul_f32 v103, v103, v155
    v_cvt_pk_bf16_f32 v140, v96, v97
    v_cvt_pk_bf16_f32 v141, v98, v99
    v_cvt_pk_bf16_f32 v142, v100, v101
    v_cvt_pk_bf16_f32 v143, v102, v103
    v_min_u32 v140, -2, v140
    v_min_u32 v141, -2, v141
    v_min_u32 v142, -2, v142
    v_min_u32 v143, -2, v143
    buffer_store_dwordx4 v[140:143], v13, s[8:11], s44 offen offset:0 sc1
    s_waitcnt lgkmcnt(5)
    v_add_f32 v104, v104, v24
    v_add_f32 v105, v105, v25
    v_add_f32 v106, v106, v26
    v_add_f32 v107, v107, v27
    s_waitcnt lgkmcnt(4)
    v_add_f32 v108, v108, v28
    v_add_f32 v109, v109, v29
    v_add_f32 v110, v110, v30
    v_add_f32 v111, v111, v31
    v_mul_f32 v104, v104, v156
    v_mul_f32 v105, v105, v157
    v_mul_f32 v106, v106, v158
    v_mul_f32 v107, v107, v159
    v_mul_f32 v108, v108, v160
    v_mul_f32 v109, v109, v161
    v_mul_f32 v110, v110, v162
    v_mul_f32 v111, v111, v163
    v_cvt_pk_bf16_f32 v144, v104, v105
    v_cvt_pk_bf16_f32 v145, v106, v107
    v_cvt_pk_bf16_f32 v146, v108, v109
    v_cvt_pk_bf16_f32 v147, v110, v111
    v_min_u32 v144, -2, v144
    v_min_u32 v145, -2, v145
    v_min_u32 v146, -2, v146
    v_min_u32 v147, -2, v147
    buffer_store_dwordx4 v[144:147], v14, s[8:11], s44 offen offset:512 sc1
    s_waitcnt lgkmcnt(3)
    v_add_f32 v64, v64, v32
    v_add_f32 v65, v65, v33
    v_add_f32 v66, v66, v34
    v_add_f32 v67, v67, v35
    s_waitcnt lgkmcnt(2)
    v_add_f32 v68, v68, v36
    v_add_f32 v69, v69, v37
    v_add_f32 v70, v70, v38
    v_add_f32 v71, v71, v39
    s_waitcnt lgkmcnt(1)
    v_add_f32 v72, v72, v40
    v_add_f32 v73, v73, v41
    v_add_f32 v74, v74, v42
    v_add_f32 v75, v75, v43
    s_waitcnt lgkmcnt(0)
    v_add_f32 v76, v76, v44
    v_rcp_f32 v9, v76
    s_nop 0
    v_mul_f32 v64, v64, v9
    v_mul_f32 v65, v65, v9
    v_mul_f32 v66, v66, v9
    v_mul_f32 v67, v67, v9
    v_mul_f32 v68, v68, v9
    v_mul_f32 v69, v69, v9
    v_mul_f32 v70, v70, v9
    v_mul_f32 v71, v71, v9
    v_mul_f32 v72, v72, v9
    v_mul_f32 v73, v73, v9
    v_mul_f32 v74, v74, v9
    v_mul_f32 v75, v75, v9
    s_mov_b32 s31, 0x4d800000
    v_mul_f32 v10, 0x43800000, v76
    v_fma_f32 v10, v9, s31, v10
    v_add_f32 v16, v64, v65
    v_add_f32 v17, v66, v67
    v_add_f32 v18, v68, v69
    v_add_f32 v19, v70, v71
    v_add_f32 v20, v72, v73
    v_add_f32 v21, v74, v75
    v_add_f32 v16, v16, v17
    v_add_f32 v18, v18, v19
    v_add_f32 v20, v20, v21
    v_add_f32 v16, v16, v18
    v_add_f32 v10, v10, v20
    v_add_f32 v10, v10, v16
    v_mov_b32 v16, 519
    v_cmp_class_f32 vcc, v10, v16
    s_cbranch_vccnz K2_SLOW1
    v_cvt_pk_bf16_f32 v124, v64, v65
    v_cvt_pk_bf16_f32 v125, v66, v67
    v_cvt_pk_bf16_f32 v126, v68, v69
    v_cvt_pk_bf16_f32 v127, v70, v71
    v_cvt_pk_bf16_f32 v128, v72, v73
    v_cvt_pk_bf16_f32 v129, v74, v75
    v_min_u32 v124, -2, v124
    v_min_u32 v125, -2, v125
    v_min_u32 v126, -2, v126
    v_min_u32 v127, -2, v127
    v_min_u32 v128, -2, v128
    v_min_u32 v129, -2, v129
    buffer_store_dwordx4 v[124:127], v7, s[8:11], s45 offen sc1
    buffer_store_dwordx2 v[128:129], v8, s[8:11], s45 offen offset:1024 sc1
K3_GO:
    s_setprio 0
    s_cmp_lt_u32 s20, 4
    s_cbranch_scc1 K3_PG
    s_setprio 3
K3_PG:
    v_add_u32 v8, s26, v6
    s_xor_b32 s27, s4, 256
    s_xor_b32 s28, s5, 256
    s_xor_b32 s29, s96, 256
    s_xor_b32 s39, s97, 256
    s_xor_b32 s40, s98, 256
    s_xor_b32 s41, s99, 256
    s_waitcnt vmcnt(4)
    v_cmp_eq_u32 vcc, 0, v3
    s_and_b64 vcc, vcc, s[100:101]
    s_barrier
    s_cbranch_scc1 K3_WAIT
K3_RDY:
    s_add_u32 s34, s64, 8192
    buffer_load_dwordx4 v[220:223], v6, s[8:11], s34 offen offset:0
    buffer_load_dwordx4 v[224:227], v6, s[8:11], s34 offen offset:1024
    buffer_load_dwordx4 v[228:231], v6, s[8:11], s34 offen offset:2048
    buffer_load_dwordx4 v[232:235], v6, s[8:11], s34 offen offset:3072
    s_add_u32 s34, s64, 12288
    buffer_load_dwordx4 v[236:239], v6, s[8:11], s34 offen offset:0
    s_add_u32 s34, s64, 24576
    buffer_load_dwordx4 v[240:243], v252, s[8:11], s34 offen offset:1024
    buffer_load_dwordx4 v[244:247], v252, s[8:11], s34 offen offset:2048
    buffer_load_dwordx4 v[248:251], v252, s[8:11], s34 offen offset:3072
    buffer_load_dwordx4 v[36:39], v1, s[8:11], s4 offen offset:0 sc1
    buffer_load_dwordx4 v[40:43], v1, s[8:11], s4 offen offset:2048 sc1
    buffer_load_dwordx4 v[44:47], v1, s[8:11], s5 offen offset:0 sc1
    buffer_load_dwordx4 v[48:51], v1, s[8:11], s5 offen offset:2048 sc1
    buffer_load_dwordx4 v[52:55], v1, s[8:11], s96 offen offset:0 sc1
    buffer_load_dwordx4 v[56:59], v253, s[8:11], s96 offen offset:2048 sc1
    buffer_load_dwordx4 v[60:63], v1, s[8:11], s27 offen offset:0 sc1
    buffer_load_dwordx4 v[64:67], v1, s[8:11], s27 offen offset:2048 sc1
    buffer_load_dwordx4 v[68:71], v1, s[8:11], s28 offen offset:0 sc1
    buffer_load_dwordx4 v[72:75], v1, s[8:11], s28 offen offset:2048 sc1
    buffer_load_dwordx4 v[76:79], v1, s[8:11], s29 offen offset:0 sc1
    buffer_load_dwordx4 v[80:83], v253, s[8:11], s29 offen offset:2048 sc1
    buffer_load_dwordx4 v[84:87], v1, s[8:11], s97 offen offset:0 sc1
    buffer_load_dwordx4 v[88:91], v1, s[8:11], s97 offen offset:2048 sc1
    buffer_load_dwordx4 v[92:95], v1, s[8:11], s98 offen offset:0 sc1
    buffer_load_dwordx4 v[96:99], v1, s[8:11], s98 offen offset:2048 sc1
    buffer_load_dwordx4 v[100:103], v1, s[8:11], s99 offen offset:0 sc1
    buffer_load_dwordx4 v[104:107], v253, s[8:11], s99 offen offset:2048 sc1
    buffer_load_dwordx4 v[108:111], v1, s[8:11], s39 offen offset:0 sc1
    buffer_load_dwordx4 v[112:115], v1, s[8:11], s39 offen offset:2048 sc1
    buffer_load_dwordx4 v[116:119], v1, s[8:11], s40 offen offset:0 sc1
    buffer_load_dwordx4 v[120:123], v1, s[8:11], s40 offen offset:2048 sc1
    buffer_load_dwordx4 v[124:127], v1, s[8:11], s41 offen offset:0 sc1
    buffer_load_dwordx4 v[128:131], v253, s[8:11], s41 offen offset:2048 sc1
    v_add_u32 v9, 0x10000, v8
    ds_read_b128 v[132:135], v8 offset:32768
    ds_read_b128 v[136:139], v8 offset:33792
    ds_read_b128 v[140:143], v8 offset:34816
    ds_read_b128 v[144:147], v8 offset:35840
    ds_read_b128 v[148:151], v9 offset:0
    ds_read_b128 v[152:155], v9 offset:1024
    ds_read_b128 v[156:159], v9 offset:2048
    ds_read_b128 v[160:163], v9 offset:3072
    ds_read_b128 v[164:167], v9 offset:32768
    ds_read_b128 v[168:171], v9 offset:33792
    ds_read_b128 v[172:175], v9 offset:34816
    ds_read_b128 v[176:179], v9 offset:35840
    v_lshrrev_b32 v16, 4, v0
    v_xor_b32 v7, v16, v0
    v_lshlrev_b32 v7, 4, v7
    v_add_u32 v7, s26, v7
    v_and_b32 v16, 1, v16
    v_and_or_b32 v16, v0, 12, v16
    s_and_b32 s31, s20, 1
    v_lshl_add_u32 v16, s31, 1, v16
    v_and_b32 v17, 3, v0
    v_xor_b32 v4, v16, v17
    v_lshl_add_u32 v4, v17, 4, v4
    v_lshlrev_b32 v4, 4, v4
    s_lshr_b32 s31, s20, 1
    s_mul_i32 s34, s31, 5
    s_and_b32 s32, s66, 3
    s_xor_b32 s31, s31, s32
    v_lshrrev_b32 v5, 5, v0
    v_lshl_add_u32 v4, v5, 14, v4
    s_lshl_b32 s32, s65, 2
    s_add_u32 s31, s31, s32
    s_mul_i32 s31, s31, 20480
    s_mul_i32 s32, s66, 160
    s_add_u32 s31, s31, s32
    v_mul_u32_u24 v16, 1280, v16
    s_bitcmp1_b32 s66, 0
    s_cselect_b32 s32, 32, 0
    s_cselect_b32 s33, 0, 128
    s_add_u32 s32, s32, s31
    s_add_u32 s33, s33, s31
    v_lshl_add_u32 v254, v5, 2, v17
    v_lshl_add_u32 v255, v17, 1, v5
    v_lshl_add_u32 v254, v254, 4, v16
    v_lshl_add_u32 v255, v255, 2, v16
    v_add_u32 v254, s32, v254
    v_add_u32 v255, s33, v255
    v_add_u32 v8, 0x10000, v7
    v_add_u32 v10, 0x20000, v7
    s_add_u32 s31, s34, 4
    s_lshr_b32 s32, s31, 2
    s_mul_i32 s32, s32, 28
    s_add_u32 s31, s31, s32
    v_lshl_add_u32 v2, s31, 10, v4
    s_add_u32 s31, s34, 3
    s_lshr_b32 s32, s31, 2
    s_mul_i32 s32, s32, 28
    s_add_u32 s31, s31, s32
    v_lshl_add_u32 v252, s31, 10, v4
    s_add_u32 s31, s34, 2
    s_lshr_b32 s32, s31, 2
    s_mul_i32 s32, s32, 28
    s_add_u32 s31, s31, s32
    v_lshl_add_u32 v6, s31, 10, v4
    s_add_u32 s31, s34, 1
    s_lshr_b32 s32, s31, 2
    s_mul_i32 s32, s32, 28
    s_add_u32 s31, s31, s32
    v_lshl_add_u32 v5, s31, 10, v4
    s_add_u32 s31, s34, 0
    s_lshr_b32 s32, s31, 2
    s_mul_i32 s32, s32, 28
    s_add_u32 s31, s31, s32
    v_lshl_add_u32 v4, s31, 10, v4
    buffer_load_dwordx4 v[12:15], v254, s[56:59], 0 offen
    buffer_load_dword v11, v255, s[56:59], 0 offen
    s_mov_b32 s30, 100000
    s_waitcnt vmcnt(25)
    v_max3_u32 v9, v36, v37, v38
    s_waitcnt vmcnt(24)
    v_max3_u32 v9, v9, v39, v40
    v_max3_u32 v9, v9, v41, v42
    s_waitcnt vmcnt(23)
    v_max3_u32 v9, v9, v43, v44
    v_max3_u32 v9, v9, v45, v46
    s_waitcnt vmcnt(22)
    v_max3_u32 v9, v9, v47, v48
    v_max3_u32 v9, v9, v49, v50
    s_waitcnt vmcnt(21)
    v_max3_u32 v9, v9, v51, v52
    v_max3_u32 v9, v9, v53, v54
    s_waitcnt vmcnt(20)
    v_max3_u32 v9, v9, v55, v56
    v_max3_u32 v9, v9, v57, v58
    v_max_u32 v9, v9, v59
    v_cmp_eq_u32 vcc, -1, v9
    s_cbranch_vccnz K3_RE0
K3_M0:
    v_mfma_f32_16x16x32_bf16 v[16:19], v[188:191], v[36:39], 0
    v_mfma_f32_16x16x32_bf16 v[20:23], v[192:195], v[36:39], 0
    v_mfma_f32_16x16x32_bf16 v[24:27], v[196:199], v[36:39], 0
    v_mfma_f32_16x16x32_bf16 v[28:31], v[200:203], v[36:39], 0
    v_mfma_f32_16x16x32_bf16 v[32:35], v[204:207], v[36:39], 0
    v_mfma_f32_16x16x32_bf16 v[16:19], v[208:211], v[40:43], v[16:19]
    v_mfma_f32_16x16x32_bf16 v[20:23], v[212:215], v[40:43], v[20:23]
    v_mfma_f32_16x16x32_bf16 v[24:27], v[216:219], v[40:43], v[24:27]
    v_mfma_f32_16x16x32_bf16 v[28:31], v[220:223], v[40:43], v[28:31]
    v_mfma_f32_16x16x32_bf16 v[32:35], v[224:227], v[40:43], v[32:35]
    v_mfma_f32_16x16x32_bf16 v[16:19], v[228:231], v[44:47], v[16:19]
    v_mfma_f32_16x16x32_bf16 v[20:23], v[232:235], v[44:47], v[20:23]
    v_mfma_f32_16x16x32_bf16 v[24:27], v[236:239], v[44:47], v[24:27]
    s_waitcnt lgkmcnt(11)
    v_mfma_f32_16x16x32_bf16 v[28:31], v[132:135], v[44:47], v[28:31]
    s_waitcnt lgkmcnt(10)
    v_mfma_f32_16x16x32_bf16 v[32:35], v[136:139], v[44:47], v[32:35]
    s_waitcnt lgkmcnt(9)
    v_mfma_f32_16x16x32_bf16 v[16:19], v[140:143], v[48:51], v[16:19]
    s_waitcnt lgkmcnt(8)
    v_mfma_f32_16x16x32_bf16 v[20:23], v[144:147], v[48:51], v[20:23]
    s_waitcnt vmcnt(19)
    v_max3_u32 v9, v60, v61, v62
    s_waitcnt lgkmcnt(7)
    v_mfma_f32_16x16x32_bf16 v[24:27], v[148:151], v[48:51], v[24:27]
    s_waitcnt vmcnt(18)
    v_max3_u32 v9, v9, v63, v64
    s_waitcnt lgkmcnt(6)
    v_mfma_f32_16x16x32_bf16 v[28:31], v[152:155], v[48:51], v[28:31]
    v_max3_u32 v9, v9, v65, v66
    s_waitcnt lgkmcnt(5)
    v_mfma_f32_16x16x32_bf16 v[32:35], v[156:159], v[48:51], v[32:35]
    s_waitcnt vmcnt(17)
    v_max3_u32 v9, v9, v67, v68
    s_waitcnt lgkmcnt(4)
    v_mfma_f32_16x16x32_bf16 v[16:19], v[160:163], v[52:55], v[16:19]
    v_max3_u32 v9, v9, v69, v70
    s_waitcnt lgkmcnt(3)
    v_mfma_f32_16x16x32_bf16 v[20:23], v[164:167], v[52:55], v[20:23]
    s_waitcnt vmcnt(16)
    v_max3_u32 v9, v9, v71, v72
    s_waitcnt lgkmcnt(2)
    v_mfma_f32_16x16x32_bf16 v[24:27], v[168:171], v[52:55], v[24:27]
    v_max3_u32 v9, v9, v73, v74
    s_waitcnt lgkmcnt(1)
    v_mfma_f32_16x16x32_bf16 v[28:31], v[172:175], v[52:55], v[28:31]
    s_waitcnt vmcnt(15)
    v_max3_u32 v9, v9, v75, v76
    s_waitcnt lgkmcnt(0)
    v_mfma_f32_16x16x32_bf16 v[32:35], v[176:179], v[52:55], v[32:35]
    v_max3_u32 v9, v9, v77, v78
    v_mfma_f32_16x16x32_bf16 v[16:19], v[240:243], v[56:59], v[16:19]
    s_waitcnt vmcnt(14)
    v_max3_u32 v9, v9, v79, v80
    v_mfma_f32_16x16x32_bf16 v[20:23], v[244:247], v[56:59], v[20:23]
    v_max3_u32 v9, v9, v81, v82
    v_mfma_f32_16x16x32_bf16 v[24:27], v[248:251], v[56:59], v[24:27]
    v_max_u32 v9, v9, v83
    v_mfma_f32_16x16x32_bf16 v[28:31], v[180:183], v[56:59], v[28:31]
    v_cmp_eq_u32 vcc, -1, v9
    v_mfma_f32_16x16x32_bf16 v[32:35], v[184:187], v[56:59], v[32:35]
    s_cbranch_vccnz K3_RE1
K3_M1:
    v_mfma_f32_16x16x32_bf16 v[36:39], v[188:191], v[60:63], 0
    v_mfma_f32_16x16x32_bf16 v[40:43], v[192:195], v[60:63], 0
    v_mfma_f32_16x16x32_bf16 v[44:47], v[196:199], v[60:63], 0
    v_mfma_f32_16x16x32_bf16 v[48:51], v[200:203], v[60:63], 0
    ds_write_b128 v7, v[16:19] offset:0
    v_mfma_f32_16x16x32_bf16 v[52:55], v[204:207], v[60:63], 0
    ds_write_b128 v7, v[20:23] offset:1024
    v_mfma_f32_16x16x32_bf16 v[36:39], v[208:211], v[64:67], v[36:39]
    ds_write_b128 v7, v[24:27] offset:2048
    v_mfma_f32_16x16x32_bf16 v[40:43], v[212:215], v[64:67], v[40:43]
    ds_write_b128 v7, v[28:31] offset:3072
    v_mfma_f32_16x16x32_bf16 v[44:47], v[216:219], v[64:67], v[44:47]
    ds_write_b128 v7, v[32:35] offset:32768
    v_mfma_f32_16x16x32_bf16 v[48:51], v[220:223], v[64:67], v[48:51]
    v_mfma_f32_16x16x32_bf16 v[52:55], v[224:227], v[64:67], v[52:55]
    v_mfma_f32_16x16x32_bf16 v[36:39], v[228:231], v[68:71], v[36:39]
    v_mfma_f32_16x16x32_bf16 v[40:43], v[232:235], v[68:71], v[40:43]
    v_mfma_f32_16x16x32_bf16 v[44:47], v[236:239], v[68:71], v[44:47]
    v_mfma_f32_16x16x32_bf16 v[48:51], v[132:135], v[68:71], v[48:51]
    v_mfma_f32_16x16x32_bf16 v[52:55], v[136:139], v[68:71], v[52:55]
    v_mfma_f32_16x16x32_bf16 v[36:39], v[140:143], v[72:75], v[36:39]
    v_mfma_f32_16x16x32_bf16 v[40:43], v[144:147], v[72:75], v[40:43]
    s_waitcnt vmcnt(13)
    v_max3_u32 v9, v84, v85, v86
    v_mfma_f32_16x16x32_bf16 v[44:47], v[148:151], v[72:75], v[44:47]
    s_waitcnt vmcnt(12)
    v_max3_u32 v9, v9, v87, v88
    v_mfma_f32_16x16x32_bf16 v[48:51], v[152:155], v[72:75], v[48:51]
    v_max3_u32 v9, v9, v89, v90
    v_mfma_f32_16x16x32_bf16 v[52:55], v[156:159], v[72:75], v[52:55]
    s_waitcnt vmcnt(11)
    v_max3_u32 v9, v9, v91, v92
    v_mfma_f32_16x16x32_bf16 v[36:39], v[160:163], v[76:79], v[36:39]
    v_max3_u32 v9, v9, v93, v94
    v_mfma_f32_16x16x32_bf16 v[40:43], v[164:167], v[76:79], v[40:43]
    s_waitcnt vmcnt(10)
    v_max3_u32 v9, v9, v95, v96
    v_mfma_f32_16x16x32_bf16 v[44:47], v[168:171], v[76:79], v[44:47]
    v_max3_u32 v9, v9, v97, v98
    v_mfma_f32_16x16x32_bf16 v[48:51], v[172:175], v[76:79], v[48:51]
    s_waitcnt vmcnt(9)
    v_max3_u32 v9, v9, v99, v100
    v_mfma_f32_16x16x32_bf16 v[52:55], v[176:179], v[76:79], v[52:55]
    v_max3_u32 v9, v9, v101, v102
    v_mfma_f32_16x16x32_bf16 v[36:39], v[240:243], v[80:83], v[36:39]
    s_waitcnt vmcnt(8)
    v_max3_u32 v9, v9, v103, v104
    v_mfma_f32_16x16x32_bf16 v[40:43], v[244:247], v[80:83], v[40:43]
    v_max3_u32 v9, v9, v105, v106
    v_mfma_f32_16x16x32_bf16 v[44:47], v[248:251], v[80:83], v[44:47]
    v_max_u32 v9, v9, v107
    v_mfma_f32_16x16x32_bf16 v[48:51], v[180:183], v[80:83], v[48:51]
    v_cmp_eq_u32 vcc, -1, v9
    v_mfma_f32_16x16x32_bf16 v[52:55], v[184:187], v[80:83], v[52:55]
    s_cbranch_vccnz K3_RE2
K3_M2:
    v_mfma_f32_16x16x32_bf16 v[60:63], v[188:191], v[84:87], 0
    v_mfma_f32_16x16x32_bf16 v[64:67], v[192:195], v[84:87], 0
    v_mfma_f32_16x16x32_bf16 v[68:71], v[196:199], v[84:87], 0
    v_mfma_f32_16x16x32_bf16 v[72:75], v[200:203], v[84:87], 0
    ds_write_b128 v7, v[36:39] offset:33792
    v_mfma_f32_16x16x32_bf16 v[76:79], v[204:207], v[84:87], 0
    ds_write_b128 v7, v[40:43] offset:34816
    v_mfma_f32_16x16x32_bf16 v[60:63], v[208:211], v[88:91], v[60:63]
    ds_write_b128 v7, v[44:47] offset:35840
    v_mfma_f32_16x16x32_bf16 v[64:67], v[212:215], v[88:91], v[64:67]
    ds_write_b128 v8, v[48:51] offset:0
    v_mfma_f32_16x16x32_bf16 v[68:71], v[216:219], v[88:91], v[68:71]
    ds_write_b128 v8, v[52:55] offset:1024
    v_mfma_f32_16x16x32_bf16 v[72:75], v[220:223], v[88:91], v[72:75]
    v_mfma_f32_16x16x32_bf16 v[76:79], v[224:227], v[88:91], v[76:79]
    v_mfma_f32_16x16x32_bf16 v[60:63], v[228:231], v[92:95], v[60:63]
    v_mfma_f32_16x16x32_bf16 v[64:67], v[232:235], v[92:95], v[64:67]
    v_mfma_f32_16x16x32_bf16 v[68:71], v[236:239], v[92:95], v[68:71]
    v_mfma_f32_16x16x32_bf16 v[72:75], v[132:135], v[92:95], v[72:75]
    v_mfma_f32_16x16x32_bf16 v[76:79], v[136:139], v[92:95], v[76:79]
    v_mfma_f32_16x16x32_bf16 v[60:63], v[140:143], v[96:99], v[60:63]
    v_mfma_f32_16x16x32_bf16 v[64:67], v[144:147], v[96:99], v[64:67]
    s_waitcnt vmcnt(7)
    v_max3_u32 v9, v108, v109, v110
    v_mfma_f32_16x16x32_bf16 v[68:71], v[148:151], v[96:99], v[68:71]
    s_waitcnt vmcnt(6)
    v_max3_u32 v9, v9, v111, v112
    v_mfma_f32_16x16x32_bf16 v[72:75], v[152:155], v[96:99], v[72:75]
    v_max3_u32 v9, v9, v113, v114
    v_mfma_f32_16x16x32_bf16 v[76:79], v[156:159], v[96:99], v[76:79]
    s_waitcnt vmcnt(5)
    v_max3_u32 v9, v9, v115, v116
    v_mfma_f32_16x16x32_bf16 v[60:63], v[160:163], v[100:103], v[60:63]
    v_max3_u32 v9, v9, v117, v118
    v_mfma_f32_16x16x32_bf16 v[64:67], v[164:167], v[100:103], v[64:67]
    s_waitcnt vmcnt(4)
    v_max3_u32 v9, v9, v119, v120
    v_mfma_f32_16x16x32_bf16 v[68:71], v[168:171], v[100:103], v[68:71]
    v_max3_u32 v9, v9, v121, v122
    v_mfma_f32_16x16x32_bf16 v[72:75], v[172:175], v[100:103], v[72:75]
    s_waitcnt vmcnt(3)
    v_max3_u32 v9, v9, v123, v124
    v_mfma_f32_16x16x32_bf16 v[76:79], v[176:179], v[100:103], v[76:79]
    v_max3_u32 v9, v9, v125, v126
    v_mfma_f32_16x16x32_bf16 v[60:63], v[240:243], v[104:107], v[60:63]
    s_waitcnt vmcnt(2)
    v_max3_u32 v9, v9, v127, v128
    v_mfma_f32_16x16x32_bf16 v[64:67], v[244:247], v[104:107], v[64:67]
    v_max3_u32 v9, v9, v129, v130
    v_mfma_f32_16x16x32_bf16 v[68:71], v[248:251], v[104:107], v[68:71]
    v_max_u32 v9, v9, v131
    v_mfma_f32_16x16x32_bf16 v[72:75], v[180:183], v[104:107], v[72:75]
    v_cmp_eq_u32 vcc, -1, v9
    v_mfma_f32_16x16x32_bf16 v[76:79], v[184:187], v[104:107], v[76:79]
    s_cbranch_vccnz K3_RE3
K3_M3:
    v_mfma_f32_16x16x32_bf16 v[84:87], v[188:191], v[108:111], 0
    v_mfma_f32_16x16x32_bf16 v[88:91], v[192:195], v[108:111], 0
    v_mfma_f32_16x16x32_bf16 v[92:95], v[196:199], v[108:111], 0
    v_mfma_f32_16x16x32_bf16 v[96:99], v[200:203], v[108:111], 0
    ds_write_b128 v8, v[60:63] offset:2048
    v_mfma_f32_16x16x32_bf16 v[100:103], v[204:207], v[108:111], 0
    ds_write_b128 v8, v[64:67] offset:3072
    v_mfma_f32_16x16x32_bf16 v[84:87], v[208:211], v[112:115], v[84:87]
    ds_write_b128 v8, v[68:71] offset:32768
    v_mfma_f32_16x16x32_bf16 v[88:91], v[212:215], v[112:115], v[88:91]
    ds_write_b128 v8, v[72:75] offset:33792
    v_mfma_f32_16x16x32_bf16 v[92:95], v[216:219], v[112:115], v[92:95]
    ds_write_b128 v8, v[76:79] offset:34816
    v_mfma_f32_16x16x32_bf16 v[96:99], v[220:223], v[112:115], v[96:99]
    v_mfma_f32_16x16x32_bf16 v[100:103], v[224:227], v[112:115], v[100:103]
    v_mfma_f32_16x16x32_bf16 v[84:87], v[228:231], v[116:119], v[84:87]
    v_mfma_f32_16x16x32_bf16 v[88:91], v[232:235], v[116:119], v[88:91]
    v_mfma_f32_16x16x32_bf16 v[92:95], v[236:239], v[116:119], v[92:95]
    v_mfma_f32_16x16x32_bf16 v[96:99], v[132:135], v[116:119], v[96:99]
    v_mfma_f32_16x16x32_bf16 v[100:103], v[136:139], v[116:119], v[100:103]
    v_mfma_f32_16x16x32_bf16 v[84:87], v[140:143], v[120:123], v[84:87]
    v_mfma_f32_16x16x32_bf16 v[88:91], v[144:147], v[120:123], v[88:91]
    v_mfma_f32_16x16x32_bf16 v[92:95], v[148:151], v[120:123], v[92:95]
    v_mfma_f32_16x16x32_bf16 v[96:99], v[152:155], v[120:123], v[96:99]
    v_mfma_f32_16x16x32_bf16 v[100:103], v[156:159], v[120:123], v[100:103]
    v_mfma_f32_16x16x32_bf16 v[84:87], v[160:163], v[124:127], v[84:87]
    v_mfma_f32_16x16x32_bf16 v[88:91], v[164:167], v[124:127], v[88:91]
    v_mfma_f32_16x16x32_bf16 v[92:95], v[168:171], v[124:127], v[92:95]
    v_mfma_f32_16x16x32_bf16 v[96:99], v[172:175], v[124:127], v[96:99]
    v_mfma_f32_16x16x32_bf16 v[100:103], v[176:179], v[124:127], v[100:103]
    v_mfma_f32_16x16x32_bf16 v[84:87], v[240:243], v[128:131], v[84:87]
    v_mfma_f32_16x16x32_bf16 v[88:91], v[244:247], v[128:131], v[88:91]
    v_mfma_f32_16x16x32_bf16 v[92:95], v[248:251], v[128:131], v[92:95]
    v_mfma_f32_16x16x32_bf16 v[96:99], v[180:183], v[128:131], v[96:99]
    v_mfma_f32_16x16x32_bf16 v[100:103], v[184:187], v[128:131], v[100:103]
    s_waitcnt vmcnt(1)
    v_lshlrev_b32 v16, 16, v12
    v_and_b32 v17, 0xffff0000, v12
    v_lshlrev_b32 v18, 16, v13
    v_and_b32 v19, 0xffff0000, v13
    v_lshlrev_b32 v20, 16, v14
    v_and_b32 v21, 0xffff0000, v14
    v_lshlrev_b32 v22, 16, v15
    v_and_b32 v23, 0xffff0000, v15
    s_waitcnt vmcnt(0)
    v_lshlrev_b32 v24, 16, v11
    v_and_b32 v25, 0xffff0000, v11
    ds_write_b128 v8, v[84:87] offset:35840
    ds_write_b128 v10, v[88:91] offset:0
    ds_write_b128 v10, v[92:95] offset:1024
    ds_write_b128 v10, v[96:99] offset:2048
    ds_write_b128 v10, v[100:103] offset:3072
    s_waitcnt lgkmcnt(0)
K3_RED:
    s_barrier
    buffer_load_dword v3, off, s[8:11], s69 sc1
    ds_read_b128 v[132:135], v4 offset:0
    ds_read_b128 v[136:139], v4 offset:4096
    ds_read_b128 v[140:143], v4 offset:8192
    ds_read_b128 v[144:147], v4 offset:12288
    ds_read_b128 v[164:167], v6 offset:0
    ds_read_b128 v[168:171], v6 offset:4096
    ds_read_b128 v[172:175], v6 offset:8192
    ds_read_b128 v[176:179], v6 offset:12288
    ds_read_b128 v[148:151], v5 offset:0
    ds_read_b128 v[152:155], v5 offset:4096
    ds_read_b128 v[156:159], v5 offset:8192
    ds_read_b128 v[160:163], v5 offset:12288
    ds_read_b128 v[180:183], v252 offset:0
    ds_read_b128 v[184:187], v252 offset:4096
    ds_read_b128 v[188:191], v252 offset:8192
    ds_read_b128 v[192:195], v252 offset:12288
    ds_read_b128 v[196:199], v2 offset:0
    ds_read_b128 v[200:203], v2 offset:4096
    ds_read_b128 v[204:207], v2 offset:8192
    ds_read_b128 v[208:211], v2 offset:12288
    s_waitcnt lgkmcnt(15)
    v_pk_add_f32 v[132:133], v[132:133], v[136:137]
    v_pk_add_f32 v[134:135], v[134:135], v[138:139]
    v_pk_add_f32 v[140:141], v[140:141], v[144:145]
    v_pk_add_f32 v[142:143], v[142:143], v[146:147]
    v_pk_add_f32 v[132:133], v[132:133], v[140:141]
    v_pk_add_f32 v[134:135], v[134:135], v[142:143]
    s_waitcnt lgkmcnt(14)
    v_pk_add_f32 v[164:165], v[164:165], v[168:169]
    v_pk_add_f32 v[166:167], v[166:167], v[170:171]
    s_waitcnt lgkmcnt(12)
    v_pk_add_f32 v[172:173], v[172:173], v[176:177]
    v_pk_add_f32 v[174:175], v[174:175], v[178:179]
    v_pk_add_f32 v[164:165], v[164:165], v[172:173]
    v_pk_add_f32 v[166:167], v[166:167], v[174:175]
    s_nop 0
    v_permlane32_swap_b32 v132, v164
    v_permlane32_swap_b32 v133, v165
    v_permlane32_swap_b32 v134, v166
    v_permlane32_swap_b32 v135, v167
    v_pk_add_f32 v[132:133], v[132:133], v[16:17]
    v_pk_add_f32 v[134:135], v[134:135], v[18:19]
    v_pk_add_f32 v[132:133], v[132:133], v[164:165]
    v_pk_add_f32 v[134:135], v[134:135], v[166:167]
    v_cvt_pk_bf16_f32 v12, v132, v133
    v_cvt_pk_bf16_f32 v13, v134, v135
    s_waitcnt lgkmcnt(10)
    v_pk_add_f32 v[148:149], v[148:149], v[152:153]
    v_pk_add_f32 v[150:151], v[150:151], v[154:155]
    s_waitcnt lgkmcnt(8)
    v_pk_add_f32 v[156:157], v[156:157], v[160:161]
    v_pk_add_f32 v[158:159], v[158:159], v[162:163]
    v_pk_add_f32 v[148:149], v[148:149], v[156:157]
    v_pk_add_f32 v[150:151], v[150:151], v[158:159]
    s_waitcnt lgkmcnt(6)
    v_pk_add_f32 v[180:181], v[180:181], v[184:185]
    v_pk_add_f32 v[182:183], v[182:183], v[186:187]
    s_waitcnt lgkmcnt(4)
    v_pk_add_f32 v[188:189], v[188:189], v[192:193]
    v_pk_add_f32 v[190:191], v[190:191], v[194:195]
    v_pk_add_f32 v[180:181], v[180:181], v[188:189]
    v_pk_add_f32 v[182:183], v[182:183], v[190:191]
    s_nop 0
    v_permlane32_swap_b32 v148, v180
    v_permlane32_swap_b32 v149, v181
    v_permlane32_swap_b32 v150, v182
    v_permlane32_swap_b32 v151, v183
    v_pk_add_f32 v[148:149], v[148:149], v[20:21]
    v_pk_add_f32 v[150:151], v[150:151], v[22:23]
    v_pk_add_f32 v[148:149], v[148:149], v[180:181]
    v_pk_add_f32 v[150:151], v[150:151], v[182:183]
    v_cvt_pk_bf16_f32 v14, v148, v149
    v_cvt_pk_bf16_f32 v15, v150, v151
    buffer_store_dwordx4 v[12:15], v254, s[60:63], 0 offen
    s_waitcnt lgkmcnt(2)
    v_pk_add_f32 v[196:197], v[196:197], v[200:201]
    v_pk_add_f32 v[198:199], v[198:199], v[202:203]
    s_waitcnt lgkmcnt(0)
    v_pk_add_f32 v[204:205], v[204:205], v[208:209]
    v_pk_add_f32 v[206:207], v[206:207], v[210:211]
    v_pk_add_f32 v[196:197], v[196:197], v[204:205]
    v_pk_add_f32 v[198:199], v[198:199], v[206:207]
    s_nop 1
    v_permlane32_swap_b32 v196, v198
    v_permlane32_swap_b32 v197, v199
    v_pk_add_f32 v[196:197], v[196:197], v[24:25]
    v_pk_add_f32 v[196:197], v[196:197], v[198:199]
    v_cvt_pk_bf16_f32 v11, v196, v197
    buffer_store_dword v11, v255, s[60:63], 0 offen
    s_waitcnt vmcnt(2)
    v_readfirstlane_b32 s31, v3
    s_cmp_lg_u32 s31, 0
    s_cbranch_scc1 K3_HELP
    s_endpgm
K3_HELP:
    s_waitcnt vmcnt(0)
    s_barrier
    v_mov_b32 v16, 0
    buffer_store_dword v16, off, s[8:11], s69 sc1
    s_sub_u32 s31, s31, 1
    s_bfe_u32 s2, s31, 0x30002
    s_bfe_u32 s32, s31, 0x30005
    s_lshl_b32 s32, s32, 3
    s_add_u32 s2, s2, s32
    s_and_b32 s32, s31, 3
    s_lshl_b32 s32, s32, 6
    s_add_u32 s2, s2, s32
    s_min_u32 s55, s55, 2
    v_lshl_add_u32 v0, s20, 6, v0
    s_waitcnt vmcnt(0)
    s_nop 7
    s_branch K2_TOP
K3_WAIT:
    s_mov_b32 s30, s55
K3_POLL:
    s_mov_b64 exec, s[100:101]
    buffer_load_dword v3, v2, s[8:11], s68 offen sc1
    s_mov_b64 exec, -1
    s_waitcnt vmcnt(0)
    v_cmp_eq_u32 vcc, 0, v3
    s_and_b64 vcc, vcc, s[100:101]
    s_cbranch_scc0 K3_RDY
    s_sub_u32 s30, s30, 1
    s_cbranch_scc0 K3_POLL
    s_ff1_i32_b64 s31, vcc
    s_nop 4
    v_readlane_b32 s31, v2, s31
    s_lshr_b32 s31, s31, 7
    s_add_u32 s31, s31, 1
    v_mov_b32 v16, s31
    buffer_store_dword v16, off, s[8:11], s69 sc1
    s_waitcnt vmcnt(0)
    v_lshrrev_b32 v16, 4, v0
    v_xor_b32 v7, v16, v0
    v_lshlrev_b32 v7, 4, v7
    v_add_u32 v7, s26, v7
    v_and_b32 v16, 1, v16
    v_and_or_b32 v16, v0, 12, v16
    s_and_b32 s31, s20, 1
    v_lshl_add_u32 v16, s31, 1, v16
    v_and_b32 v17, 3, v0
    v_xor_b32 v4, v16, v17
    v_lshl_add_u32 v4, v17, 4, v4
    v_lshlrev_b32 v4, 4, v4
    s_lshr_b32 s31, s20, 1
    s_mul_i32 s34, s31, 5
    s_and_b32 s32, s66, 3
    s_xor_b32 s31, s31, s32
    v_lshrrev_b32 v5, 5, v0
    v_lshl_add_u32 v4, v5, 14, v4
    s_lshl_b32 s32, s65, 2
    s_add_u32 s31, s31, s32
    s_mul_i32 s31, s31, 20480
    s_mul_i32 s32, s66, 160
    s_add_u32 s31, s31, s32
    v_mul_u32_u24 v16, 1280, v16
    s_bitcmp1_b32 s66, 0
    s_cselect_b32 s32, 32, 0
    s_cselect_b32 s33, 0, 128
    s_add_u32 s32, s32, s31
    s_add_u32 s33, s33, s31
    v_lshl_add_u32 v254, v5, 2, v17
    v_lshl_add_u32 v255, v17, 1, v5
    v_lshl_add_u32 v254, v254, 4, v16
    v_lshl_add_u32 v255, v255, 2, v16
    v_add_u32 v254, s32, v254
    v_add_u32 v255, s33, v255
    v_add_u32 v8, 0x10000, v7
    v_add_u32 v10, 0x20000, v7
    s_add_u32 s31, s34, 4
    s_lshr_b32 s32, s31, 2
    s_mul_i32 s32, s32, 28
    s_add_u32 s31, s31, s32
    v_lshl_add_u32 v2, s31, 10, v4
    s_add_u32 s31, s34, 3
    s_lshr_b32 s32, s31, 2
    s_mul_i32 s32, s32, 28
    s_add_u32 s31, s31, s32
    v_lshl_add_u32 v252, s31, 10, v4
    s_add_u32 s31, s34, 2
    s_lshr_b32 s32, s31, 2
    s_mul_i32 s32, s32, 28
    s_add_u32 s31, s31, s32
    v_lshl_add_u32 v6, s31, 10, v4
    s_add_u32 s31, s34, 1
    s_lshr_b32 s32, s31, 2
    s_mul_i32 s32, s32, 28
    s_add_u32 s31, s31, s32
    v_lshl_add_u32 v5, s31, 10, v4
    s_add_u32 s31, s34, 0
    s_lshr_b32 s32, s31, 2
    s_mul_i32 s32, s32, 28
    s_add_u32 s31, s31, s32
    v_lshl_add_u32 v4, s31, 10, v4
    s_branch K3_RED
K3_RE0:
    s_waitcnt vmcnt(0)
    s_mov_b32 s31, 0
    v_max3_u32 v9, v36, v37, v38
    v_max3_u32 v9, v9, v39, v60
    v_max3_u32 v9, v9, v61, v62
    v_max3_u32 v9, v9, v63, v84
    v_max3_u32 v9, v9, v85, v86
    v_max3_u32 v9, v9, v87, v108
    v_max3_u32 v9, v9, v109, v110
    v_max_u32 v9, v9, v111
    v_cmp_eq_u32 vcc, -1, v9
    s_and_b64 exec, vcc, vcc
    s_cbranch_scc0 K3_RE00
    s_mov_b32 s31, 1
    buffer_load_dwordx4 v[36:39], v1, s[8:11], s4 offen offset:0 sc1
    buffer_load_dwordx4 v[60:63], v1, s[8:11], s27 offen offset:0 sc1
    buffer_load_dwordx4 v[84:87], v1, s[8:11], s97 offen offset:0 sc1
    buffer_load_dwordx4 v[108:111], v1, s[8:11], s39 offen offset:0 sc1
K3_RE00:
    s_mov_b64 exec, -1
    v_max3_u32 v9, v40, v41, v42
    v_max3_u32 v9, v9, v43, v64
    v_max3_u32 v9, v9, v65, v66
    v_max3_u32 v9, v9, v67, v88
    v_max3_u32 v9, v9, v89, v90
    v_max3_u32 v9, v9, v91, v112
    v_max3_u32 v9, v9, v113, v114
    v_max_u32 v9, v9, v115
    v_cmp_eq_u32 vcc, -1, v9
    s_and_b64 exec, vcc, vcc
    s_cbranch_scc0 K3_RE01
    s_mov_b32 s31, 1
    buffer_load_dwordx4 v[40:43], v1, s[8:11], s4 offen offset:2048 sc1
    buffer_load_dwordx4 v[64:67], v1, s[8:11], s27 offen offset:2048 sc1
    buffer_load_dwordx4 v[88:91], v1, s[8:11], s97 offen offset:2048 sc1
    buffer_load_dwordx4 v[112:115], v1, s[8:11], s39 offen offset:2048 sc1
K3_RE01:
    s_mov_b64 exec, -1
    v_max3_u32 v9, v44, v45, v46
    v_max3_u32 v9, v9, v47, v68
    v_max3_u32 v9, v9, v69, v70
    v_max3_u32 v9, v9, v71, v92
    v_max3_u32 v9, v9, v93, v94
    v_max3_u32 v9, v9, v95, v116
    v_max3_u32 v9, v9, v117, v118
    v_max_u32 v9, v9, v119
    v_cmp_eq_u32 vcc, -1, v9
    s_and_b64 exec, vcc, vcc
    s_cbranch_scc0 K3_RE02
    s_mov_b32 s31, 1
    buffer_load_dwordx4 v[44:47], v1, s[8:11], s5 offen offset:0 sc1
    buffer_load_dwordx4 v[68:71], v1, s[8:11], s28 offen offset:0 sc1
    buffer_load_dwordx4 v[92:95], v1, s[8:11], s98 offen offset:0 sc1
    buffer_load_dwordx4 v[116:119], v1, s[8:11], s40 offen offset:0 sc1
K3_RE02:
    s_mov_b64 exec, -1
    v_max3_u32 v9, v48, v49, v50
    v_max3_u32 v9, v9, v51, v72
    v_max3_u32 v9, v9, v73, v74
    v_max3_u32 v9, v9, v75, v96
    v_max3_u32 v9, v9, v97, v98
    v_max3_u32 v9, v9, v99, v120
    v_max3_u32 v9, v9, v121, v122
    v_max_u32 v9, v9, v123
    v_cmp_eq_u32 vcc, -1, v9
    s_and_b64 exec, vcc, vcc
    s_cbranch_scc0 K3_RE03
    s_mov_b32 s31, 1
    buffer_load_dwordx4 v[48:51], v1, s[8:11], s5 offen offset:2048 sc1
    buffer_load_dwordx4 v[72:75], v1, s[8:11], s28 offen offset:2048 sc1
    buffer_load_dwordx4 v[96:99], v1, s[8:11], s98 offen offset:2048 sc1
    buffer_load_dwordx4 v[120:123], v1, s[8:11], s40 offen offset:2048 sc1
K3_RE03:
    s_mov_b64 exec, -1
    v_max3_u32 v9, v52, v53, v54
    v_max3_u32 v9, v9, v55, v76
    v_max3_u32 v9, v9, v77, v78
    v_max3_u32 v9, v9, v79, v100
    v_max3_u32 v9, v9, v101, v102
    v_max3_u32 v9, v9, v103, v124
    v_max3_u32 v9, v9, v125, v126
    v_max_u32 v9, v9, v127
    v_cmp_eq_u32 vcc, -1, v9
    s_and_b64 exec, vcc, vcc
    s_cbranch_scc0 K3_RE04
    s_mov_b32 s31, 1
    buffer_load_dwordx4 v[52:55], v1, s[8:11], s96 offen offset:0 sc1
    buffer_load_dwordx4 v[76:79], v1, s[8:11], s29 offen offset:0 sc1
    buffer_load_dwordx4 v[100:103], v1, s[8:11], s99 offen offset:0 sc1
    buffer_load_dwordx4 v[124:127], v1, s[8:11], s41 offen offset:0 sc1
K3_RE04:
    s_mov_b64 exec, -1
    v_max3_u32 v9, v56, v57, v58
    v_max3_u32 v9, v9, v59, v80
    v_max3_u32 v9, v9, v81, v82
    v_max3_u32 v9, v9, v83, v104
    v_max3_u32 v9, v9, v105, v106
    v_max3_u32 v9, v9, v107, v128
    v_max3_u32 v9, v9, v129, v130
    v_max_u32 v9, v9, v131
    v_cmp_eq_u32 vcc, -1, v9
    s_and_b64 exec, vcc, vcc
    s_cbranch_scc0 K3_RE05
    s_mov_b32 s31, 1
    buffer_load_dwordx4 v[56:59], v253, s[8:11], s96 offen offset:2048 sc1
    buffer_load_dwordx4 v[80:83], v253, s[8:11], s29 offen offset:2048 sc1
    buffer_load_dwordx4 v[104:107], v253, s[8:11], s99 offen offset:2048 sc1
    buffer_load_dwordx4 v[128:131], v253, s[8:11], s41 offen offset:2048 sc1
K3_RE05:
    s_mov_b64 exec, -1
    s_cmp_eq_u32 s31, 0
    s_cbranch_scc1 K3_M0
    s_sub_u32 s30, s30, 1
    s_cbranch_scc0 K3_RE0
    s_mov_b32 s30, 0
    s_waitcnt vmcnt(0)
    s_branch K3_M0
K3_RE1:
    s_waitcnt vmcnt(0)
    s_mov_b32 s31, 0
    v_max3_u32 v9, v60, v61, v62
    v_max3_u32 v9, v9, v63, v84
    v_max3_u32 v9, v9, v85, v86
    v_max3_u32 v9, v9, v87, v108
    v_max3_u32 v9, v9, v109, v110
    v_max_u32 v9, v9, v111
    v_cmp_eq_u32 vcc, -1, v9
    s_and_b64 exec, vcc, vcc
    s_cbranch_scc0 K3_RE10
    s_mov_b32 s31, 1
    buffer_load_dwordx4 v[60:63], v1, s[8:11], s27 offen offset:0 sc1
    buffer_load_dwordx4 v[84:87], v1, s[8:11], s97 offen offset:0 sc1
    buffer_load_dwordx4 v[108:111], v1, s[8:11], s39 offen offset:0 sc1
K3_RE10:
    s_mov_b64 exec, -1
    v_max3_u32 v9, v64, v65, v66
    v_max3_u32 v9, v9, v67, v88
    v_max3_u32 v9, v9, v89, v90
    v_max3_u32 v9, v9, v91, v112
    v_max3_u32 v9, v9, v113, v114
    v_max_u32 v9, v9, v115
    v_cmp_eq_u32 vcc, -1, v9
    s_and_b64 exec, vcc, vcc
    s_cbranch_scc0 K3_RE11
    s_mov_b32 s31, 1
    buffer_load_dwordx4 v[64:67], v1, s[8:11], s27 offen offset:2048 sc1
    buffer_load_dwordx4 v[88:91], v1, s[8:11], s97 offen offset:2048 sc1
    buffer_load_dwordx4 v[112:115], v1, s[8:11], s39 offen offset:2048 sc1
K3_RE11:
    s_mov_b64 exec, -1
    v_max3_u32 v9, v68, v69, v70
    v_max3_u32 v9, v9, v71, v92
    v_max3_u32 v9, v9, v93, v94
    v_max3_u32 v9, v9, v95, v116
    v_max3_u32 v9, v9, v117, v118
    v_max_u32 v9, v9, v119
    v_cmp_eq_u32 vcc, -1, v9
    s_and_b64 exec, vcc, vcc
    s_cbranch_scc0 K3_RE12
    s_mov_b32 s31, 1
    buffer_load_dwordx4 v[68:71], v1, s[8:11], s28 offen offset:0 sc1
    buffer_load_dwordx4 v[92:95], v1, s[8:11], s98 offen offset:0 sc1
    buffer_load_dwordx4 v[116:119], v1, s[8:11], s40 offen offset:0 sc1
K3_RE12:
    s_mov_b64 exec, -1
    v_max3_u32 v9, v72, v73, v74
    v_max3_u32 v9, v9, v75, v96
    v_max3_u32 v9, v9, v97, v98
    v_max3_u32 v9, v9, v99, v120
    v_max3_u32 v9, v9, v121, v122
    v_max_u32 v9, v9, v123
    v_cmp_eq_u32 vcc, -1, v9
    s_and_b64 exec, vcc, vcc
    s_cbranch_scc0 K3_RE13
    s_mov_b32 s31, 1
    buffer_load_dwordx4 v[72:75], v1, s[8:11], s28 offen offset:2048 sc1
    buffer_load_dwordx4 v[96:99], v1, s[8:11], s98 offen offset:2048 sc1
    buffer_load_dwordx4 v[120:123], v1, s[8:11], s40 offen offset:2048 sc1
K3_RE13:
    s_mov_b64 exec, -1
    v_max3_u32 v9, v76, v77, v78
    v_max3_u32 v9, v9, v79, v100
    v_max3_u32 v9, v9, v101, v102
    v_max3_u32 v9, v9, v103, v124
    v_max3_u32 v9, v9, v125, v126
    v_max_u32 v9, v9, v127
    v_cmp_eq_u32 vcc, -1, v9
    s_and_b64 exec, vcc, vcc
    s_cbranch_scc0 K3_RE14
    s_mov_b32 s31, 1
    buffer_load_dwordx4 v[76:79], v1, s[8:11], s29 offen offset:0 sc1
    buffer_load_dwordx4 v[100:103], v1, s[8:11], s99 offen offset:0 sc1
    buffer_load_dwordx4 v[124:127], v1, s[8:11], s41 offen offset:0 sc1
K3_RE14:
    s_mov_b64 exec, -1
    v_max3_u32 v9, v80, v81, v82
    v_max3_u32 v9, v9, v83, v104
    v_max3_u32 v9, v9, v105, v106
    v_max3_u32 v9, v9, v107, v128
    v_max3_u32 v9, v9, v129, v130
    v_max_u32 v9, v9, v131
    v_cmp_eq_u32 vcc, -1, v9
    s_and_b64 exec, vcc, vcc
    s_cbranch_scc0 K3_RE15
    s_mov_b32 s31, 1
    buffer_load_dwordx4 v[80:83], v253, s[8:11], s29 offen offset:2048 sc1
    buffer_load_dwordx4 v[104:107], v253, s[8:11], s99 offen offset:2048 sc1
    buffer_load_dwordx4 v[128:131], v253, s[8:11], s41 offen offset:2048 sc1
K3_RE15:
    s_mov_b64 exec, -1
    s_cmp_eq_u32 s31, 0
    s_cbranch_scc1 K3_M1
    s_sub_u32 s30, s30, 1
    s_cbranch_scc0 K3_RE1
    s_mov_b32 s30, 0
    s_waitcnt vmcnt(0)
    s_branch K3_M1
K3_RE2:
    s_waitcnt vmcnt(0)
    s_mov_b32 s31, 0
    v_max3_u32 v9, v84, v85, v86
    v_max3_u32 v9, v9, v87, v108
    v_max3_u32 v9, v9, v109, v110
    v_max_u32 v9, v9, v111
    v_cmp_eq_u32 vcc, -1, v9
    s_and_b64 exec, vcc, vcc
    s_cbranch_scc0 K3_RE20
    s_mov_b32 s31, 1
    buffer_load_dwordx4 v[84:87], v1, s[8:11], s97 offen offset:0 sc1
    buffer_load_dwordx4 v[108:111], v1, s[8:11], s39 offen offset:0 sc1
K3_RE20:
    s_mov_b64 exec, -1
    v_max3_u32 v9, v88, v89, v90
    v_max3_u32 v9, v9, v91, v112
    v_max3_u32 v9, v9, v113, v114
    v_max_u32 v9, v9, v115
    v_cmp_eq_u32 vcc, -1, v9
    s_and_b64 exec, vcc, vcc
    s_cbranch_scc0 K3_RE21
    s_mov_b32 s31, 1
    buffer_load_dwordx4 v[88:91], v1, s[8:11], s97 offen offset:2048 sc1
    buffer_load_dwordx4 v[112:115], v1, s[8:11], s39 offen offset:2048 sc1
K3_RE21:
    s_mov_b64 exec, -1
    v_max3_u32 v9, v92, v93, v94
    v_max3_u32 v9, v9, v95, v116
    v_max3_u32 v9, v9, v117, v118
    v_max_u32 v9, v9, v119
    v_cmp_eq_u32 vcc, -1, v9
    s_and_b64 exec, vcc, vcc
    s_cbranch_scc0 K3_RE22
    s_mov_b32 s31, 1
    buffer_load_dwordx4 v[92:95], v1, s[8:11], s98 offen offset:0 sc1
    buffer_load_dwordx4 v[116:119], v1, s[8:11], s40 offen offset:0 sc1
K3_RE22:
    s_mov_b64 exec, -1
    v_max3_u32 v9, v96, v97, v98
    v_max3_u32 v9, v9, v99, v120
    v_max3_u32 v9, v9, v121, v122
    v_max_u32 v9, v9, v123
    v_cmp_eq_u32 vcc, -1, v9
    s_and_b64 exec, vcc, vcc
    s_cbranch_scc0 K3_RE23
    s_mov_b32 s31, 1
    buffer_load_dwordx4 v[96:99], v1, s[8:11], s98 offen offset:2048 sc1
    buffer_load_dwordx4 v[120:123], v1, s[8:11], s40 offen offset:2048 sc1
K3_RE23:
    s_mov_b64 exec, -1
    v_max3_u32 v9, v100, v101, v102
    v_max3_u32 v9, v9, v103, v124
    v_max3_u32 v9, v9, v125, v126
    v_max_u32 v9, v9, v127
    v_cmp_eq_u32 vcc, -1, v9
    s_and_b64 exec, vcc, vcc
    s_cbranch_scc0 K3_RE24
    s_mov_b32 s31, 1
    buffer_load_dwordx4 v[100:103], v1, s[8:11], s99 offen offset:0 sc1
    buffer_load_dwordx4 v[124:127], v1, s[8:11], s41 offen offset:0 sc1
K3_RE24:
    s_mov_b64 exec, -1
    v_max3_u32 v9, v104, v105, v106
    v_max3_u32 v9, v9, v107, v128
    v_max3_u32 v9, v9, v129, v130
    v_max_u32 v9, v9, v131
    v_cmp_eq_u32 vcc, -1, v9
    s_and_b64 exec, vcc, vcc
    s_cbranch_scc0 K3_RE25
    s_mov_b32 s31, 1
    buffer_load_dwordx4 v[104:107], v253, s[8:11], s99 offen offset:2048 sc1
    buffer_load_dwordx4 v[128:131], v253, s[8:11], s41 offen offset:2048 sc1
K3_RE25:
    s_mov_b64 exec, -1
    s_cmp_eq_u32 s31, 0
    s_cbranch_scc1 K3_M2
    s_sub_u32 s30, s30, 1
    s_cbranch_scc0 K3_RE2
    s_mov_b32 s30, 0
    s_waitcnt vmcnt(0)
    s_branch K3_M2
K3_RE3:
    s_waitcnt vmcnt(0)
    s_mov_b32 s31, 0
    v_max3_u32 v9, v108, v109, v110
    v_max_u32 v9, v9, v111
    v_cmp_eq_u32 vcc, -1, v9
    s_and_b64 exec, vcc, vcc
    s_cbranch_scc0 K3_RE30
    s_mov_b32 s31, 1
    buffer_load_dwordx4 v[108:111], v1, s[8:11], s39 offen offset:0 sc1
K3_RE30:
    s_mov_b64 exec, -1
    v_max3_u32 v9, v112, v113, v114
    v_max_u32 v9, v9, v115
    v_cmp_eq_u32 vcc, -1, v9
    s_and_b64 exec, vcc, vcc
    s_cbranch_scc0 K3_RE31
    s_mov_b32 s31, 1
    buffer_load_dwordx4 v[112:115], v1, s[8:11], s39 offen offset:2048 sc1
K3_RE31:
    s_mov_b64 exec, -1
    v_max3_u32 v9, v116, v117, v118
    v_max_u32 v9, v9, v119
    v_cmp_eq_u32 vcc, -1, v9
    s_and_b64 exec, vcc, vcc
    s_cbranch_scc0 K3_RE32
    s_mov_b32 s31, 1
    buffer_load_dwordx4 v[116:119], v1, s[8:11], s40 offen offset:0 sc1
K3_RE32:
    s_mov_b64 exec, -1
    v_max3_u32 v9, v120, v121, v122
    v_max_u32 v9, v9, v123
    v_cmp_eq_u32 vcc, -1, v9
    s_and_b64 exec, vcc, vcc
    s_cbranch_scc0 K3_RE33
    s_mov_b32 s31, 1
    buffer_load_dwordx4 v[120:123], v1, s[8:11], s40 offen offset:2048 sc1
K3_RE33:
    s_mov_b64 exec, -1
    v_max3_u32 v9, v124, v125, v126
    v_max_u32 v9, v9, v127
    v_cmp_eq_u32 vcc, -1, v9
    s_and_b64 exec, vcc, vcc
    s_cbranch_scc0 K3_RE34
    s_mov_b32 s31, 1
    buffer_load_dwordx4 v[124:127], v1, s[8:11], s41 offen offset:0 sc1
K3_RE34:
    s_mov_b64 exec, -1
    v_max3_u32 v9, v128, v129, v130
    v_max_u32 v9, v9, v131
    v_cmp_eq_u32 vcc, -1, v9
    s_and_b64 exec, vcc, vcc
    s_cbranch_scc0 K3_RE35
    s_mov_b32 s31, 1
    buffer_load_dwordx4 v[128:131], v253, s[8:11], s41 offen offset:2048 sc1
K3_RE35:
    s_mov_b64 exec, -1
    s_cmp_eq_u32 s31, 0
    s_cbranch_scc1 K3_M3
    s_sub_u32 s30, s30, 1
    s_cbranch_scc0 K3_RE3
    s_mov_b32 s30, 0
    s_waitcnt vmcnt(0)
    s_branch K3_M3
K2_SLOW0:
    s_waitcnt vmcnt(0)
    v_cndmask_b32 v120, v120, 0, s[36:37]
    v_cndmask_b32 v121, v121, 0, s[36:37]
    v_mov_b32 v254, 0xff800000
    s_mov_b32 s31, s39
    s_mov_b32 s30, 0
K2_SLOW0_a:
    s_add_u32 s32, s31, 0
    buffer_load_dwordx4 v[124:127], v7, s[8:11], s32 offen
    buffer_load_dwordx2 v[140:141], v8, s[8:11], s32 offen offset:1024
    s_add_u32 s32, s31, 122880
    buffer_load_dwordx4 v[128:131], v7, s[8:11], s32 offen
    buffer_load_dwordx2 v[142:143], v8, s[8:11], s32 offen offset:1024
    s_add_u32 s32, s31, 245760
    buffer_load_dwordx4 v[132:135], v7, s[8:11], s32 offen
    buffer_load_dwordx2 v[144:145], v8, s[8:11], s32 offen offset:1024
    s_add_u32 s32, s31, 368640
    buffer_load_dwordx4 v[136:139], v7, s[8:11], s32 offen
    buffer_load_dwordx2 v[146:147], v8, s[8:11], s32 offen offset:1024
    s_waitcnt vmcnt(7)
    v_mfma_f32_32x32x16_bf16 v[16:31], v[124:127], v[112:115], 0
    s_waitcnt vmcnt(6)
    v_mfma_f32_32x32x8bf16_1k v[16:31], v[140:141], v[120:121], v[16:31]
    s_nop 11
    v_max3_f32 v254, v254, v16, v17
    v_max3_f32 v254, v254, v18, v19
    v_max3_f32 v254, v254, v20, v21
    v_max3_f32 v254, v254, v22, v23
    v_max3_f32 v254, v254, v24, v25
    v_max3_f32 v254, v254, v26, v27
    v_max3_f32 v254, v254, v28, v29
    v_max3_f32 v254, v254, v30, v31
    s_waitcnt vmcnt(5)
    v_mfma_f32_32x32x16_bf16 v[16:31], v[128:131], v[112:115], 0
    s_waitcnt vmcnt(4)
    v_mfma_f32_32x32x8bf16_1k v[16:31], v[142:143], v[120:121], v[16:31]
    s_nop 11
    v_max3_f32 v254, v254, v16, v17
    v_max3_f32 v254, v254, v18, v19
    v_max3_f32 v254, v254, v20, v21
    v_max3_f32 v254, v254, v22, v23
    v_max3_f32 v254, v254, v24, v25
    v_max3_f32 v254, v254, v26, v27
    v_max3_f32 v254, v254, v28, v29
    v_max3_f32 v254, v254, v30, v31
    s_waitcnt vmcnt(3)
    v_mfma_f32_32x32x16_bf16 v[16:31], v[132:135], v[112:115], 0
    s_waitcnt vmcnt(2)
    v_mfma_f32_32x32x8bf16_1k v[16:31], v[144:145], v[120:121], v[16:31]
    s_nop 11
    v_max3_f32 v254, v254, v16, v17
    v_max3_f32 v254, v254, v18, v19
    v_max3_f32 v254, v254, v20, v21
    v_max3_f32 v254, v254, v22, v23
    v_max3_f32 v254, v254, v24, v25
    v_max3_f32 v254, v254, v26, v27
    v_max3_f32 v254, v254, v28, v29
    v_max3_f32 v254, v254, v30, v31
    s_waitcnt vmcnt(1)
    v_mfma_f32_32x32x16_bf16 v[16:31], v[136:139], v[112:115], 0
    s_waitcnt vmcnt(0)
    v_mfma_f32_32x32x8bf16_1k v[16:31], v[146:147], v[120:121], v[16:31]
    s_nop 11
    v_max3_f32 v254, v254, v16, v17
    v_max3_f32 v254, v254, v18, v19
    v_max3_f32 v254, v254, v20, v21
    v_max3_f32 v254, v254, v22, v23
    v_max3_f32 v254, v254, v24, v25
    v_max3_f32 v254, v254, v26, v27
    v_max3_f32 v254, v254, v28, v29
    v_max3_f32 v254, v254, v30, v31
    s_add_u32 s31, s31, 491520
    s_add_u32 s30, s30, 1
    s_cmp_lt_u32 s30, 16
    s_cbranch_scc1 K2_SLOW0_a
    v_mov_b32 v9, v254
    s_nop 1
    v_permlane32_swap_b32 v9, v254
    v_max_f32 v254, v254, v9
    s_add_u32 s34, s26, 32768
    v_add_u32 v255, s34, v255
    s_mov_b32 s31, s39
    s_mov_b32 s30, 0
    v_lshl_add_u32 v9, v0, 3, s34
    v_mov_b32 v16, 0x3f80
    v_mov_b32 v17, 0
    ds_write_b64 v9, v[16:17] offset:1536
    ds_write_b64 v9, v[16:17] offset:3584
    ds_write_b64 v9, v[16:17] offset:34304
    ds_write_b64 v9, v[16:17] offset:36352
    s_waitcnt lgkmcnt(0)
    v_mov_b32 v48, 0
    v_mov_b32 v49, 0
    v_mov_b32 v50, 0
    v_mov_b32 v51, 0
    v_mov_b32 v52, 0
    v_mov_b32 v53, 0
    v_mov_b32 v54, 0
    v_mov_b32 v55, 0
    v_mov_b32 v56, 0
    v_mov_b32 v57, 0
    v_mov_b32 v58, 0
    v_mov_b32 v59, 0
    v_mov_b32 v60, 0
    v_mov_b32 v61, 0
    v_mov_b32 v62, 0
    v_mov_b32 v63, 0
K2_SLOW0_b:
    s_add_u32 s33, s31, 40960
    s_add_u32 m0, s34, 0
    s_nop 0
    buffer_load_dwordx4 v7, s[8:11], s33 offen lds
    s_mov_b32 exec_hi, 0
    buffer_load_dwordx4 v6, s[8:11], s33 offen offset:1024 lds
    s_mov_b32 exec_hi, -1
    s_add_u32 s33, s31, 163840
    s_add_u32 m0, s34, 2048
    s_nop 0
    buffer_load_dwordx4 v7, s[8:11], s33 offen lds
    s_mov_b32 exec_hi, 0
    buffer_load_dwordx4 v6, s[8:11], s33 offen offset:1024 lds
    s_mov_b32 exec_hi, -1
    s_add_u32 s33, s31, 286720
    s_add_u32 m0, s34, 32768
    s_nop 0
    buffer_load_dwordx4 v7, s[8:11], s33 offen lds
    s_mov_b32 exec_hi, 0
    buffer_load_dwordx4 v6, s[8:11], s33 offen offset:1024 lds
    s_mov_b32 exec_hi, -1
    s_add_u32 s33, s31, 409600
    s_add_u32 m0, s34, 34816
    s_nop 0
    buffer_load_dwordx4 v7, s[8:11], s33 offen lds
    s_mov_b32 exec_hi, 0
    buffer_load_dwordx4 v6, s[8:11], s33 offen offset:1024 lds
    s_mov_b32 exec_hi, -1
    s_add_u32 s32, s31, 0
    buffer_load_dwordx4 v[124:127], v7, s[8:11], s32 offen
    buffer_load_dwordx2 v[140:141], v8, s[8:11], s32 offen offset:1024
    s_add_u32 s32, s31, 122880
    buffer_load_dwordx4 v[128:131], v7, s[8:11], s32 offen
    buffer_load_dwordx2 v[142:143], v8, s[8:11], s32 offen offset:1024
    s_add_u32 s32, s31, 245760
    buffer_load_dwordx4 v[132:135], v7, s[8:11], s32 offen
    buffer_load_dwordx2 v[144:145], v8, s[8:11], s32 offen offset:1024
    s_add_u32 s32, s31, 368640
    buffer_load_dwordx4 v[136:139], v7, s[8:11], s32 offen
    buffer_load_dwordx2 v[146:147], v8, s[8:11], s32 offen offset:1024
    s_waitcnt vmcnt(0)
    v_mfma_f32_32x32x16_bf16 v[16:31], v[124:127], v[112:115], 0
    v_mfma_f32_32x32x8bf16_1k v[16:31], v[140:141], v[120:121], v[16:31]
    ds_read_b64_tr_b16 v[148:149], v255 offset:0
    ds_read_b64_tr_b16 v[150:151], v255 offset:64
    ds_read_b64_tr_b16 v[152:153], v255 offset:256
    ds_read_b64_tr_b16 v[154:155], v255 offset:320
    s_nop 7
    v_sub_f32 v16, v16, v254
    v_sub_f32 v17, v17, v254
    v_sub_f32 v18, v18, v254
    v_sub_f32 v19, v19, v254
    v_sub_f32 v20, v20, v254
    v_sub_f32 v21, v21, v254
    v_sub_f32 v22, v22, v254
    v_sub_f32 v23, v23, v254
    v_sub_f32 v24, v24, v254
    v_sub_f32 v25, v25, v254
    v_sub_f32 v26, v26, v254
    v_sub_f32 v27, v27, v254
    v_sub_f32 v28, v28, v254
    v_sub_f32 v29, v29, v254
    v_sub_f32 v30, v30, v254
    v_sub_f32 v31, v31, v254
    v_exp_f32 v16, v16
    v_exp_f32 v17, v17
    v_exp_f32 v18, v18
    v_exp_f32 v19, v19
    v_exp_f32 v20, v20
    v_exp_f32 v21, v21
    v_exp_f32 v22, v22
    v_exp_f32 v23, v23
    v_exp_f32 v24, v24
    v_exp_f32 v25, v25
    v_exp_f32 v26, v26
    v_exp_f32 v27, v27
    v_exp_f32 v28, v28
    v_exp_f32 v29, v29
    v_exp_f32 v30, v30
    v_exp_f32 v31, v31
    s_waitcnt lgkmcnt(2)
    v_smfmac_f32_32x32x32_bf16 v[48:63], v[148:151], v[16:23], v5
    s_waitcnt lgkmcnt(0)
    v_smfmac_f32_32x32x32_bf16 v[48:63], v[152:155], v[24:31], v5
    v_mfma_f32_32x32x16_bf16 v[16:31], v[128:131], v[112:115], 0
    v_mfma_f32_32x32x8bf16_1k v[16:31], v[142:143], v[120:121], v[16:31]
    ds_read_b64_tr_b16 v[148:149], v255 offset:2048
    ds_read_b64_tr_b16 v[150:151], v255 offset:2112
    ds_read_b64_tr_b16 v[152:153], v255 offset:2304
    ds_read_b64_tr_b16 v[154:155], v255 offset:2368
    s_nop 7
    v_sub_f32 v16, v16, v254
    v_sub_f32 v17, v17, v254
    v_sub_f32 v18, v18, v254
    v_sub_f32 v19, v19, v254
    v_sub_f32 v20, v20, v254
    v_sub_f32 v21, v21, v254
    v_sub_f32 v22, v22, v254
    v_sub_f32 v23, v23, v254
    v_sub_f32 v24, v24, v254
    v_sub_f32 v25, v25, v254
    v_sub_f32 v26, v26, v254
    v_sub_f32 v27, v27, v254
    v_sub_f32 v28, v28, v254
    v_sub_f32 v29, v29, v254
    v_sub_f32 v30, v30, v254
    v_sub_f32 v31, v31, v254
    v_exp_f32 v16, v16
    v_exp_f32 v17, v17
    v_exp_f32 v18, v18
    v_exp_f32 v19, v19
    v_exp_f32 v20, v20
    v_exp_f32 v21, v21
    v_exp_f32 v22, v22
    v_exp_f32 v23, v23
    v_exp_f32 v24, v24
    v_exp_f32 v25, v25
    v_exp_f32 v26, v26
    v_exp_f32 v27, v27
    v_exp_f32 v28, v28
    v_exp_f32 v29, v29
    v_exp_f32 v30, v30
    v_exp_f32 v31, v31
    s_waitcnt lgkmcnt(2)
    v_smfmac_f32_32x32x32_bf16 v[48:63], v[148:151], v[16:23], v5
    s_waitcnt lgkmcnt(0)
    v_smfmac_f32_32x32x32_bf16 v[48:63], v[152:155], v[24:31], v5
    v_mfma_f32_32x32x16_bf16 v[16:31], v[132:135], v[112:115], 0
    v_mfma_f32_32x32x8bf16_1k v[16:31], v[144:145], v[120:121], v[16:31]
    ds_read_b64_tr_b16 v[148:149], v255 offset:32768
    ds_read_b64_tr_b16 v[150:151], v255 offset:32832
    ds_read_b64_tr_b16 v[152:153], v255 offset:33024
    ds_read_b64_tr_b16 v[154:155], v255 offset:33088
    s_nop 7
    v_sub_f32 v16, v16, v254
    v_sub_f32 v17, v17, v254
    v_sub_f32 v18, v18, v254
    v_sub_f32 v19, v19, v254
    v_sub_f32 v20, v20, v254
    v_sub_f32 v21, v21, v254
    v_sub_f32 v22, v22, v254
    v_sub_f32 v23, v23, v254
    v_sub_f32 v24, v24, v254
    v_sub_f32 v25, v25, v254
    v_sub_f32 v26, v26, v254
    v_sub_f32 v27, v27, v254
    v_sub_f32 v28, v28, v254
    v_sub_f32 v29, v29, v254
    v_sub_f32 v30, v30, v254
    v_sub_f32 v31, v31, v254
    v_exp_f32 v16, v16
    v_exp_f32 v17, v17
    v_exp_f32 v18, v18
    v_exp_f32 v19, v19
    v_exp_f32 v20, v20
    v_exp_f32 v21, v21
    v_exp_f32 v22, v22
    v_exp_f32 v23, v23
    v_exp_f32 v24, v24
    v_exp_f32 v25, v25
    v_exp_f32 v26, v26
    v_exp_f32 v27, v27
    v_exp_f32 v28, v28
    v_exp_f32 v29, v29
    v_exp_f32 v30, v30
    v_exp_f32 v31, v31
    s_waitcnt lgkmcnt(2)
    v_smfmac_f32_32x32x32_bf16 v[48:63], v[148:151], v[16:23], v5
    s_waitcnt lgkmcnt(0)
    v_smfmac_f32_32x32x32_bf16 v[48:63], v[152:155], v[24:31], v5
    v_mfma_f32_32x32x16_bf16 v[16:31], v[136:139], v[112:115], 0
    v_mfma_f32_32x32x8bf16_1k v[16:31], v[146:147], v[120:121], v[16:31]
    ds_read_b64_tr_b16 v[148:149], v255 offset:34816
    ds_read_b64_tr_b16 v[150:151], v255 offset:34880
    ds_read_b64_tr_b16 v[152:153], v255 offset:35072
    ds_read_b64_tr_b16 v[154:155], v255 offset:35136
    s_nop 7
    v_sub_f32 v16, v16, v254
    v_sub_f32 v17, v17, v254
    v_sub_f32 v18, v18, v254
    v_sub_f32 v19, v19, v254
    v_sub_f32 v20, v20, v254
    v_sub_f32 v21, v21, v254
    v_sub_f32 v22, v22, v254
    v_sub_f32 v23, v23, v254
    v_sub_f32 v24, v24, v254
    v_sub_f32 v25, v25, v254
    v_sub_f32 v26, v26, v254
    v_sub_f32 v27, v27, v254
    v_sub_f32 v28, v28, v254
    v_sub_f32 v29, v29, v254
    v_sub_f32 v30, v30, v254
    v_sub_f32 v31, v31, v254
    v_exp_f32 v16, v16
    v_exp_f32 v17, v17
    v_exp_f32 v18, v18
    v_exp_f32 v19, v19
    v_exp_f32 v20, v20
    v_exp_f32 v21, v21
    v_exp_f32 v22, v22
    v_exp_f32 v23, v23
    v_exp_f32 v24, v24
    v_exp_f32 v25, v25
    v_exp_f32 v26, v26
    v_exp_f32 v27, v27
    v_exp_f32 v28, v28
    v_exp_f32 v29, v29
    v_exp_f32 v30, v30
    v_exp_f32 v31, v31
    s_waitcnt lgkmcnt(2)
    v_smfmac_f32_32x32x32_bf16 v[48:63], v[148:151], v[16:23], v5
    s_waitcnt lgkmcnt(0)
    v_smfmac_f32_32x32x32_bf16 v[48:63], v[152:155], v[24:31], v5
    s_add_u32 s31, s31, 491520
    s_add_u32 s30, s30, 1
    s_cmp_lt_u32 s30, 16
    s_cbranch_scc1 K2_SLOW0_b
    s_nop 7
    v_rcp_f32 v9, v60
    s_nop 0
    v_mul_f32 v48, v48, v9
    v_mul_f32 v49, v49, v9
    v_mul_f32 v50, v50, v9
    v_mul_f32 v51, v51, v9
    v_mul_f32 v52, v52, v9
    v_mul_f32 v53, v53, v9
    v_mul_f32 v54, v54, v9
    v_mul_f32 v55, v55, v9
    v_mul_f32 v56, v56, v9
    v_mul_f32 v57, v57, v9
    v_mul_f32 v58, v58, v9
    v_mul_f32 v59, v59, v9
    v_cvt_pk_bf16_f32 v124, v48, v49
    v_cvt_pk_bf16_f32 v125, v50, v51
    v_cvt_pk_bf16_f32 v126, v52, v53
    v_cvt_pk_bf16_f32 v127, v54, v55
    v_cvt_pk_bf16_f32 v128, v56, v57
    v_cvt_pk_bf16_f32 v129, v58, v59
    v_min_u32 v124, -2, v124
    v_min_u32 v125, -2, v125
    v_min_u32 v126, -2, v126
    v_min_u32 v127, -2, v127
    v_min_u32 v128, -2, v128
    v_min_u32 v129, -2, v129
    buffer_store_dwordx4 v[124:127], v7, s[8:11], s45 offen sc1
    buffer_store_dwordx2 v[128:129], v8, s[8:11], s45 offen offset:1024 sc1
    s_add_u32 m0, s26, 32768
    s_add_u32 s34, s64, 13312
    buffer_load_dwordx4 v6, s[8:11], s34 offen offset:0 lds
    buffer_load_dwordx4 v6, s[8:11], s34 offen offset:1024 lds
    buffer_load_dwordx4 v6, s[8:11], s34 offen offset:2048 lds
    buffer_load_dwordx4 v6, s[8:11], s34 offen offset:3072 lds
    s_add_u32 m0, s26, 65536
    s_add_u32 s34, s64, 17408
    buffer_load_dwordx4 v6, s[8:11], s34 offen offset:0 lds
    buffer_load_dwordx4 v6, s[8:11], s34 offen offset:1024 lds
    buffer_load_dwordx4 v6, s[8:11], s34 offen offset:2048 lds
    buffer_load_dwordx4 v6, s[8:11], s34 offen offset:3072 lds
    s_waitcnt vmcnt(0)
    s_branch K3_GO
K2_SLOW1:
    s_waitcnt vmcnt(0)
    v_cndmask_b32 v122, v122, 0, s[36:37]
    v_cndmask_b32 v123, v123, 0, s[36:37]
    v_mov_b32 v254, 0xff800000
    s_mov_b32 s31, s39
    s_mov_b32 s30, 0
K2_SLOW1_a:
    s_add_u32 s32, s31, 0
    buffer_load_dwordx4 v[124:127], v7, s[8:11], s32 offen
    buffer_load_dwordx2 v[140:141], v8, s[8:11], s32 offen offset:1024
    s_add_u32 s32, s31, 122880
    buffer_load_dwordx4 v[128:131], v7, s[8:11], s32 offen
    buffer_load_dwordx2 v[142:143], v8, s[8:11], s32 offen offset:1024
    s_add_u32 s32, s31, 245760
    buffer_load_dwordx4 v[132:135], v7, s[8:11], s32 offen
    buffer_load_dwordx2 v[144:145], v8, s[8:11], s32 offen offset:1024
    s_add_u32 s32, s31, 368640
    buffer_load_dwordx4 v[136:139], v7, s[8:11], s32 offen
    buffer_load_dwordx2 v[146:147], v8, s[8:11], s32 offen offset:1024
    s_waitcnt vmcnt(7)
    v_mfma_f32_32x32x16_bf16 v[16:31], v[124:127], v[116:119], 0
    s_waitcnt vmcnt(6)
    v_mfma_f32_32x32x8bf16_1k v[16:31], v[140:141], v[122:123], v[16:31]
    s_nop 11
    v_max3_f32 v254, v254, v16, v17
    v_max3_f32 v254, v254, v18, v19
    v_max3_f32 v254, v254, v20, v21
    v_max3_f32 v254, v254, v22, v23
    v_max3_f32 v254, v254, v24, v25
    v_max3_f32 v254, v254, v26, v27
    v_max3_f32 v254, v254, v28, v29
    v_max3_f32 v254, v254, v30, v31
    s_waitcnt vmcnt(5)
    v_mfma_f32_32x32x16_bf16 v[16:31], v[128:131], v[116:119], 0
    s_waitcnt vmcnt(4)
    v_mfma_f32_32x32x8bf16_1k v[16:31], v[142:143], v[122:123], v[16:31]
    s_nop 11
    v_max3_f32 v254, v254, v16, v17
    v_max3_f32 v254, v254, v18, v19
    v_max3_f32 v254, v254, v20, v21
    v_max3_f32 v254, v254, v22, v23
    v_max3_f32 v254, v254, v24, v25
    v_max3_f32 v254, v254, v26, v27
    v_max3_f32 v254, v254, v28, v29
    v_max3_f32 v254, v254, v30, v31
    s_waitcnt vmcnt(3)
    v_mfma_f32_32x32x16_bf16 v[16:31], v[132:135], v[116:119], 0
    s_waitcnt vmcnt(2)
    v_mfma_f32_32x32x8bf16_1k v[16:31], v[144:145], v[122:123], v[16:31]
    s_nop 11
    v_max3_f32 v254, v254, v16, v17
    v_max3_f32 v254, v254, v18, v19
    v_max3_f32 v254, v254, v20, v21
    v_max3_f32 v254, v254, v22, v23
    v_max3_f32 v254, v254, v24, v25
    v_max3_f32 v254, v254, v26, v27
    v_max3_f32 v254, v254, v28, v29
    v_max3_f32 v254, v254, v30, v31
    s_waitcnt vmcnt(1)
    v_mfma_f32_32x32x16_bf16 v[16:31], v[136:139], v[116:119], 0
    s_waitcnt vmcnt(0)
    v_mfma_f32_32x32x8bf16_1k v[16:31], v[146:147], v[122:123], v[16:31]
    s_nop 11
    v_max3_f32 v254, v254, v16, v17
    v_max3_f32 v254, v254, v18, v19
    v_max3_f32 v254, v254, v20, v21
    v_max3_f32 v254, v254, v22, v23
    v_max3_f32 v254, v254, v24, v25
    v_max3_f32 v254, v254, v26, v27
    v_max3_f32 v254, v254, v28, v29
    v_max3_f32 v254, v254, v30, v31
    s_add_u32 s31, s31, 491520
    s_add_u32 s30, s30, 1
    s_cmp_lt_u32 s30, 16
    s_cbranch_scc1 K2_SLOW1_a
    v_mov_b32 v9, v254
    s_nop 1
    v_permlane32_swap_b32 v9, v254
    v_max_f32 v254, v254, v9
    s_add_u32 s34, s26, 32768
    v_add_u32 v255, s34, v255
    s_mov_b32 s31, s39
    s_mov_b32 s30, 0
    v_lshl_add_u32 v9, v0, 3, s34
    v_mov_b32 v16, 0x3f80
    v_mov_b32 v17, 0
    ds_write_b64 v9, v[16:17] offset:1536
    ds_write_b64 v9, v[16:17] offset:3584
    ds_write_b64 v9, v[16:17] offset:34304
    ds_write_b64 v9, v[16:17] offset:36352
    s_waitcnt lgkmcnt(0)
    v_mov_b32 v64, 0
    v_mov_b32 v65, 0
    v_mov_b32 v66, 0
    v_mov_b32 v67, 0
    v_mov_b32 v68, 0
    v_mov_b32 v69, 0
    v_mov_b32 v70, 0
    v_mov_b32 v71, 0
    v_mov_b32 v72, 0
    v_mov_b32 v73, 0
    v_mov_b32 v74, 0
    v_mov_b32 v75, 0
    v_mov_b32 v76, 0
    v_mov_b32 v77, 0
    v_mov_b32 v78, 0
    v_mov_b32 v79, 0
K2_SLOW1_b:
    s_add_u32 s33, s31, 40960
    s_add_u32 m0, s34, 0
    s_nop 0
    buffer_load_dwordx4 v7, s[8:11], s33 offen lds
    s_mov_b32 exec_hi, 0
    buffer_load_dwordx4 v6, s[8:11], s33 offen offset:1024 lds
    s_mov_b32 exec_hi, -1
    s_add_u32 s33, s31, 163840
    s_add_u32 m0, s34, 2048
    s_nop 0
    buffer_load_dwordx4 v7, s[8:11], s33 offen lds
    s_mov_b32 exec_hi, 0
    buffer_load_dwordx4 v6, s[8:11], s33 offen offset:1024 lds
    s_mov_b32 exec_hi, -1
    s_add_u32 s33, s31, 286720
    s_add_u32 m0, s34, 32768
    s_nop 0
    buffer_load_dwordx4 v7, s[8:11], s33 offen lds
    s_mov_b32 exec_hi, 0
    buffer_load_dwordx4 v6, s[8:11], s33 offen offset:1024 lds
    s_mov_b32 exec_hi, -1
    s_add_u32 s33, s31, 409600
    s_add_u32 m0, s34, 34816
    s_nop 0
    buffer_load_dwordx4 v7, s[8:11], s33 offen lds
    s_mov_b32 exec_hi, 0
    buffer_load_dwordx4 v6, s[8:11], s33 offen offset:1024 lds
    s_mov_b32 exec_hi, -1
    s_add_u32 s32, s31, 0
    buffer_load_dwordx4 v[124:127], v7, s[8:11], s32 offen
    buffer_load_dwordx2 v[140:141], v8, s[8:11], s32 offen offset:1024
    s_add_u32 s32, s31, 122880
    buffer_load_dwordx4 v[128:131], v7, s[8:11], s32 offen
    buffer_load_dwordx2 v[142:143], v8, s[8:11], s32 offen offset:1024
    s_add_u32 s32, s31, 245760
    buffer_load_dwordx4 v[132:135], v7, s[8:11], s32 offen
    buffer_load_dwordx2 v[144:145], v8, s[8:11], s32 offen offset:1024
    s_add_u32 s32, s31, 368640
    buffer_load_dwordx4 v[136:139], v7, s[8:11], s32 offen
    buffer_load_dwordx2 v[146:147], v8, s[8:11], s32 offen offset:1024
    s_waitcnt vmcnt(0)
    v_mfma_f32_32x32x16_bf16 v[16:31], v[124:127], v[116:119], 0
    v_mfma_f32_32x32x8bf16_1k v[16:31], v[140:141], v[122:123], v[16:31]
    ds_read_b64_tr_b16 v[148:149], v255 offset:0
    ds_read_b64_tr_b16 v[150:151], v255 offset:64
    ds_read_b64_tr_b16 v[152:153], v255 offset:256
    ds_read_b64_tr_b16 v[154:155], v255 offset:320
    s_nop 7
    v_sub_f32 v16, v16, v254
    v_sub_f32 v17, v17, v254
    v_sub_f32 v18, v18, v254
    v_sub_f32 v19, v19, v254
    v_sub_f32 v20, v20, v254
    v_sub_f32 v21, v21, v254
    v_sub_f32 v22, v22, v254
    v_sub_f32 v23, v23, v254
    v_sub_f32 v24, v24, v254
    v_sub_f32 v25, v25, v254
    v_sub_f32 v26, v26, v254
    v_sub_f32 v27, v27, v254
    v_sub_f32 v28, v28, v254
    v_sub_f32 v29, v29, v254
    v_sub_f32 v30, v30, v254
    v_sub_f32 v31, v31, v254
    v_exp_f32 v16, v16
    v_exp_f32 v17, v17
    v_exp_f32 v18, v18
    v_exp_f32 v19, v19
    v_exp_f32 v20, v20
    v_exp_f32 v21, v21
    v_exp_f32 v22, v22
    v_exp_f32 v23, v23
    v_exp_f32 v24, v24
    v_exp_f32 v25, v25
    v_exp_f32 v26, v26
    v_exp_f32 v27, v27
    v_exp_f32 v28, v28
    v_exp_f32 v29, v29
    v_exp_f32 v30, v30
    v_exp_f32 v31, v31
    s_waitcnt lgkmcnt(2)
    v_smfmac_f32_32x32x32_bf16 v[64:79], v[148:151], v[16:23], v5
    s_waitcnt lgkmcnt(0)
    v_smfmac_f32_32x32x32_bf16 v[64:79], v[152:155], v[24:31], v5
    v_mfma_f32_32x32x16_bf16 v[16:31], v[128:131], v[116:119], 0
    v_mfma_f32_32x32x8bf16_1k v[16:31], v[142:143], v[122:123], v[16:31]
    ds_read_b64_tr_b16 v[148:149], v255 offset:2048
    ds_read_b64_tr_b16 v[150:151], v255 offset:2112
    ds_read_b64_tr_b16 v[152:153], v255 offset:2304
    ds_read_b64_tr_b16 v[154:155], v255 offset:2368
    s_nop 7
    v_sub_f32 v16, v16, v254
    v_sub_f32 v17, v17, v254
    v_sub_f32 v18, v18, v254
    v_sub_f32 v19, v19, v254
    v_sub_f32 v20, v20, v254
    v_sub_f32 v21, v21, v254
    v_sub_f32 v22, v22, v254
    v_sub_f32 v23, v23, v254
    v_sub_f32 v24, v24, v254
    v_sub_f32 v25, v25, v254
    v_sub_f32 v26, v26, v254
    v_sub_f32 v27, v27, v254
    v_sub_f32 v28, v28, v254
    v_sub_f32 v29, v29, v254
    v_sub_f32 v30, v30, v254
    v_sub_f32 v31, v31, v254
    v_exp_f32 v16, v16
    v_exp_f32 v17, v17
    v_exp_f32 v18, v18
    v_exp_f32 v19, v19
    v_exp_f32 v20, v20
    v_exp_f32 v21, v21
    v_exp_f32 v22, v22
    v_exp_f32 v23, v23
    v_exp_f32 v24, v24
    v_exp_f32 v25, v25
    v_exp_f32 v26, v26
    v_exp_f32 v27, v27
    v_exp_f32 v28, v28
    v_exp_f32 v29, v29
    v_exp_f32 v30, v30
    v_exp_f32 v31, v31
    s_waitcnt lgkmcnt(2)
    v_smfmac_f32_32x32x32_bf16 v[64:79], v[148:151], v[16:23], v5
    s_waitcnt lgkmcnt(0)
    v_smfmac_f32_32x32x32_bf16 v[64:79], v[152:155], v[24:31], v5
    v_mfma_f32_32x32x16_bf16 v[16:31], v[132:135], v[116:119], 0
    v_mfma_f32_32x32x8bf16_1k v[16:31], v[144:145], v[122:123], v[16:31]
    ds_read_b64_tr_b16 v[148:149], v255 offset:32768
    ds_read_b64_tr_b16 v[150:151], v255 offset:32832
    ds_read_b64_tr_b16 v[152:153], v255 offset:33024
    ds_read_b64_tr_b16 v[154:155], v255 offset:33088
    s_nop 7
    v_sub_f32 v16, v16, v254
    v_sub_f32 v17, v17, v254
    v_sub_f32 v18, v18, v254
    v_sub_f32 v19, v19, v254
    v_sub_f32 v20, v20, v254
    v_sub_f32 v21, v21, v254
    v_sub_f32 v22, v22, v254
    v_sub_f32 v23, v23, v254
    v_sub_f32 v24, v24, v254
    v_sub_f32 v25, v25, v254
    v_sub_f32 v26, v26, v254
    v_sub_f32 v27, v27, v254
    v_sub_f32 v28, v28, v254
    v_sub_f32 v29, v29, v254
    v_sub_f32 v30, v30, v254
    v_sub_f32 v31, v31, v254
    v_exp_f32 v16, v16
    v_exp_f32 v17, v17
    v_exp_f32 v18, v18
    v_exp_f32 v19, v19
    v_exp_f32 v20, v20
    v_exp_f32 v21, v21
    v_exp_f32 v22, v22
    v_exp_f32 v23, v23
    v_exp_f32 v24, v24
    v_exp_f32 v25, v25
    v_exp_f32 v26, v26
    v_exp_f32 v27, v27
    v_exp_f32 v28, v28
    v_exp_f32 v29, v29
    v_exp_f32 v30, v30
    v_exp_f32 v31, v31
    s_waitcnt lgkmcnt(2)
    v_smfmac_f32_32x32x32_bf16 v[64:79], v[148:151], v[16:23], v5
    s_waitcnt lgkmcnt(0)
    v_smfmac_f32_32x32x32_bf16 v[64:79], v[152:155], v[24:31], v5
    v_mfma_f32_32x32x16_bf16 v[16:31], v[136:139], v[116:119], 0
    v_mfma_f32_32x32x8bf16_1k v[16:31], v[146:147], v[122:123], v[16:31]
    ds_read_b64_tr_b16 v[148:149], v255 offset:34816
    ds_read_b64_tr_b16 v[150:151], v255 offset:34880
    ds_read_b64_tr_b16 v[152:153], v255 offset:35072
    ds_read_b64_tr_b16 v[154:155], v255 offset:35136
    s_nop 7
    v_sub_f32 v16, v16, v254
    v_sub_f32 v17, v17, v254
    v_sub_f32 v18, v18, v254
    v_sub_f32 v19, v19, v254
    v_sub_f32 v20, v20, v254
    v_sub_f32 v21, v21, v254
    v_sub_f32 v22, v22, v254
    v_sub_f32 v23, v23, v254
    v_sub_f32 v24, v24, v254
    v_sub_f32 v25, v25, v254
    v_sub_f32 v26, v26, v254
    v_sub_f32 v27, v27, v254
    v_sub_f32 v28, v28, v254
    v_sub_f32 v29, v29, v254
    v_sub_f32 v30, v30, v254
    v_sub_f32 v31, v31, v254
    v_exp_f32 v16, v16
    v_exp_f32 v17, v17
    v_exp_f32 v18, v18
    v_exp_f32 v19, v19
    v_exp_f32 v20, v20
    v_exp_f32 v21, v21
    v_exp_f32 v22, v22
    v_exp_f32 v23, v23
    v_exp_f32 v24, v24
    v_exp_f32 v25, v25
    v_exp_f32 v26, v26
    v_exp_f32 v27, v27
    v_exp_f32 v28, v28
    v_exp_f32 v29, v29
    v_exp_f32 v30, v30
    v_exp_f32 v31, v31
    s_waitcnt lgkmcnt(2)
    v_smfmac_f32_32x32x32_bf16 v[64:79], v[148:151], v[16:23], v5
    s_waitcnt lgkmcnt(0)
    v_smfmac_f32_32x32x32_bf16 v[64:79], v[152:155], v[24:31], v5
    s_add_u32 s31, s31, 491520
    s_add_u32 s30, s30, 1
    s_cmp_lt_u32 s30, 16
    s_cbranch_scc1 K2_SLOW1_b
    s_nop 7
    v_rcp_f32 v9, v76
    s_nop 0
    v_mul_f32 v64, v64, v9
    v_mul_f32 v65, v65, v9
    v_mul_f32 v66, v66, v9
    v_mul_f32 v67, v67, v9
    v_mul_f32 v68, v68, v9
    v_mul_f32 v69, v69, v9
    v_mul_f32 v70, v70, v9
    v_mul_f32 v71, v71, v9
    v_mul_f32 v72, v72, v9
    v_mul_f32 v73, v73, v9
    v_mul_f32 v74, v74, v9
    v_mul_f32 v75, v75, v9
    v_cvt_pk_bf16_f32 v124, v64, v65
    v_cvt_pk_bf16_f32 v125, v66, v67
    v_cvt_pk_bf16_f32 v126, v68, v69
    v_cvt_pk_bf16_f32 v127, v70, v71
    v_cvt_pk_bf16_f32 v128, v72, v73
    v_cvt_pk_bf16_f32 v129, v74, v75
    v_min_u32 v124, -2, v124
    v_min_u32 v125, -2, v125
    v_min_u32 v126, -2, v126
    v_min_u32 v127, -2, v127
    v_min_u32 v128, -2, v128
    v_min_u32 v129, -2, v129
    buffer_store_dwordx4 v[124:127], v7, s[8:11], s45 offen sc1
    buffer_store_dwordx2 v[128:129], v8, s[8:11], s45 offen offset:1024 sc1
    s_add_u32 m0, s26, 32768
    s_add_u32 s34, s64, 13312
    buffer_load_dwordx4 v6, s[8:11], s34 offen offset:0 lds
    buffer_load_dwordx4 v6, s[8:11], s34 offen offset:1024 lds
    buffer_load_dwordx4 v6, s[8:11], s34 offen offset:2048 lds
    buffer_load_dwordx4 v6, s[8:11], s34 offen offset:3072 lds
    s_add_u32 m0, s26, 65536
    s_add_u32 s34, s64, 17408
    buffer_load_dwordx4 v6, s[8:11], s34 offen offset:0 lds
    buffer_load_dwordx4 v6, s[8:11], s34 offen offset:1024 lds
    buffer_load_dwordx4 v6, s[8:11], s34 offen offset:2048 lds
    buffer_load_dwordx4 v6, s[8:11], s34 offen offset:3072 lds
    s_waitcnt vmcnt(0)
    s_branch K3_GO
K2_FIX:
    s_waitcnt vmcnt(0) lgkmcnt(0)
    s_nop 7
    s_nop 7
    s_nop 7
    v_lshrrev_b32 v73, 5, v0
    v_mul_u32_u24 v74, 6912, v73
    v_lshl_add_u32 v72, v0, 3, v74
    v_mov_b32 v75, 2130706432
    s_lshr_b32 s31, s41, 9
    s_add_u32 s31, s31, 4
    v_add_u32 v74, 0, v73
    v_cmp_gt_u32 vcc, s42, v74
    s_nop 1
    v_cndmask_b32 v76, v75, v6, vcc
    v_add_u32 v74, s31, v74
    v_lshrrev_b32 v74, 3, v74
    v_lshlrev_b32 v74, 6, v74
    v_cndmask_b32 v80, v75, v74, vcc
    v_add_u32 v74, 2, v73
    v_cmp_gt_u32 vcc, s42, v74
    s_nop 1
    v_cndmask_b32 v77, v75, v6, vcc
    v_add_u32 v74, s31, v74
    v_lshrrev_b32 v74, 3, v74
    v_lshlrev_b32 v74, 6, v74
    v_cndmask_b32 v81, v75, v74, vcc
    v_add_u32 v74, 4, v73
    v_cmp_gt_u32 vcc, s42, v74
    s_nop 1
    v_cndmask_b32 v78, v75, v6, vcc
    v_add_u32 v74, s31, v74
    v_lshrrev_b32 v74, 3, v74
    v_lshlrev_b32 v74, 6, v74
    v_cndmask_b32 v82, v75, v74, vcc
    v_add_u32 v74, 6, v73
    v_cmp_gt_u32 vcc, s42, v74
    s_nop 1
    v_cndmask_b32 v79, v75, v6, vcc
    v_add_u32 v74, s31, v74
    v_lshrrev_b32 v74, 3, v74
    v_lshlrev_b32 v74, 6, v74
    v_cndmask_b32 v83, v75, v74, vcc
    s_mov_b32 s30, s20
K2_FIXL:
    s_lshr_b32 s31, s30, 2
    s_lshl_b32 s31, s31, 14
    s_and_b32 s32, s30, 3
    s_lshl_b32 s32, s32, 8
    s_add_u32 s31, s31, s32
    s_add_u32 s31, s31, 22675456
    s_add_u32 s32, s31, 4096
    s_mul_i32 s33, s30, 110592
    s_add_u32 s33, s33, s41
    s_add_u32 s33, s33, 7919616
    s_add_u32 s34, s30, 14942208
    buffer_load_dwordx2 v[16:17], v72, s[8:11], s31 offen offset:0
    buffer_load_dwordx2 v[18:19], v72, s[8:11], s31 offen offset:1024
    buffer_load_dwordx2 v[20:21], v72, s[8:11], s31 offen offset:2048
    buffer_load_dwordx2 v[22:23], v72, s[8:11], s31 offen offset:3072
    buffer_load_dwordx2 v[24:25], v72, s[8:11], s32 offen offset:0
    buffer_load_dwordx2 v[26:27], v72, s[8:11], s32 offen offset:1024
    buffer_load_dwordx2 v[28:29], v72, s[8:11], s32 offen offset:2048
    buffer_load_dwordx4 v[32:35], v76, s[8:11], s33 offen offset:0
    buffer_load_ubyte v48, v80, s[8:11], s34 offen
    buffer_load_dwordx4 v[36:39], v77, s[8:11], s33 offen offset:1024
    buffer_load_ubyte v49, v81, s[8:11], s34 offen
    buffer_load_dwordx4 v[40:43], v78, s[8:11], s33 offen offset:2048
    buffer_load_ubyte v50, v82, s[8:11], s34 offen
    buffer_load_dwordx4 v[44:47], v79, s[8:11], s33 offen offset:3072
    buffer_load_ubyte v51, v83, s[8:11], s34 offen
    s_waitcnt vmcnt(13)
    v_add_f32 v16, v16, v18
    v_add_f32 v17, v17, v19
    s_waitcnt vmcnt(11)
    v_add_f32 v20, v20, v22
    v_add_f32 v21, v21, v23
    s_waitcnt vmcnt(9)
    v_add_f32 v24, v24, v26
    v_add_f32 v25, v25, v27
    s_waitcnt vmcnt(8)
    v_add_f32 v16, v16, v28
    v_add_f32 v17, v17, v29
    v_add_f32 v20, v20, v24
    v_add_f32 v21, v21, v25
    v_add_f32 v16, v16, v20
    v_add_f32 v17, v17, v21
    v_mov_b32 v18, v16
    v_mov_b32 v19, v17
    s_nop 0
    v_permlane32_swap_b32 v16, v18
    v_permlane32_swap_b32 v17, v19
    v_add_f32 v16, v16, v18
    v_add_f32 v17, v17, v19
    v_mul_f32 v16, 0xba97b426, v16
    v_mul_f32 v17, 0x3a97b426, v17
    v_fma_f32 v17, -v16, v16, v17
    v_max_f32 v17, 0, v17
    v_add_f32 v17, 0x3727c5ac, v17
    v_rsq_f32 v18, v17
    s_nop 0
    v_mul_f32 v19, v16, v18
    s_add_u32 s33, s33, 16998400
    s_waitcnt vmcnt(6)
    v_cmp_ne_u32 vcc, 0, v48
    s_nop 1
    v_cndmask_b32 v20, 1.0, v18, vcc
    v_cndmask_b32 v21, 0, v19, vcc
    v_lshlrev_b32 v56, 16, v32
    v_and_b32 v57, 0xffff0000, v32
    v_lshlrev_b32 v58, 16, v33
    v_and_b32 v59, 0xffff0000, v33
    v_lshlrev_b32 v60, 16, v34
    v_and_b32 v61, 0xffff0000, v34
    v_lshlrev_b32 v62, 16, v35
    v_and_b32 v63, 0xffff0000, v35
    v_fma_f32 v56, v56, v20, v21
    v_fma_f32 v57, v57, v20, v21
    v_fma_f32 v58, v58, v20, v21
    v_fma_f32 v59, v59, v20, v21
    v_fma_f32 v60, v60, v20, v21
    v_fma_f32 v61, v61, v20, v21
    v_fma_f32 v62, v62, v20, v21
    v_fma_f32 v63, v63, v20, v21
    v_cvt_pk_bf16_f32 v32, v56, v57
    v_cvt_pk_bf16_f32 v33, v58, v59
    v_cvt_pk_bf16_f32 v34, v60, v61
    v_cvt_pk_bf16_f32 v35, v62, v63
    buffer_store_dwordx4 v[32:35], v76, s[8:11], s33 offen offset:0
    s_waitcnt vmcnt(5)
    v_cmp_ne_u32 vcc, 0, v49
    s_nop 1
    v_cndmask_b32 v20, 1.0, v18, vcc
    v_cndmask_b32 v21, 0, v19, vcc
    v_lshlrev_b32 v56, 16, v36
    v_and_b32 v57, 0xffff0000, v36
    v_lshlrev_b32 v58, 16, v37
    v_and_b32 v59, 0xffff0000, v37
    v_lshlrev_b32 v60, 16, v38
    v_and_b32 v61, 0xffff0000, v38
    v_lshlrev_b32 v62, 16, v39
    v_and_b32 v63, 0xffff0000, v39
    v_fma_f32 v56, v56, v20, v21
    v_fma_f32 v57, v57, v20, v21
    v_fma_f32 v58, v58, v20, v21
    v_fma_f32 v59, v59, v20, v21
    v_fma_f32 v60, v60, v20, v21
    v_fma_f32 v61, v61, v20, v21
    v_fma_f32 v62, v62, v20, v21
    v_fma_f32 v63, v63, v20, v21
    v_cvt_pk_bf16_f32 v36, v56, v57
    v_cvt_pk_bf16_f32 v37, v58, v59
    v_cvt_pk_bf16_f32 v38, v60, v61
    v_cvt_pk_bf16_f32 v39, v62, v63
    buffer_store_dwordx4 v[36:39], v77, s[8:11], s33 offen offset:1024
    s_waitcnt vmcnt(4)
    v_cmp_ne_u32 vcc, 0, v50
    s_nop 1
    v_cndmask_b32 v20, 1.0, v18, vcc
    v_cndmask_b32 v21, 0, v19, vcc
    v_lshlrev_b32 v56, 16, v40
    v_and_b32 v57, 0xffff0000, v40
    v_lshlrev_b32 v58, 16, v41
    v_and_b32 v59, 0xffff0000, v41
    v_lshlrev_b32 v60, 16, v42
    v_and_b32 v61, 0xffff0000, v42
    v_lshlrev_b32 v62, 16, v43
    v_and_b32 v63, 0xffff0000, v43
    v_fma_f32 v56, v56, v20, v21
    v_fma_f32 v57, v57, v20, v21
    v_fma_f32 v58, v58, v20, v21
    v_fma_f32 v59, v59, v20, v21
    v_fma_f32 v60, v60, v20, v21
    v_fma_f32 v61, v61, v20, v21
    v_fma_f32 v62, v62, v20, v21
    v_fma_f32 v63, v63, v20, v21
    v_cvt_pk_bf16_f32 v40, v56, v57
    v_cvt_pk_bf16_f32 v41, v58, v59
    v_cvt_pk_bf16_f32 v42, v60, v61
    v_cvt_pk_bf16_f32 v43, v62, v63
    buffer_store_dwordx4 v[40:43], v78, s[8:11], s33 offen offset:2048
    s_waitcnt vmcnt(3)
    v_cmp_ne_u32 vcc, 0, v51
    s_nop 1
    v_cndmask_b32 v20, 1.0, v18, vcc
    v_cndmask_b32 v21, 0, v19, vcc
    v_lshlrev_b32 v56, 16, v44
    v_and_b32 v57, 0xffff0000, v44
    v_lshlrev_b32 v58, 16, v45
    v_and_b32 v59, 0xffff0000, v45
    v_lshlrev_b32 v60, 16, v46
    v_and_b32 v61, 0xffff0000, v46
    v_lshlrev_b32 v62, 16, v47
    v_and_b32 v63, 0xffff0000, v47
    v_fma_f32 v56, v56, v20, v21
    v_fma_f32 v57, v57, v20, v21
    v_fma_f32 v58, v58, v20, v21
    v_fma_f32 v59, v59, v20, v21
    v_fma_f32 v60, v60, v20, v21
    v_fma_f32 v61, v61, v20, v21
    v_fma_f32 v62, v62, v20, v21
    v_fma_f32 v63, v63, v20, v21
    v_cvt_pk_bf16_f32 v44, v56, v57
    v_cvt_pk_bf16_f32 v45, v58, v59
    v_cvt_pk_bf16_f32 v46, v60, v61
    v_cvt_pk_bf16_f32 v47, v62, v63
    buffer_store_dwordx4 v[44:47], v79, s[8:11], s33 offen offset:3072
    s_waitcnt vmcnt(0)
    s_add_u32 s30, s30, 8
    s_cmp_lt_u32 s30, 64
    s_cbranch_scc1 K2_FIXL
    s_barrier
    s_mov_b32 s50, 24915968
    s_mov_b64 s[48:49], 0
    v_lshl_add_u32 v0, s20, 6, v0
    s_nop 7
    s_branch K2_GO
K2_END:
    s_endpgm
.section .rodata,"a"
.p2align 6
.amdhsa_kernel parallel_sum__softmax_full_mha__mixer_gmlp__prompt_kernel
  .amdhsa_next_free_vgpr 256
  .amdhsa_next_free_sgpr 102
  .amdhsa_accum_offset 256
  .amdhsa_group_segment_fixed_size 0
  .amdhsa_kernarg_size 88
  .amdhsa_user_sgpr_count 2
  .amdhsa_user_sgpr_kernarg_segment_ptr 1
  .amdhsa_system_sgpr_workgroup_id_x 1
.end_amdhsa_kernel
.p2align 6
.amdhsa_kernel k23_kernel
  .amdhsa_next_free_vgpr 256
  .amdhsa_next_free_sgpr 102
  .amdhsa_accum_offset 256
  .amdhsa_group_segment_fixed_size 0
  .amdhsa_kernarg_size 88
  .amdhsa_user_sgpr_count 2
  .amdhsa_user_sgpr_kernarg_segment_ptr 1
  .amdhsa_system_sgpr_workgroup_id_x 1
.end_amdhsa_kernel
```
